```python
import torch

def _softmax(x, axis=-1):
    return torch.softmax(x, dim=axis)
def _gelu(x):
    return torch.nn.functional.gelu(x, approximate="tanh")
def _silu(x):
    return torch.nn.functional.silu(x)
def _sigmoid(x):
    return torch.sigmoid(x)
def _layernorm(x, axis=-1, eps=1e-5):
    m = x.mean(dim=axis, keepdim=True)
    v = x.var(dim=axis, keepdim=True, unbiased=False)
    return (x - m) / torch.sqrt(v + eps)
def _scatter_add(tgt, idx, src, axis=0):
    return tgt.clone().index_add_(axis, idx, src)
def _segment_sum(src, seg, n):
    out = torch.zeros((n,) + src.shape[1:], dtype=src.dtype)
    return out.index_add_(0, seg, src)
def _pad(x, pw):
    flat = tuple(v for pair in reversed(pw) for v in pair)
    return torch.nn.functional.pad(x, flat)

kernel_name = 'concat_heads__mha_block_cached__gqa_block_cached__near_ridge'

def setup_inputs():

    _w = (lambda a: (lambda t: t.to(torch.bfloat16) if t.is_floating_point() else t)(torch.as_tensor(a)))
    def _A_setup():
        B, Sq, D = 32, 32, 640
        H, Sk, Dh = 32, 32, 128
        return {
            "x": _w((lambda *s: torch.randn(*s, dtype=torch.bfloat16) * 0.8)(B, Sq, D)),
            "k_cache": _w((lambda *s: torch.randn(*s, dtype=torch.bfloat16) * 0.8)(B, H, Sk, Dh)),
            "v_cache": _w((lambda *s: torch.randn(*s, dtype=torch.bfloat16) * 0.05)(B, H, Sk, Dh)),
            "wq": _w((lambda *s: torch.randn(*s, dtype=torch.bfloat16) * 0.8)(D, H * Dh) * (D ** -0.5)),
            "wo": _w((lambda *s: torch.randn(*s, dtype=torch.bfloat16) * 0.05)(H * Dh, D) * ((H * Dh) ** -0.5)),
        }
    _A_in = _A_setup()

    def _B_setup():
        B, Sq, D = 32, 32, 640
        Hq, Hkv, Sk, Dh = 32, 32, 32, 128
        assert Hq % Hkv == 0, (Hq, Hkv)
        return {
            "x": _w((lambda *s: torch.randn(*s, dtype=torch.bfloat16) * 0.8)(B, Sq, D)),
            "k_cache": _w((lambda *s: torch.randn(*s, dtype=torch.bfloat16) * 0.8)(B, Hkv, Sk, Dh)),
            "v_cache": _w((lambda *s: torch.randn(*s, dtype=torch.bfloat16) * 0.05)(B, Hkv, Sk, Dh)),
            "wq": _w((lambda *s: torch.randn(*s, dtype=torch.bfloat16) * 0.8)(D, Hq * Dh) * (D ** -0.5)),
            "wo": _w((lambda *s: torch.randn(*s, dtype=torch.bfloat16) * 0.05)(Hq * Dh, D) * ((Hq * Dh) ** -0.5)),
        }
    _B_in = _B_setup()

    return {
        "A_x": _A_in["x"],
        "A_k_cache": _A_in["k_cache"],
        "A_v_cache": _A_in["v_cache"],
        "A_wq": _A_in["wq"],
        "A_wo": _A_in["wo"],
        "B_x": _B_in["x"],
        "B_k_cache": _B_in["k_cache"],
        "B_v_cache": _B_in["v_cache"],
        "B_wq": _B_in["wq"],
        "B_wo": _B_in["wo"],
    }

def reference(A_x, A_k_cache, A_v_cache, A_wq, A_wo, B_x, B_k_cache, B_v_cache, B_wq, B_wo):
    def _A_ref(x, k_cache, v_cache, wq, wo):
        B, Sq, D = x.shape
        H, Dh = 32, 128
        q = (lambda x, *d: x.permute(*d))((x @ wq).reshape(B, Sq, H, Dh), 0, 2, 1, 3)
        scores = torch.einsum("bhqd,bhkd->bhqk", q, k_cache) * (Dh ** -0.5)
        p = _softmax(scores, axis=-1)
        o = torch.einsum("bhqk,bhkd->bhqd", p, v_cache)
        return (lambda x, *d: x.permute(*d))(o, 0, 2, 1, 3).reshape(B, Sq, H * Dh) @ wo

    def _B_ref(x, k_cache, v_cache, wq, wo):
        B, Sq, D = x.shape
        Hq, Dh = 32, 128
        Hkv = k_cache.shape[1]
        rep = Hq // Hkv
        q = (lambda x, *d: x.permute(*d))((x @ wq).reshape(B, Sq, Hq, Dh), 0, 2, 1, 3)
        k = (lambda x, n, axis: torch.repeat_interleave(x, n, dim=axis))(k_cache, rep, axis=1)
        v = (lambda x, n, axis: torch.repeat_interleave(x, n, dim=axis))(v_cache, rep, axis=1)
        scores = torch.einsum("bhqd,bhkd->bhqk", q, k) * (Dh ** -0.5)
        p = _softmax(scores, axis=-1)
        o = torch.einsum("bhqk,bhkd->bhqd", p, v)
        return (lambda x, *d: x.permute(*d))(o, 0, 2, 1, 3).reshape(B, Sq, Hq * Dh) @ wo

    a = _A_ref(A_x, A_k_cache, A_v_cache, A_wq, A_wo)
    b = _B_ref(B_x, B_k_cache, B_v_cache, B_wq, B_wo)
    return torch.concatenate([a, b], axis=-1)
```

```asm
; @launch grid=(256,1,1) block=(512,1,1) lds=163840
.amdgcn_target "amdgcn-amd-amdhsa--gfx950"
.text
.globl concat_heads__mha_block_cached__gqa_block_cached__near_ridge_kernel
.p2align 8
.type concat_heads__mha_block_cached__gqa_block_cached__near_ridge_kernel,@function
concat_heads__mha_block_cached__gqa_block_cached__near_ridge_kernel:
    s_cmp_ge_u32 s2, 256
    s_cbranch_scc1 L_end
    s_load_dwordx16 s[16:31], s[0:1], 0
    s_load_dwordx8 s[32:39], s[0:1], 64
    s_load_dwordx2 s[40:41], s[0:1], 96
    v_lshrrev_b32 v1, 6, v0
    v_and_b32 v255, 63, v0
    s_and_b32 s5, s2, 3
    v_readfirstlane_b32 s3, v1
    s_bfe_u32 s4, s2, 0x10002
    s_lshr_b32 s6, s2, 5
    s_bfe_u32 s7, s2, 0x20003
    s_mov_b32 s46, 1310720
    s_mov_b32 s47, 0x20000
    s_mov_b32 s50, 5242880
    s_mov_b32 s51, 0x20000
    s_mov_b32 s54, 8388608
    s_mov_b32 s55, 0x20000
    s_mov_b32 s58, 8388608
    s_mov_b32 s59, 0x20000
    s_mov_b32 s62, 5242880
    s_mov_b32 s63, 0x20000
    s_mov_b32 s66, 0x10000000
    s_mov_b32 s67, 0x20000
    s_mov_b32 s70, 2621440
    s_mov_b32 s71, 0x20000
    s_mov_b32 s74, 256
    s_mov_b32 s75, 0x20000
    s_cmp_ge_u32 s3, 4
    s_cbranch_scc0 L_compute
    s_sub_u32 s8, s3, 4
    s_lshl_b32 s15, s8, 12
    s_lshl_b32 s13, s6, 2
    s_add_u32 s13, s13, s8
    s_mul_i32 s9, s13, 40960
    s_lshl_b32 s11, s13, 18
    s_lshl_b32 s13, s5, 16
    s_add_u32 s11, s11, s13
    s_lshl_b32 s10, s8, 16
    s_lshl_b32 s13, s5, 11
    s_add_u32 s10, s10, s13
    s_lshl_b32 s13, s7, 9
    s_add_u32 s10, s10, s13
    s_and_b32 s13, s8, 1
    s_lshl_b32 s13, s13, 7
    v_lshrrev_b32 v32, 3, v255
    v_lshrrev_b32 v33, 4, v255
    v_and_b32 v34, 7, v255
    v_xor_b32 v35, v34, v33
    v_lshlrev_b32 v35, 4, v35
    v_xor_b32 v36, 64, v35
    v_mul_u32_u24 v37, 1280, v32
    v_add_u32 v2, v37, v35
    v_add_u32 v3, v37, v36
    v_add_u32 v3, 9216, v3
    v_add_u32 v4, 18432, v2
    v_add_u32 v5, 18432, v3
    v_lshrrev_b32 v38, 5, v255
    v_and_b32 v39, 31, v255
    v_lshlrev_b32 v39, 4, v39
    v_lshlrev_b32 v40, 5, v38
    v_xor_b32 v39, v39, v40
    v_xor_b32 v39, s13, v39
    v_lshl_add_u32 v6, v38, 13, v39
    v_xor_b32 v7, 64, v6
    v_add_u32 v7, 15360, v7
    v_add_u32 v8, 30720, v6
    v_add_u32 v9, 30720, v7
    s_add_u32 s13, s6, s7
    s_and_b32 s13, s13, 3
    s_lshl_b32 s13, s13, 2
    s_lshr_b32 s100, 0x0, s13
    s_and_b32 s100, s100, 15
    s_add_u32 s13, s6, s7
    s_and_b32 s13, s13, 3
    s_lshl_b32 s13, s13, 2
    s_lshr_b32 s101, 0x1010, s13
    s_and_b32 s101, s101, 15
    s_lshr_b32 s99, s6, 1
    s_lshr_b32 s13, s7, 1
    s_add_u32 s99, s99, s13
    s_and_b32 s99, s99, 1
    s_mul_i32 s98, s99, 1
    s_add_u32 s13, s6, s7
    s_and_b32 s13, s13, 1
    s_lshl_b32 s13, s13, 1
    s_or_b32 s98, s98, s13
    s_cmp_eq_u32 s4, 0
    s_waitcnt lgkmcnt(0)
    s_cselect_b64 s[44:45], s[16:17], s[26:27]
    s_cselect_b64 s[48:49], s[22:23], s[32:33]
    s_cselect_b64 s[52:53], s[18:19], s[28:29]
    s_cselect_b64 s[56:57], s[20:21], s[30:31]
    s_cselect_b64 s[60:61], s[24:25], s[34:35]
    s_mov_b64 s[64:65], s[40:41]
    s_mov_b64 s[68:69], s[36:37]
    s_mov_b64 s[72:73], s[38:39]
    s_add_u32 m0, s15, 0
    s_xor_b32 s13, s98, 0
    s_add_u32 s13, s13, s100
    s_sub_u32 s14, s13, 10
    s_cselect_b32 s13, s13, s14
    s_lshl_b32 s13, s13, 7
    s_add_u32 s13, s13, s9
    buffer_load_dwordx4 v2, s[44:47], s13 offen offset:0 lds
    buffer_load_dwordx4 v3, s[44:47], s13 offen offset:1024 lds
    buffer_load_dwordx4 v4, s[44:47], s13 offen offset:2048 lds
    buffer_load_dwordx4 v5, s[44:47], s13 offen offset:3072 lds
    s_add_u32 m0, s15, 131072
    s_xor_b32 s13, s98, 0
    s_add_u32 s13, s13, s100
    s_sub_u32 s14, s13, 10
    s_cselect_b32 s13, s13, s14
    s_lshl_b32 s13, s13, 19
    s_add_u32 s13, s13, s10
    buffer_load_dwordx4 v6, s[48:51], s13 offen offset:0 lds
    buffer_load_dwordx4 v7, s[48:51], s13 offen offset:1024 lds
    buffer_load_dwordx4 v8, s[48:51], s13 offen offset:2048 lds
    buffer_load_dwordx4 v9, s[48:51], s13 offen offset:3072 lds
    s_add_u32 m0, s15, 147456
    s_xor_b32 s13, s98, 0
    s_add_u32 s13, s13, s100
    s_sub_u32 s14, s13, 10
    s_cselect_b32 s13, s13, s14
    s_lshl_b32 s13, s13, 19
    s_add_u32 s13, s13, s10
    s_add_u32 s13, s13, 262144
    buffer_load_dwordx4 v6, s[48:51], s13 offen offset:0 lds
    buffer_load_dwordx4 v7, s[48:51], s13 offen offset:1024 lds
    buffer_load_dwordx4 v8, s[48:51], s13 offen offset:2048 lds
    buffer_load_dwordx4 v9, s[48:51], s13 offen offset:3072 lds
    v_lshl_add_u32 v10, v32, 8, v35
    v_lshl_add_u32 v11, v32, 8, v36
    v_add_u32 v11, 1024, v11
    v_add_u32 v12, 2048, v10
    v_add_u32 v13, 2048, v11
    v_lshlrev_b32 v24, 4, v255
    v_lshlrev_b32 v19, 7, v255
    v_mov_b32 v28, -1
    v_mov_b32 v29, -1
    v_mov_b32 v30, -1
    v_mov_b32 v31, -1
    s_lshl_b32 s27, s4, 5
    s_lshl_b32 s13, s6, 2
    s_add_u32 s27, s27, s13
    s_add_u32 s27, s27, s8
    s_lshl_b32 s27, s27, 5
    s_lshl_b32 s13, s5, 3
    s_add_u32 s27, s27, s13
    s_lshl_b32 s27, s27, 11
    s_lshl_b32 s28, s7, 12
    s_add_u32 s28, s28, s27
    s_and_b32 s13, s8, 1
    s_mul_i32 s13, s13, 4294713344
    s_add_u32 s30, s11, s13
    s_lshl_b32 s13, s7, 14
    s_add_u32 s30, s30, s13
    v_mul_u32_u24 v32, 21846, v255
    v_lshrrev_b32 v32, 16, v32
    v_mul_u32_u24 v33, 3, v32
    v_sub_u32 v33, v255, v33
    v_min_u32 v32, 15, v32
    v_mul_u32_u24 v32, 1280, v32
    v_lshl_add_u32 v20, v33, 7, v32
    v_mov_b32 v25, 1
    s_mul_i32 s42, s8, 5120
    s_mul_i32 s12, s5, 1310720
    s_mul_i32 s13, s8, 20480
    s_add_u32 s12, s12, s13
    s_mul_i32 s13, s7, 320
    s_add_u32 s12, s12, s13
    s_lshl_b32 s43, s4, 3
    s_add_u32 s43, s43, s6
    s_lshl_b32 s43, s43, 4
    s_mov_b32 s26, 0x3e0293ee
    s_lshl_b32 s29, s2, 7
    s_lshl_b32 s13, s8, 2
    s_add_u32 s29, s29, s13
    s_add_u32 s29, s29, 33554432
    v_and_b32 v32, 3, v255
    s_andn2_b32 s14, s2, 0x18
    v_lshl_add_u32 v33, v32, 3, s14
    v_lshlrev_b32 v33, 7, v33
    s_andn2_b32 s13, s13, 4
    s_add_u32 s13, s13, 33554432
    v_add_u32 v21, s13, v33
    v_and_b32 v33, 4, v255
    v_add_u32 v21, v21, v33
    s_andn2_b32 s14, s2, 3
    v_add_u32 v33, s14, v32
    v_lshlrev_b32 v33, 7, v33
    s_lshl_b32 s13, s5, 2
    s_add_u32 s13, s13, 33554448
    v_add_u32 v22, s13, v33
    s_sub_u32 s31, s2, s5
    s_add_u32 s31, s31, s8
    s_lshl_b32 s31, s31, 2
    s_add_u32 s31, s31, s5
    s_mul_i32 s31, s31, 10240
    s_add_u32 s31, s31, 8388608
    s_cmp_eq_u32 s8, s5
    s_cselect_b32 s31, 0x20000000, s31
    v_add_u32 v32, 0, v255
    v_mul_u32_u24 v33, 3277, v32
    v_lshrrev_b32 v33, 16, v33
    v_mul_u32_u24 v34, 20, v33
    v_sub_u32 v34, v32, v34
    v_bfe_u32 v35, v33, 3, 1
    v_lshlrev_b32 v35, 1, v35
    v_xor_b32 v34, v34, v35
    v_lshlrev_b32 v34, 4, v34
    v_mul_u32_u24 v33, 1280, v33
    v_add_u32 v14, v33, v34
    v_add_u32 v32, 64, v255
    v_mul_u32_u24 v33, 3277, v32
    v_lshrrev_b32 v33, 16, v33
    v_mul_u32_u24 v34, 20, v33
    v_sub_u32 v34, v32, v34
    v_bfe_u32 v35, v33, 3, 1
    v_lshlrev_b32 v35, 1, v35
    v_xor_b32 v34, v34, v35
    v_lshlrev_b32 v34, 4, v34
    v_mul_u32_u24 v33, 1280, v33
    v_add_u32 v15, v33, v34
    v_subrev_u32 v15, 1024, v15
    v_add_u32 v32, 128, v255
    v_mul_u32_u24 v33, 3277, v32
    v_lshrrev_b32 v33, 16, v33
    v_mul_u32_u24 v34, 20, v33
    v_sub_u32 v34, v32, v34
    v_bfe_u32 v35, v33, 3, 1
    v_lshlrev_b32 v35, 1, v35
    v_xor_b32 v34, v34, v35
    v_lshlrev_b32 v34, 4, v34
    v_mul_u32_u24 v33, 1280, v33
    v_add_u32 v16, v33, v34
    v_subrev_u32 v16, 2048, v16
    v_add_u32 v32, 192, v255
    v_mul_u32_u24 v33, 3277, v32
    v_lshrrev_b32 v33, 16, v33
    v_mul_u32_u24 v34, 20, v33
    v_sub_u32 v34, v32, v34
    v_bfe_u32 v35, v33, 3, 1
    v_lshlrev_b32 v35, 1, v35
    v_xor_b32 v34, v34, v35
    v_lshlrev_b32 v34, 4, v34
    v_mul_u32_u24 v33, 1280, v33
    v_add_u32 v17, v33, v34
    v_subrev_u32 v17, 3072, v17
    v_add_u32 v32, 256, v255
    v_mul_u32_u24 v33, 3277, v32
    v_lshrrev_b32 v33, 16, v33
    v_mul_u32_u24 v34, 20, v33
    v_sub_u32 v34, v32, v34
    v_bfe_u32 v35, v33, 3, 1
    v_lshlrev_b32 v35, 1, v35
    v_xor_b32 v34, v34, v35
    v_lshlrev_b32 v34, 4, v34
    v_mul_u32_u24 v33, 1280, v33
    v_add_u32 v18, v33, v34
    s_waitcnt vmcnt(4)
    s_barrier
    s_add_u32 m0, s15, 16384
    s_xor_b32 s13, s98, 1
    s_add_u32 s13, s13, s100
    s_sub_u32 s14, s13, 10
    s_cselect_b32 s13, s13, s14
    s_lshl_b32 s13, s13, 7
    s_add_u32 s13, s13, s9
    buffer_load_dwordx4 v2, s[44:47], s13 offen offset:0 lds
    buffer_load_dwordx4 v3, s[44:47], s13 offen offset:1024 lds
    buffer_load_dwordx4 v4, s[44:47], s13 offen offset:2048 lds
    buffer_load_dwordx4 v5, s[44:47], s13 offen offset:3072 lds
    s_add_u32 m0, s15, 65536
    s_xor_b32 s13, s98, 1
    s_add_u32 s13, s13, s100
    s_sub_u32 s14, s13, 10
    s_cselect_b32 s13, s13, s14
    s_lshl_b32 s13, s13, 19
    s_add_u32 s13, s13, s10
    buffer_load_dwordx4 v6, s[48:51], s13 offen offset:0 lds
    buffer_load_dwordx4 v7, s[48:51], s13 offen offset:1024 lds
    buffer_load_dwordx4 v8, s[48:51], s13 offen offset:2048 lds
    buffer_load_dwordx4 v9, s[48:51], s13 offen offset:3072 lds
    s_waitcnt vmcnt(8)
    s_barrier
    s_add_u32 m0, s15, 81920
    s_xor_b32 s13, s98, 1
    s_add_u32 s13, s13, s100
    s_sub_u32 s14, s13, 10
    s_cselect_b32 s13, s13, s14
    s_lshl_b32 s13, s13, 19
    s_add_u32 s13, s13, s10
    s_add_u32 s13, s13, 262144
    buffer_load_dwordx4 v6, s[48:51], s13 offen offset:0 lds
    buffer_load_dwordx4 v7, s[48:51], s13 offen offset:1024 lds
    buffer_load_dwordx4 v8, s[48:51], s13 offen offset:2048 lds
    buffer_load_dwordx4 v9, s[48:51], s13 offen offset:3072 lds
    s_add_u32 m0, s15, 32768
    s_xor_b32 s13, s98, 2
    s_add_u32 s13, s13, s100
    s_sub_u32 s14, s13, 10
    s_cselect_b32 s13, s13, s14
    s_lshl_b32 s13, s13, 7
    s_add_u32 s13, s13, s9
    buffer_load_dwordx4 v2, s[44:47], s13 offen offset:0 lds
    buffer_load_dwordx4 v3, s[44:47], s13 offen offset:1024 lds
    buffer_load_dwordx4 v4, s[44:47], s13 offen offset:2048 lds
    buffer_load_dwordx4 v5, s[44:47], s13 offen offset:3072 lds
    s_waitcnt vmcnt(8)
    s_barrier
    s_add_u32 m0, s15, 98304
    s_xor_b32 s13, s98, 2
    s_add_u32 s13, s13, s100
    s_sub_u32 s14, s13, 10
    s_cselect_b32 s13, s13, s14
    s_lshl_b32 s13, s13, 19
    s_add_u32 s13, s13, s10
    buffer_load_dwordx4 v6, s[48:51], s13 offen offset:0 lds
    buffer_load_dwordx4 v7, s[48:51], s13 offen offset:1024 lds
    buffer_load_dwordx4 v8, s[48:51], s13 offen offset:2048 lds
    buffer_load_dwordx4 v9, s[48:51], s13 offen offset:3072 lds
    s_add_u32 m0, s15, 114688
    s_xor_b32 s13, s98, 2
    s_add_u32 s13, s13, s100
    s_sub_u32 s14, s13, 10
    s_cselect_b32 s13, s13, s14
    s_lshl_b32 s13, s13, 19
    s_add_u32 s13, s13, s10
    s_add_u32 s13, s13, 262144
    buffer_load_dwordx4 v6, s[48:51], s13 offen offset:0 lds
    buffer_load_dwordx4 v7, s[48:51], s13 offen offset:1024 lds
    buffer_load_dwordx4 v8, s[48:51], s13 offen offset:2048 lds
    buffer_load_dwordx4 v9, s[48:51], s13 offen offset:3072 lds
    s_add_u32 m0, s15, 49152
    s_xor_b32 s13, s98, 3
    s_add_u32 s13, s13, s100
    s_sub_u32 s14, s13, 10
    s_cselect_b32 s13, s13, s14
    s_lshl_b32 s13, s13, 7
    s_add_u32 s13, s13, s9
    buffer_load_dwordx4 v2, s[44:47], s13 offen offset:0 lds
    buffer_load_dwordx4 v3, s[44:47], s13 offen offset:1024 lds
    s_waitcnt vmcnt(14)
    s_barrier
    s_add_u32 m0, s15, 49152
    s_xor_b32 s13, s98, 3
    s_add_u32 s13, s13, s100
    s_sub_u32 s14, s13, 10
    s_cselect_b32 s13, s13, s14
    s_lshl_b32 s13, s13, 7
    s_add_u32 s13, s13, s9
    buffer_load_dwordx4 v4, s[44:47], s13 offen offset:2048 lds
    buffer_load_dwordx4 v5, s[44:47], s13 offen offset:3072 lds
    s_add_u32 m0, s15, 131072
    s_xor_b32 s13, s98, 3
    s_add_u32 s13, s13, s100
    s_sub_u32 s14, s13, 10
    s_cselect_b32 s13, s13, s14
    s_lshl_b32 s13, s13, 19
    s_add_u32 s13, s13, s10
    buffer_load_dwordx4 v6, s[48:51], s13 offen offset:0 lds
    buffer_load_dwordx4 v7, s[48:51], s13 offen offset:1024 lds
    buffer_load_dwordx4 v8, s[48:51], s13 offen offset:2048 lds
    buffer_load_dwordx4 v9, s[48:51], s13 offen offset:3072 lds
    s_add_u32 m0, s15, 147456
    s_xor_b32 s13, s98, 3
    s_add_u32 s13, s13, s100
    s_sub_u32 s14, s13, 10
    s_cselect_b32 s13, s13, s14
    s_lshl_b32 s13, s13, 19
    s_add_u32 s13, s13, s10
    s_add_u32 s13, s13, 262144
    buffer_load_dwordx4 v6, s[48:51], s13 offen offset:0 lds
    buffer_load_dwordx4 v7, s[48:51], s13 offen offset:1024 lds
    buffer_load_dwordx4 v8, s[48:51], s13 offen offset:2048 lds
    buffer_load_dwordx4 v9, s[48:51], s13 offen offset:3072 lds
    s_waitcnt vmcnt(16)
    s_barrier
    s_add_u32 m0, s15, 0
    s_xor_b32 s13, s98, 4
    s_add_u32 s13, s13, s100
    s_sub_u32 s14, s13, 10
    s_cselect_b32 s13, s13, s14
    s_lshl_b32 s13, s13, 7
    s_add_u32 s13, s13, s9
    buffer_load_dwordx4 v2, s[44:47], s13 offen offset:0 lds
    buffer_load_dwordx4 v3, s[44:47], s13 offen offset:1024 lds
    buffer_load_dwordx4 v4, s[44:47], s13 offen offset:2048 lds
    buffer_load_dwordx4 v5, s[44:47], s13 offen offset:3072 lds
    s_add_u32 m0, s15, 65536
    s_xor_b32 s13, s98, 4
    s_add_u32 s13, s13, s100
    s_sub_u32 s14, s13, 10
    s_cselect_b32 s13, s13, s14
    s_lshl_b32 s13, s13, 19
    s_add_u32 s13, s13, s10
    buffer_load_dwordx4 v6, s[48:51], s13 offen offset:0 lds
    buffer_load_dwordx4 v7, s[48:51], s13 offen offset:1024 lds
    buffer_load_dwordx4 v8, s[48:51], s13 offen offset:2048 lds
    buffer_load_dwordx4 v9, s[48:51], s13 offen offset:3072 lds
    s_waitcnt vmcnt(20)
    s_barrier
    s_add_u32 m0, s15, 81920
    s_xor_b32 s13, s98, 4
    s_add_u32 s13, s13, s100
    s_sub_u32 s14, s13, 10
    s_cselect_b32 s13, s13, s14
    s_lshl_b32 s13, s13, 19
    s_add_u32 s13, s13, s10
    s_add_u32 s13, s13, 262144
    buffer_load_dwordx4 v6, s[48:51], s13 offen offset:0 lds
    buffer_load_dwordx4 v7, s[48:51], s13 offen offset:1024 lds
    buffer_load_dwordx4 v8, s[48:51], s13 offen offset:2048 lds
    buffer_load_dwordx4 v9, s[48:51], s13 offen offset:3072 lds
    s_waitcnt vmcnt(16)
    s_barrier
    s_add_u32 m0, s15, 16384
    s_xor_b32 s13, s98, 5
    s_add_u32 s13, s13, s100
    s_sub_u32 s14, s13, 10
    s_cselect_b32 s13, s13, s14
    s_lshl_b32 s13, s13, 7
    s_add_u32 s13, s13, s9
    buffer_load_dwordx4 v2, s[44:47], s13 offen offset:0 lds
    buffer_load_dwordx4 v3, s[44:47], s13 offen offset:1024 lds
    s_waitcnt vmcnt(14)
    s_barrier
    s_add_u32 m0, s15, 16384
    s_xor_b32 s13, s98, 5
    s_add_u32 s13, s13, s100
    s_sub_u32 s14, s13, 10
    s_cselect_b32 s13, s13, s14
    s_lshl_b32 s13, s13, 7
    s_add_u32 s13, s13, s9
    buffer_load_dwordx4 v4, s[44:47], s13 offen offset:2048 lds
    buffer_load_dwordx4 v5, s[44:47], s13 offen offset:3072 lds
    s_add_u32 m0, s15, 98304
    s_xor_b32 s13, s98, 5
    s_add_u32 s13, s13, s100
    s_sub_u32 s14, s13, 10
    s_cselect_b32 s13, s13, s14
    s_lshl_b32 s13, s13, 19
    s_add_u32 s13, s13, s10
    buffer_load_dwordx4 v6, s[48:51], s13 offen offset:0 lds
    buffer_load_dwordx4 v7, s[48:51], s13 offen offset:1024 lds
    buffer_load_dwordx4 v8, s[48:51], s13 offen offset:2048 lds
    buffer_load_dwordx4 v9, s[48:51], s13 offen offset:3072 lds
    s_add_u32 m0, s15, 114688
    s_xor_b32 s13, s98, 5
    s_add_u32 s13, s13, s100
    s_sub_u32 s14, s13, 10
    s_cselect_b32 s13, s13, s14
    s_lshl_b32 s13, s13, 19
    s_add_u32 s13, s13, s10
    s_add_u32 s13, s13, 262144
    buffer_load_dwordx4 v6, s[48:51], s13 offen offset:0 lds
    buffer_load_dwordx4 v7, s[48:51], s13 offen offset:1024 lds
    s_waitcnt vmcnt(14)
    s_barrier
    s_add_u32 m0, s15, 114688
    s_xor_b32 s13, s98, 5
    s_add_u32 s13, s13, s100
    s_sub_u32 s14, s13, 10
    s_cselect_b32 s13, s13, s14
    s_lshl_b32 s13, s13, 19
    s_add_u32 s13, s13, s10
    s_add_u32 s13, s13, 262144
    buffer_load_dwordx4 v8, s[48:51], s13 offen offset:2048 lds
    buffer_load_dwordx4 v9, s[48:51], s13 offen offset:3072 lds
    s_add_u32 m0, s15, 32768
    s_xor_b32 s13, s98, 6
    s_add_u32 s13, s13, s100
    s_sub_u32 s14, s13, 10
    s_cselect_b32 s13, s13, s14
    s_lshl_b32 s13, s13, 7
    s_add_u32 s13, s13, s9
    buffer_load_dwordx4 v2, s[44:47], s13 offen offset:0 lds
    buffer_load_dwordx4 v3, s[44:47], s13 offen offset:1024 lds
    buffer_load_dwordx4 v4, s[44:47], s13 offen offset:2048 lds
    buffer_load_dwordx4 v5, s[44:47], s13 offen offset:3072 lds
    s_add_u32 m0, s15, 131072
    s_xor_b32 s13, s98, 6
    s_add_u32 s13, s13, s100
    s_sub_u32 s14, s13, 10
    s_cselect_b32 s13, s13, s14
    s_lshl_b32 s13, s13, 19
    s_add_u32 s13, s13, s10
    buffer_load_dwordx4 v6, s[48:51], s13 offen offset:0 lds
    buffer_load_dwordx4 v7, s[48:51], s13 offen offset:1024 lds
    s_and_b32 s14, s6, 1
    s_cmp_eq_u32 s14, 0
    s_cbranch_scc0 L_t1
    s_mov_b32 s13, s30
    buffer_load_dword v40, v19, s[52:55], s13 offen
    s_add_u32 s13, s30, 262144
    buffer_load_dword v40, v19, s[52:55], s13 offen
L_t1:
    s_waitcnt vmcnt(18)
    s_barrier
    s_add_u32 m0, s15, 131072
    s_xor_b32 s13, s98, 6
    s_add_u32 s13, s13, s100
    s_sub_u32 s14, s13, 10
    s_cselect_b32 s13, s13, s14
    s_lshl_b32 s13, s13, 19
    s_add_u32 s13, s13, s10
    buffer_load_dwordx4 v8, s[48:51], s13 offen offset:2048 lds
    buffer_load_dwordx4 v9, s[48:51], s13 offen offset:3072 lds
    s_add_u32 m0, s15, 147456
    s_xor_b32 s13, s98, 6
    s_add_u32 s13, s13, s100
    s_sub_u32 s14, s13, 10
    s_cselect_b32 s13, s13, s14
    s_lshl_b32 s13, s13, 19
    s_add_u32 s13, s13, s10
    s_add_u32 s13, s13, 262144
    buffer_load_dwordx4 v6, s[48:51], s13 offen offset:0 lds
    buffer_load_dwordx4 v7, s[48:51], s13 offen offset:1024 lds
    buffer_load_dwordx4 v8, s[48:51], s13 offen offset:2048 lds
    buffer_load_dwordx4 v9, s[48:51], s13 offen offset:3072 lds
    s_add_u32 m0, s15, 49152
    s_xor_b32 s13, s98, 7
    s_add_u32 s13, s13, s100
    s_sub_u32 s14, s13, 10
    s_cselect_b32 s13, s13, s14
    s_lshl_b32 s13, s13, 7
    s_add_u32 s13, s13, s9
    buffer_load_dwordx4 v2, s[44:47], s13 offen offset:0 lds
    buffer_load_dwordx4 v3, s[44:47], s13 offen offset:1024 lds
    s_waitcnt vmcnt(18)
    s_barrier
    s_lshl_b32 s13, s4, 5
    s_add_u32 s13, s13, s6
    s_lshl_b32 s13, s13, 2
    v_and_b32 v51, 3, v255
    v_lshl_add_u32 v51, v51, 5, s13
    buffer_load_dword v23, v51, s[72:75], 0 offen sc1
    s_add_u32 m0, s15, 49152
    s_xor_b32 s13, s98, 7
    s_add_u32 s13, s13, s100
    s_sub_u32 s14, s13, 10
    s_cselect_b32 s13, s13, s14
    s_lshl_b32 s13, s13, 7
    s_add_u32 s13, s13, s9
    buffer_load_dwordx4 v4, s[44:47], s13 offen offset:2048 lds
    buffer_load_dwordx4 v5, s[44:47], s13 offen offset:3072 lds
    s_add_u32 m0, s15, 65536
    s_xor_b32 s13, s98, 7
    s_add_u32 s13, s13, s100
    s_sub_u32 s14, s13, 10
    s_cselect_b32 s13, s13, s14
    s_lshl_b32 s13, s13, 19
    s_add_u32 s13, s13, s10
    buffer_load_dwordx4 v6, s[48:51], s13 offen offset:0 lds
    buffer_load_dwordx4 v7, s[48:51], s13 offen offset:1024 lds
    buffer_load_dwordx4 v8, s[48:51], s13 offen offset:2048 lds
    buffer_load_dwordx4 v9, s[48:51], s13 offen offset:3072 lds
    s_waitcnt vmcnt(21)
    s_barrier
    s_add_u32 m0, s15, 81920
    s_xor_b32 s13, s98, 7
    s_add_u32 s13, s13, s100
    s_sub_u32 s14, s13, 10
    s_cselect_b32 s13, s13, s14
    s_lshl_b32 s13, s13, 19
    s_add_u32 s13, s13, s10
    s_add_u32 s13, s13, 262144
    buffer_load_dwordx4 v6, s[48:51], s13 offen offset:0 lds
    buffer_load_dwordx4 v7, s[48:51], s13 offen offset:1024 lds
    buffer_load_dwordx4 v8, s[48:51], s13 offen offset:2048 lds
    buffer_load_dwordx4 v9, s[48:51], s13 offen offset:3072 lds
    s_add_u32 m0, s15, 0
    s_xor_b32 s13, s99, 8
    s_add_u32 s13, s13, s100
    s_sub_u32 s14, s13, 10
    s_cselect_b32 s13, s13, s14
    s_lshl_b32 s13, s13, 7
    s_add_u32 s13, s13, s9
    buffer_load_dwordx4 v2, s[44:47], s13 offen offset:0 lds
    buffer_load_dwordx4 v3, s[44:47], s13 offen offset:1024 lds
    buffer_load_dwordx4 v4, s[44:47], s13 offen offset:2048 lds
    buffer_load_dwordx4 v5, s[44:47], s13 offen offset:3072 lds
    s_waitcnt vmcnt(21)
    s_barrier
    s_add_u32 m0, s15, 98304
    s_xor_b32 s13, s99, 8
    s_add_u32 s13, s13, s100
    s_sub_u32 s14, s13, 10
    s_cselect_b32 s13, s13, s14
    s_lshl_b32 s13, s13, 19
    s_add_u32 s13, s13, s10
    buffer_load_dwordx4 v6, s[48:51], s13 offen offset:0 lds
    buffer_load_dwordx4 v7, s[48:51], s13 offen offset:1024 lds
    buffer_load_dwordx4 v8, s[48:51], s13 offen offset:2048 lds
    buffer_load_dwordx4 v9, s[48:51], s13 offen offset:3072 lds
    s_waitcnt vmcnt(21)
    s_waitcnt vmcnt(18)
    v_cmp_ne_u32 vcc, 0, v23
    s_nop 0
    s_cmp_eq_u64 vcc, exec
    s_cbranch_scc0 L_mark_s
L_mark_d:
    s_barrier
    s_getpc_b64 s[38:39]
L_pc2:
    s_sub_u32 s38, s38, L_pc2-concat_heads__mha_block_cached__gqa_block_cached__near_ridge_kernel
    s_subb_u32 s39, s39, 0
    s_lshr_b32 s13, s2, 3
    s_lshl_b32 s13, s13, 2
    s_add_u32 s13, s13, s8
    s_lshl_b32 s13, s13, 7
    v_mov_b32 v46, s13
    v_add_u32 v47, L_at_B12-concat_heads__mha_block_cached__gqa_block_cached__near_ridge_kernel, v46
    v_min_u32 v47, L_end-concat_heads__mha_block_cached__gqa_block_cached__near_ridge_kernel, v47
    global_load_dword v48, v47, s[38:39]
    s_add_u32 m0, s15, 114688
    s_xor_b32 s13, s99, 8
    s_add_u32 s13, s13, s100
    s_sub_u32 s14, s13, 10
    s_cselect_b32 s13, s13, s14
    s_lshl_b32 s13, s13, 19
    s_add_u32 s13, s13, s10
    s_add_u32 s13, s13, 262144
    buffer_load_dwordx4 v6, s[48:51], s13 offen offset:0 lds
    buffer_load_dwordx4 v7, s[48:51], s13 offen offset:1024 lds
    buffer_load_dwordx4 v8, s[48:51], s13 offen offset:2048 lds
    buffer_load_dwordx4 v9, s[48:51], s13 offen offset:3072 lds
    s_add_u32 m0, s15, 16384
    s_xor_b32 s13, s99, 9
    s_add_u32 s13, s13, s100
    s_sub_u32 s14, s13, 10
    s_cselect_b32 s13, s13, s14
    s_lshl_b32 s13, s13, 7
    s_add_u32 s13, s13, s9
    buffer_load_dwordx4 v2, s[44:47], s13 offen offset:0 lds
    buffer_load_dwordx4 v3, s[44:47], s13 offen offset:1024 lds
    buffer_load_dwordx4 v4, s[44:47], s13 offen offset:2048 lds
    buffer_load_dwordx4 v5, s[44:47], s13 offen offset:3072 lds
    s_waitcnt vmcnt(20)
    s_barrier
    s_add_u32 m0, s15, 131072
    s_xor_b32 s13, s99, 9
    s_add_u32 s13, s13, s100
    s_sub_u32 s14, s13, 10
    s_cselect_b32 s13, s13, s14
    s_lshl_b32 s13, s13, 19
    s_add_u32 s13, s13, s10
    buffer_load_dwordx4 v6, s[48:51], s13 offen offset:0 lds
    buffer_load_dwordx4 v7, s[48:51], s13 offen offset:1024 lds
    buffer_load_dwordx4 v8, s[48:51], s13 offen offset:2048 lds
    buffer_load_dwordx4 v9, s[48:51], s13 offen offset:3072 lds
    s_waitcnt vmcnt(20)
    s_barrier
    s_add_u32 m0, s15, 147456
    s_xor_b32 s13, s99, 9
    s_add_u32 s13, s13, s100
    s_sub_u32 s14, s13, 10
    s_cselect_b32 s13, s13, s14
    s_lshl_b32 s13, s13, 19
    s_add_u32 s13, s13, s10
    s_add_u32 s13, s13, 262144
    buffer_load_dwordx4 v6, s[48:51], s13 offen offset:0 lds
    buffer_load_dwordx4 v7, s[48:51], s13 offen offset:1024 lds
    buffer_load_dwordx4 v8, s[48:51], s13 offen offset:2048 lds
    buffer_load_dwordx4 v9, s[48:51], s13 offen offset:3072 lds
    s_add_u32 m0, s15, 32768
    s_mov_b32 s13, s30
    buffer_load_dwordx4 v10, s[52:55], s13 offen offset:0 nt lds
    buffer_load_dwordx4 v11, s[52:55], s13 offen offset:1024 nt lds
    buffer_load_dwordx4 v12, s[52:55], s13 offen offset:2048 nt lds
    buffer_load_dwordx4 v13, s[52:55], s13 offen offset:3072 nt lds
    s_waitcnt vmcnt(20)
    s_barrier
    s_add_u32 m0, s15, 65536
    s_add_u32 s13, s30, 128
    buffer_load_dwordx4 v10, s[52:55], s13 offen offset:0 nt lds
    buffer_load_dwordx4 v11, s[52:55], s13 offen offset:1024 nt lds
    buffer_load_dwordx4 v12, s[52:55], s13 offen offset:2048 nt lds
    buffer_load_dwordx4 v13, s[52:55], s13 offen offset:3072 nt lds
    s_waitcnt vmcnt(20)
    s_barrier
    s_add_u32 m0, s15, 49152
    s_add_u32 s13, s30, 262144
    buffer_load_dwordx4 v10, s[52:55], s13 offen offset:0 nt lds
    buffer_load_dwordx4 v11, s[52:55], s13 offen offset:1024 nt lds
    buffer_load_dwordx4 v12, s[52:55], s13 offen offset:2048 nt lds
    buffer_load_dwordx4 v13, s[52:55], s13 offen offset:3072 nt lds
    s_waitcnt vmcnt(16)
    s_barrier
    s_add_u32 m0, s15, 81920
    s_add_u32 s13, s30, 262272
    buffer_load_dwordx4 v10, s[52:55], s13 offen offset:0 nt lds
    buffer_load_dwordx4 v11, s[52:55], s13 offen offset:1024 nt lds
    buffer_load_dwordx4 v12, s[52:55], s13 offen offset:2048 nt lds
    buffer_load_dwordx4 v13, s[52:55], s13 offen offset:3072 nt lds
    s_waitcnt vmcnt(16)
    s_barrier
    s_add_u32 m0, s15, 0
    s_xor_b32 s13, s101, 0
    s_and_b32 s13, s13, 7
    s_mul_i32 s13, s13, 8192
    s_add_u32 s13, s13, s11
    s_xor_b32 s14, s99, 0
    s_mul_i32 s14, s14, 128
    s_add_u32 s13, s13, s14
    buffer_load_dwordx4 v10, s[56:59], s13 offen offset:0 lds
    buffer_load_dwordx4 v11, s[56:59], s13 offen offset:1024 lds
    buffer_load_dwordx4 v12, s[56:59], s13 offen offset:2048 lds
    buffer_load_dwordx4 v13, s[56:59], s13 offen offset:3072 lds
    s_barrier
    s_add_u32 m0, s42, 98304
    s_xor_b32 s13, s101, 0
    s_and_b32 s13, s13, 7
    s_mul_i32 s13, s13, 163840
    s_add_u32 s13, s13, s12
    s_xor_b32 s14, s99, 0
    s_mul_i32 s14, s14, 81920
    s_add_u32 s13, s13, s14
    buffer_load_dwordx4 v14, s[60:63], s13 offen offset:0 lds
    buffer_load_dwordx4 v15, s[60:63], s13 offen offset:1024 lds
    buffer_load_dwordx4 v16, s[60:63], s13 offen offset:2048 lds
    buffer_load_dwordx4 v17, s[60:63], s13 offen offset:3072 lds
    s_add_u32 m0, m0, 4096
    s_nop 0
    buffer_load_dwordx4 v18, s[60:63], s13 offen offset:0 lds
    s_waitcnt vmcnt(17)
    s_barrier
    s_add_u32 m0, s15, 16384
    s_xor_b32 s13, s101, 0
    s_and_b32 s13, s13, 7
    s_mul_i32 s13, s13, 8192
    s_add_u32 s13, s13, s11
    s_xor_b32 s14, s99, 1
    s_mul_i32 s14, s14, 128
    s_add_u32 s13, s13, s14
    buffer_load_dwordx4 v10, s[56:59], s13 offen offset:0 lds
    buffer_load_dwordx4 v11, s[56:59], s13 offen offset:1024 lds
    buffer_load_dwordx4 v12, s[56:59], s13 offen offset:2048 lds
    buffer_load_dwordx4 v13, s[56:59], s13 offen offset:3072 lds
    s_add_u32 m0, s42, 118784
    s_xor_b32 s13, s101, 0
    s_and_b32 s13, s13, 7
    s_mul_i32 s13, s13, 163840
    s_add_u32 s13, s13, s12
    s_xor_b32 s14, s99, 1
    s_mul_i32 s14, s14, 81920
    s_add_u32 s13, s13, s14
    buffer_load_dwordx4 v14, s[60:63], s13 offen offset:0 lds
    buffer_load_dwordx4 v15, s[60:63], s13 offen offset:1024 lds
    buffer_load_dwordx4 v16, s[60:63], s13 offen offset:2048 lds
    buffer_load_dwordx4 v17, s[60:63], s13 offen offset:3072 lds
    s_add_u32 m0, m0, 4096
    s_nop 0
    buffer_load_dwordx4 v18, s[60:63], s13 offen offset:0 lds
    s_waitcnt vmcnt(18)
    s_barrier
    s_add_u32 m0, s15, 32768
    s_xor_b32 s13, s101, 1
    s_and_b32 s13, s13, 7
    s_mul_i32 s13, s13, 8192
    s_add_u32 s13, s13, s11
    s_xor_b32 s14, s99, 0
    s_mul_i32 s14, s14, 128
    s_add_u32 s13, s13, s14
    buffer_load_dwordx4 v10, s[56:59], s13 offen offset:0 lds
    buffer_load_dwordx4 v11, s[56:59], s13 offen offset:1024 lds
    buffer_load_dwordx4 v12, s[56:59], s13 offen offset:2048 lds
    buffer_load_dwordx4 v13, s[56:59], s13 offen offset:3072 lds
    s_add_u32 m0, s42, 139264
    s_xor_b32 s13, s101, 1
    s_and_b32 s13, s13, 7
    s_mul_i32 s13, s13, 163840
    s_add_u32 s13, s13, s12
    s_xor_b32 s14, s99, 0
    s_mul_i32 s14, s14, 81920
    s_add_u32 s13, s13, s14
    buffer_load_dwordx4 v14, s[60:63], s13 offen offset:0 lds
    buffer_load_dwordx4 v15, s[60:63], s13 offen offset:1024 lds
    buffer_load_dwordx4 v16, s[60:63], s13 offen offset:2048 lds
    buffer_load_dwordx4 v17, s[60:63], s13 offen offset:3072 lds
    s_add_u32 m0, m0, 4096
    s_nop 0
    buffer_load_dwordx4 v18, s[60:63], s13 offen offset:0 lds
    s_waitcnt vmcnt(18)
    s_barrier
    v_add_u32 v47, L_at_C0-concat_heads__mha_block_cached__gqa_block_cached__near_ridge_kernel, v46
    v_min_u32 v47, L_end-concat_heads__mha_block_cached__gqa_block_cached__near_ridge_kernel, v47
    global_load_dword v48, v47, s[38:39]
    s_add_u32 m0, s15, 49152
    s_xor_b32 s13, s101, 1
    s_and_b32 s13, s13, 7
    s_mul_i32 s13, s13, 8192
    s_add_u32 s13, s13, s11
    s_xor_b32 s14, s99, 1
    s_mul_i32 s14, s14, 128
    s_add_u32 s13, s13, s14
    buffer_load_dwordx4 v10, s[56:59], s13 offen offset:0 lds
    buffer_load_dwordx4 v11, s[56:59], s13 offen offset:1024 lds
    buffer_load_dwordx4 v12, s[56:59], s13 offen offset:2048 lds
    buffer_load_dwordx4 v13, s[56:59], s13 offen offset:3072 lds
    s_add_u32 m0, s42, 77824
    s_xor_b32 s13, s101, 1
    s_and_b32 s13, s13, 7
    s_mul_i32 s13, s13, 163840
    s_add_u32 s13, s13, s12
    s_xor_b32 s14, s99, 1
    s_mul_i32 s14, s14, 81920
    s_add_u32 s13, s13, s14
    buffer_load_dwordx4 v14, s[60:63], s13 offen offset:0 lds
    buffer_load_dwordx4 v15, s[60:63], s13 offen offset:1024 lds
    buffer_load_dwordx4 v16, s[60:63], s13 offen offset:2048 lds
    buffer_load_dwordx4 v17, s[60:63], s13 offen offset:3072 lds
    s_add_u32 m0, m0, 4096
    s_nop 0
    buffer_load_dwordx4 v18, s[60:63], s13 offen offset:0 lds
    s_waitcnt vmcnt(18)
    s_barrier
    s_waitcnt vmcnt(9)
    s_barrier
    s_add_u32 m0, s15, 0
    s_xor_b32 s13, s101, 2
    s_and_b32 s13, s13, 7
    s_mul_i32 s13, s13, 8192
    s_add_u32 s13, s13, s11
    s_xor_b32 s14, s99, 0
    s_mul_i32 s14, s14, 128
    s_add_u32 s13, s13, s14
    buffer_load_dwordx4 v10, s[56:59], s13 offen offset:0 lds
    buffer_load_dwordx4 v11, s[56:59], s13 offen offset:1024 lds
    buffer_load_dwordx4 v12, s[56:59], s13 offen offset:2048 lds
    buffer_load_dwordx4 v13, s[56:59], s13 offen offset:3072 lds
    s_add_u32 m0, s42, 98304
    s_xor_b32 s13, s101, 2
    s_and_b32 s13, s13, 7
    s_mul_i32 s13, s13, 163840
    s_add_u32 s13, s13, s12
    s_xor_b32 s14, s99, 0
    s_mul_i32 s14, s14, 81920
    s_add_u32 s13, s13, s14
    buffer_load_dwordx4 v14, s[60:63], s13 offen offset:0 lds
    buffer_load_dwordx4 v15, s[60:63], s13 offen offset:1024 lds
    buffer_load_dwordx4 v16, s[60:63], s13 offen offset:2048 lds
    buffer_load_dwordx4 v17, s[60:63], s13 offen offset:3072 lds
    s_add_u32 m0, m0, 4096
    s_nop 0
    buffer_load_dwordx4 v18, s[60:63], s13 offen offset:0 lds
    s_waitcnt vmcnt(9)
    s_barrier
    s_add_u32 m0, s15, 16384
    s_xor_b32 s13, s101, 2
    s_and_b32 s13, s13, 7
    s_mul_i32 s13, s13, 8192
    s_add_u32 s13, s13, s11
    s_xor_b32 s14, s99, 1
    s_mul_i32 s14, s14, 128
    s_add_u32 s13, s13, s14
    buffer_load_dwordx4 v10, s[56:59], s13 offen offset:0 lds
    buffer_load_dwordx4 v11, s[56:59], s13 offen offset:1024 lds
    buffer_load_dwordx4 v12, s[56:59], s13 offen offset:2048 lds
    buffer_load_dwordx4 v13, s[56:59], s13 offen offset:3072 lds
    s_add_u32 m0, s42, 118784
    s_xor_b32 s13, s101, 2
    s_and_b32 s13, s13, 7
    s_mul_i32 s13, s13, 163840
    s_add_u32 s13, s13, s12
    s_xor_b32 s14, s99, 1
    s_mul_i32 s14, s14, 81920
    s_add_u32 s13, s13, s14
    buffer_load_dwordx4 v14, s[60:63], s13 offen offset:0 lds
    buffer_load_dwordx4 v15, s[60:63], s13 offen offset:1024 lds
    buffer_load_dwordx4 v16, s[60:63], s13 offen offset:2048 lds
    buffer_load_dwordx4 v17, s[60:63], s13 offen offset:3072 lds
    s_add_u32 m0, m0, 4096
    s_nop 0
    buffer_load_dwordx4 v18, s[60:63], s13 offen offset:0 lds
    s_waitcnt vmcnt(9)
    s_barrier
    s_add_u32 m0, s15, 32768
    s_xor_b32 s13, s101, 3
    s_and_b32 s13, s13, 7
    s_mul_i32 s13, s13, 8192
    s_add_u32 s13, s13, s11
    s_xor_b32 s14, s99, 0
    s_mul_i32 s14, s14, 128
    s_add_u32 s13, s13, s14
    buffer_load_dwordx4 v10, s[56:59], s13 offen offset:0 lds
    buffer_load_dwordx4 v11, s[56:59], s13 offen offset:1024 lds
    buffer_load_dwordx4 v12, s[56:59], s13 offen offset:2048 lds
    buffer_load_dwordx4 v13, s[56:59], s13 offen offset:3072 lds
    s_add_u32 m0, s42, 139264
    s_xor_b32 s13, s101, 3
    s_and_b32 s13, s13, 7
    s_mul_i32 s13, s13, 163840
    s_add_u32 s13, s13, s12
    s_xor_b32 s14, s99, 0
    s_mul_i32 s14, s14, 81920
    s_add_u32 s13, s13, s14
    buffer_load_dwordx4 v14, s[60:63], s13 offen offset:0 lds
    buffer_load_dwordx4 v15, s[60:63], s13 offen offset:1024 lds
    buffer_load_dwordx4 v16, s[60:63], s13 offen offset:2048 lds
    buffer_load_dwordx4 v17, s[60:63], s13 offen offset:3072 lds
    s_add_u32 m0, m0, 4096
    s_nop 0
    buffer_load_dwordx4 v18, s[60:63], s13 offen offset:0 lds
    s_waitcnt vmcnt(9)
    s_barrier
    buffer_load_dword v23, v21, s[64:67], 0 offen sc1
    s_add_u32 m0, s15, 49152
    s_xor_b32 s13, s101, 3
    s_and_b32 s13, s13, 7
    s_mul_i32 s13, s13, 8192
    s_add_u32 s13, s13, s11
    s_xor_b32 s14, s99, 1
    s_mul_i32 s14, s14, 128
    s_add_u32 s13, s13, s14
    buffer_load_dwordx4 v10, s[56:59], s13 offen offset:0 lds
    buffer_load_dwordx4 v11, s[56:59], s13 offen offset:1024 lds
    buffer_load_dwordx4 v12, s[56:59], s13 offen offset:2048 lds
    buffer_load_dwordx4 v13, s[56:59], s13 offen offset:3072 lds
    s_add_u32 m0, s42, 77824
    s_xor_b32 s13, s101, 3
    s_and_b32 s13, s13, 7
    s_mul_i32 s13, s13, 163840
    s_add_u32 s13, s13, s12
    s_xor_b32 s14, s99, 1
    s_mul_i32 s14, s14, 81920
    s_add_u32 s13, s13, s14
    buffer_load_dwordx4 v14, s[60:63], s13 offen offset:0 lds
    buffer_load_dwordx4 v15, s[60:63], s13 offen offset:1024 lds
    buffer_load_dwordx4 v16, s[60:63], s13 offen offset:2048 lds
    buffer_load_dwordx4 v17, s[60:63], s13 offen offset:3072 lds
    s_add_u32 m0, m0, 4096
    s_nop 0
    buffer_load_dwordx4 v18, s[60:63], s13 offen offset:0 lds
    s_waitcnt vmcnt(10)
    s_waitcnt vmcnt(9)
    v_cmp_ne_u32 vcc, 0, v23
    s_nop 0
    s_cmp_eq_u64 vcc, exec
    s_cbranch_scc0 L_cp_s
L_cp_d:
    s_barrier
    v_add_u32 v47, L_at_C5-concat_heads__mha_block_cached__gqa_block_cached__near_ridge_kernel, v46
    v_min_u32 v47, L_end-concat_heads__mha_block_cached__gqa_block_cached__near_ridge_kernel, v47
    global_load_dword v48, v47, s[38:39]
    s_add_u32 m0, s15, 0
    s_xor_b32 s13, s101, 4
    s_and_b32 s13, s13, 7
    s_mul_i32 s13, s13, 8192
    s_add_u32 s13, s13, s11
    s_xor_b32 s14, s99, 0
    s_mul_i32 s14, s14, 128
    s_add_u32 s13, s13, s14
    buffer_load_dwordx4 v10, s[56:59], s13 offen offset:0 lds
    buffer_load_dwordx4 v11, s[56:59], s13 offen offset:1024 lds
    buffer_load_dwordx4 v12, s[56:59], s13 offen offset:2048 lds
    buffer_load_dwordx4 v13, s[56:59], s13 offen offset:3072 lds
    s_add_u32 m0, s42, 98304
    s_xor_b32 s13, s101, 4
    s_and_b32 s13, s13, 7
    s_mul_i32 s13, s13, 163840
    s_add_u32 s13, s13, s12
    s_xor_b32 s14, s99, 0
    s_mul_i32 s14, s14, 81920
    s_add_u32 s13, s13, s14
    buffer_load_dwordx4 v14, s[60:63], s13 offen offset:0 lds
    buffer_load_dwordx4 v15, s[60:63], s13 offen offset:1024 lds
    buffer_load_dwordx4 v16, s[60:63], s13 offen offset:2048 lds
    buffer_load_dwordx4 v17, s[60:63], s13 offen offset:3072 lds
    s_add_u32 m0, m0, 4096
    s_nop 0
    buffer_load_dwordx4 v18, s[60:63], s13 offen offset:0 lds
    s_waitcnt vmcnt(9)
    s_barrier
    s_add_u32 m0, s15, 16384
    s_xor_b32 s13, s101, 4
    s_and_b32 s13, s13, 7
    s_mul_i32 s13, s13, 8192
    s_add_u32 s13, s13, s11
    s_xor_b32 s14, s99, 1
    s_mul_i32 s14, s14, 128
    s_add_u32 s13, s13, s14
    buffer_load_dwordx4 v10, s[56:59], s13 offen offset:0 lds
    buffer_load_dwordx4 v11, s[56:59], s13 offen offset:1024 lds
    buffer_load_dwordx4 v12, s[56:59], s13 offen offset:2048 lds
    buffer_load_dwordx4 v13, s[56:59], s13 offen offset:3072 lds
    s_add_u32 m0, s42, 118784
    s_xor_b32 s13, s101, 4
    s_and_b32 s13, s13, 7
    s_mul_i32 s13, s13, 163840
    s_add_u32 s13, s13, s12
    s_xor_b32 s14, s99, 1
    s_mul_i32 s14, s14, 81920
    s_add_u32 s13, s13, s14
    buffer_load_dwordx4 v14, s[60:63], s13 offen offset:0 lds
    buffer_load_dwordx4 v15, s[60:63], s13 offen offset:1024 lds
    buffer_load_dwordx4 v16, s[60:63], s13 offen offset:2048 lds
    buffer_load_dwordx4 v17, s[60:63], s13 offen offset:3072 lds
    s_add_u32 m0, m0, 4096
    s_nop 0
    buffer_load_dwordx4 v18, s[60:63], s13 offen offset:0 lds
    s_waitcnt vmcnt(9)
    s_barrier
    s_add_u32 m0, s15, 32768
    s_xor_b32 s13, s101, 5
    s_and_b32 s13, s13, 7
    s_mul_i32 s13, s13, 8192
    s_add_u32 s13, s13, s11
    s_xor_b32 s14, s99, 0
    s_mul_i32 s14, s14, 128
    s_add_u32 s13, s13, s14
    buffer_load_dwordx4 v10, s[56:59], s13 offen offset:0 lds
    buffer_load_dwordx4 v11, s[56:59], s13 offen offset:1024 lds
    buffer_load_dwordx4 v12, s[56:59], s13 offen offset:2048 lds
    buffer_load_dwordx4 v13, s[56:59], s13 offen offset:3072 lds
    s_add_u32 m0, s42, 139264
    s_xor_b32 s13, s101, 5
    s_and_b32 s13, s13, 7
    s_mul_i32 s13, s13, 163840
    s_add_u32 s13, s13, s12
    s_xor_b32 s14, s99, 0
    s_mul_i32 s14, s14, 81920
    s_add_u32 s13, s13, s14
    buffer_load_dwordx4 v14, s[60:63], s13 offen offset:0 lds
    buffer_load_dwordx4 v15, s[60:63], s13 offen offset:1024 lds
    buffer_load_dwordx4 v16, s[60:63], s13 offen offset:2048 lds
    buffer_load_dwordx4 v17, s[60:63], s13 offen offset:3072 lds
    s_add_u32 m0, m0, 4096
    s_nop 0
    buffer_load_dwordx4 v18, s[60:63], s13 offen offset:0 lds
    s_waitcnt vmcnt(9)
    s_barrier
    s_add_u32 m0, s15, 49152
    s_xor_b32 s13, s101, 5
    s_and_b32 s13, s13, 7
    s_mul_i32 s13, s13, 8192
    s_add_u32 s13, s13, s11
    s_xor_b32 s14, s99, 1
    s_mul_i32 s14, s14, 128
    s_add_u32 s13, s13, s14
    buffer_load_dwordx4 v10, s[56:59], s13 offen offset:0 lds
    buffer_load_dwordx4 v11, s[56:59], s13 offen offset:1024 lds
    buffer_load_dwordx4 v12, s[56:59], s13 offen offset:2048 lds
    buffer_load_dwordx4 v13, s[56:59], s13 offen offset:3072 lds
    s_add_u32 m0, s42, 77824
    s_xor_b32 s13, s101, 5
    s_and_b32 s13, s13, 7
    s_mul_i32 s13, s13, 163840
    s_add_u32 s13, s13, s12
    s_xor_b32 s14, s99, 1
    s_mul_i32 s14, s14, 81920
    s_add_u32 s13, s13, s14
    buffer_load_dwordx4 v14, s[60:63], s13 offen offset:0 lds
    buffer_load_dwordx4 v15, s[60:63], s13 offen offset:1024 lds
    buffer_load_dwordx4 v16, s[60:63], s13 offen offset:2048 lds
    buffer_load_dwordx4 v17, s[60:63], s13 offen offset:3072 lds
    s_add_u32 m0, m0, 4096
    s_nop 0
    buffer_load_dwordx4 v18, s[60:63], s13 offen offset:0 lds
    s_waitcnt vmcnt(9)
    s_barrier
    s_add_u32 m0, s15, 0
    s_xor_b32 s13, s101, 6
    s_and_b32 s13, s13, 7
    s_mul_i32 s13, s13, 8192
    s_add_u32 s13, s13, s11
    s_xor_b32 s14, s99, 0
    s_mul_i32 s14, s14, 128
    s_add_u32 s13, s13, s14
    buffer_load_dwordx4 v10, s[56:59], s13 offen offset:0 lds
    buffer_load_dwordx4 v11, s[56:59], s13 offen offset:1024 lds
    buffer_load_dwordx4 v12, s[56:59], s13 offen offset:2048 lds
    buffer_load_dwordx4 v13, s[56:59], s13 offen offset:3072 lds
    s_add_u32 m0, s42, 98304
    s_xor_b32 s13, s101, 6
    s_and_b32 s13, s13, 7
    s_mul_i32 s13, s13, 163840
    s_add_u32 s13, s13, s12
    s_xor_b32 s14, s99, 0
    s_mul_i32 s14, s14, 81920
    s_add_u32 s13, s13, s14
    buffer_load_dwordx4 v14, s[60:63], s13 offen offset:0 lds
    buffer_load_dwordx4 v15, s[60:63], s13 offen offset:1024 lds
    buffer_load_dwordx4 v16, s[60:63], s13 offen offset:2048 lds
    buffer_load_dwordx4 v17, s[60:63], s13 offen offset:3072 lds
    s_add_u32 m0, m0, 4096
    s_nop 0
    buffer_load_dwordx4 v18, s[60:63], s13 offen offset:0 lds
    s_lshl_b32 s33, s8, 11
    s_add_u32 s34, s33, 155648
    s_add_u32 s33, s33, 65536
    s_cmp_lt_u32 s8, 2
    s_cbranch_scc0 L_plb_loader
    s_add_u32 s34, s33, 8192
L_plb_loader:
    s_xor_b32 s32, s101, 6
    s_and_b32 s32, s32, 7
    s_mul_i32 s32, s32, 2048
    s_add_u32 s32, s32, s27
    s_mov_b32 m0, s33
    s_nop 0
    buffer_load_dwordx4 v24, s[64:67], s32 offen offset:0 sc1 lds
    buffer_load_dwordx4 v24, s[64:67], s32 offen offset:1024 sc1 lds
    s_waitcnt vmcnt(11)
    s_barrier
    v_add_u32 v47, L_at_C10-concat_heads__mha_block_cached__gqa_block_cached__near_ridge_kernel, v46
    v_min_u32 v47, L_end-concat_heads__mha_block_cached__gqa_block_cached__near_ridge_kernel, v47
    global_load_dword v48, v47, s[38:39]
    s_add_u32 m0, s15, 16384
    s_xor_b32 s13, s101, 6
    s_and_b32 s13, s13, 7
    s_mul_i32 s13, s13, 8192
    s_add_u32 s13, s13, s11
    s_xor_b32 s14, s99, 1
    s_mul_i32 s14, s14, 128
    s_add_u32 s13, s13, s14
    buffer_load_dwordx4 v10, s[56:59], s13 offen offset:0 lds
    buffer_load_dwordx4 v11, s[56:59], s13 offen offset:1024 lds
    buffer_load_dwordx4 v12, s[56:59], s13 offen offset:2048 lds
    buffer_load_dwordx4 v13, s[56:59], s13 offen offset:3072 lds
    s_add_u32 m0, s42, 118784
    s_xor_b32 s13, s101, 6
    s_and_b32 s13, s13, 7
    s_mul_i32 s13, s13, 163840
    s_add_u32 s13, s13, s12
    s_xor_b32 s14, s99, 1
    s_mul_i32 s14, s14, 81920
    s_add_u32 s13, s13, s14
    buffer_load_dwordx4 v14, s[60:63], s13 offen offset:0 lds
    buffer_load_dwordx4 v15, s[60:63], s13 offen offset:1024 lds
    buffer_load_dwordx4 v16, s[60:63], s13 offen offset:2048 lds
    buffer_load_dwordx4 v17, s[60:63], s13 offen offset:3072 lds
    s_add_u32 m0, m0, 4096
    s_nop 0
    buffer_load_dwordx4 v18, s[60:63], s13 offen offset:0 lds
    s_waitcnt vmcnt(11)
    s_barrier
    s_add_u32 m0, s15, 32768
    s_xor_b32 s13, s101, 7
    s_and_b32 s13, s13, 7
    s_mul_i32 s13, s13, 8192
    s_add_u32 s13, s13, s11
    s_xor_b32 s14, s99, 0
    s_mul_i32 s14, s14, 128
    s_add_u32 s13, s13, s14
    buffer_load_dwordx4 v10, s[56:59], s13 offen offset:0 lds
    buffer_load_dwordx4 v11, s[56:59], s13 offen offset:1024 lds
    buffer_load_dwordx4 v12, s[56:59], s13 offen offset:2048 lds
    buffer_load_dwordx4 v13, s[56:59], s13 offen offset:3072 lds
    s_add_u32 m0, s42, 139264
    s_xor_b32 s13, s101, 7
    s_and_b32 s13, s13, 7
    s_mul_i32 s13, s13, 163840
    s_add_u32 s13, s13, s12
    s_xor_b32 s14, s99, 0
    s_mul_i32 s14, s14, 81920
    s_add_u32 s13, s13, s14
    buffer_load_dwordx4 v14, s[60:63], s13 offen offset:0 lds
    buffer_load_dwordx4 v15, s[60:63], s13 offen offset:1024 lds
    buffer_load_dwordx4 v16, s[60:63], s13 offen offset:2048 lds
    buffer_load_dwordx4 v17, s[60:63], s13 offen offset:3072 lds
    s_add_u32 m0, m0, 4096
    s_nop 0
    buffer_load_dwordx4 v18, s[60:63], s13 offen offset:0 lds
    s_xor_b32 s32, s101, 7
    s_and_b32 s32, s32, 7
    s_mul_i32 s32, s32, 2048
    s_add_u32 s32, s32, s27
    s_mov_b32 m0, s34
    s_nop 0
    buffer_load_dwordx4 v24, s[64:67], s32 offen offset:0 sc1 lds
    buffer_load_dwordx4 v24, s[64:67], s32 offen offset:1024 sc1 lds
    s_waitcnt vmcnt(2)
    s_barrier
    s_add_u32 m0, s15, 49152
    s_xor_b32 s13, s101, 7
    s_and_b32 s13, s13, 7
    s_mul_i32 s13, s13, 8192
    s_add_u32 s13, s13, s11
    s_xor_b32 s14, s99, 1
    s_mul_i32 s14, s14, 128
    s_add_u32 s13, s13, s14
    buffer_load_dwordx4 v10, s[56:59], s13 offen offset:0 lds
    buffer_load_dwordx4 v11, s[56:59], s13 offen offset:1024 lds
    buffer_load_dwordx4 v12, s[56:59], s13 offen offset:2048 lds
    buffer_load_dwordx4 v13, s[56:59], s13 offen offset:3072 lds
    s_add_u32 m0, s42, 77824
    s_xor_b32 s13, s101, 7
    s_and_b32 s13, s13, 7
    s_mul_i32 s13, s13, 163840
    s_add_u32 s13, s13, s12
    s_xor_b32 s14, s99, 1
    s_mul_i32 s14, s14, 81920
    s_add_u32 s13, s13, s14
    buffer_load_dwordx4 v14, s[60:63], s13 offen offset:0 lds
    buffer_load_dwordx4 v15, s[60:63], s13 offen offset:1024 lds
    buffer_load_dwordx4 v16, s[60:63], s13 offen offset:2048 lds
    buffer_load_dwordx4 v17, s[60:63], s13 offen offset:3072 lds
    s_add_u32 m0, m0, 4096
    s_nop 0
    buffer_load_dwordx4 v18, s[60:63], s13 offen offset:0 lds
    buffer_store_dwordx4 v[28:31], v24, s[64:67], s31 offen offset:0 sc1
    buffer_store_dwordx4 v[28:31], v24, s[64:67], s31 offen offset:1024 sc1
    buffer_store_dwordx4 v[28:31], v24, s[64:67], s31 offen offset:2048 sc1
    buffer_store_dwordx4 v[28:31], v24, s[64:67], s31 offen offset:3072 sc1
    s_add_u32 s31, s31, 4096
    buffer_store_dwordx4 v[28:31], v24, s[64:67], s31 offen offset:0 sc1
    buffer_store_dwordx4 v[28:31], v24, s[64:67], s31 offen offset:1024 sc1
    s_waitcnt vmcnt(6)
    s_barrier
    v_mov_b32 v32, 0
    v_mov_b32 v34, 0
    v_mov_b32 v35, 0
    ds_write_b64 v32, v[34:35]
    buffer_store_dwordx4 v[28:31], v24, s[64:67], s31 offen offset:2048 sc1
    buffer_store_dwordx4 v[28:31], v24, s[64:67], s31 offen offset:3072 sc1
    s_add_u32 s31, s31, 4096
    buffer_store_dwordx4 v[28:31], v24, s[64:67], s31 offen offset:0 sc1
    buffer_store_dwordx4 v[28:31], v24, s[64:67], s31 offen offset:1024 sc1
    s_waitcnt vmcnt(4)
    s_waitcnt lgkmcnt(0)
    s_barrier
    s_waitcnt vmcnt(0)
    buffer_store_dword v25, off, s[64:67], s29 offset:16 sc1
    s_barrier
    s_mov_b64 vcc, 0
    buffer_load_dword v23, v22, s[64:67], 0 offen sc1
    s_waitcnt vmcnt(0)
    v_cmp_ne_u32 vcc, 0, v23
    s_nop 0
    s_cmp_eq_u64 vcc, exec
    s_cbranch_scc0 L_ce_s
L_ce_d:
    v_mov_b32 v5, 0
    ds_write_b32 v5, v25 offset:4
    v_and_b32 v3, 15, v255
    v_mul_u32_u24 v3, 2560, v3
    v_bfe_u32 v4, v255, 4, 1
    v_lshl_add_u32 v3, v4, 5, v3
    v_lshrrev_b32 v4, 5, v255
    v_lshl_add_u32 v3, v4, 4, v3
    s_mov_b32 s21, 0xffff0000
    s_lshl_b32 s20, s6, 2
    s_add_u32 s20, s20, s5
    s_mul_i32 s20, s20, 81920
    s_mul_i32 s13, s4, 1280
    s_add_u32 s20, s20, s13
    s_mul_i32 s13, s7, 320
    s_add_u32 s20, s20, s13
    s_mul_i32 s22, s2, 40960
    s_add_u32 s22, s22, 8388608
    s_add_u32 s23, s5, 1
    s_and_b32 s23, s23, 3
    s_mul_i32 s23, s23, 10240
    s_add_u32 s23, s23, s22
    s_add_u32 s24, s5, 2
    s_and_b32 s24, s24, 3
    s_mul_i32 s24, s24, 10240
    s_add_u32 s24, s24, s22
    s_add_u32 s25, s5, 3
    s_and_b32 s25, s25, 3
    s_mul_i32 s25, s25, 10240
    s_add_u32 s25, s25, s22
    s_lshl_b32 s18, s8, 12
    s_add_u32 s18, s18, 98304
    v_add_u32 v6, s18, v24
    s_lshl_b32 s18, s8, 11
    v_add_u32 v7, s18, v24
    s_add_u32 s16, s8, 2
    s_min_u32 s16, s16, 5
    s_mov_b32 s13, 8388608
L_lp:
    ds_read_b32 v9, v5 offset:0
    s_waitcnt lgkmcnt(0)
    v_readfirstlane_b32 s19, v9
    s_sub_u32 s13, s13, 1
    s_cbranch_scc1 L_lp_d
    s_cmp_ge_u32 s19, s16
    s_cbranch_scc0 L_lp
L_lp_d:
    ds_read_b128 v[64:67], v6 offset:0
    ds_read_b128 v[68:71], v6 offset:1024
    ds_read_b128 v[72:75], v6 offset:2048
    ds_read_b128 v[76:79], v6 offset:3072
    s_mov_b32 s13, 524288
L_fp:
    buffer_load_dwordx4 v[40:43], v7, s[64:67], s23 offen offset:0 sc1
    buffer_load_dwordx4 v[44:47], v7, s[64:67], s23 offen offset:1024 sc1
    buffer_load_dwordx4 v[48:51], v7, s[64:67], s24 offen offset:0 sc1
    buffer_load_dwordx4 v[52:55], v7, s[64:67], s24 offen offset:1024 sc1
    buffer_load_dwordx4 v[56:59], v7, s[64:67], s25 offen offset:0 sc1
    buffer_load_dwordx4 v[60:63], v7, s[64:67], s25 offen offset:1024 sc1
    s_waitcnt vmcnt(0)
    v_max3_u32 v9, v40, v41, v42
    v_max3_u32 v9, v9, v43, v44
    v_max3_u32 v9, v9, v45, v46
    v_max3_u32 v9, v9, v47, v48
    v_max3_u32 v9, v9, v49, v50
    v_max3_u32 v9, v9, v51, v52
    v_max3_u32 v9, v9, v53, v54
    v_max3_u32 v9, v9, v55, v56
    v_max3_u32 v9, v9, v57, v58
    v_max3_u32 v9, v9, v59, v60
    v_max3_u32 v9, v9, v61, v62
    v_max_u32 v9, v9, v63
    v_cmp_eq_u32 vcc, -1, v9
    s_sub_u32 s13, s13, 1
    s_cbranch_scc1 L_fp_d
    s_cbranch_vccnz L_fp
L_fp_d:
    s_lshl_b32 s18, s8, 6
    s_add_u32 s18, s18, s20
    s_add_u32 s19, s18, 40960
    s_waitcnt lgkmcnt(0)
    v_lshlrev_b32 v10, 16, v40
    v_and_b32 v11, s21, v40
    v_add_f32 v64, v64, v10
    v_add_f32 v65, v65, v11
    v_lshlrev_b32 v10, 16, v41
    v_and_b32 v11, s21, v41
    v_add_f32 v66, v66, v10
    v_add_f32 v67, v67, v11
    v_lshlrev_b32 v10, 16, v42
    v_and_b32 v11, s21, v42
    v_add_f32 v68, v68, v10
    v_add_f32 v69, v69, v11
    v_lshlrev_b32 v10, 16, v43
    v_and_b32 v11, s21, v43
    v_add_f32 v70, v70, v10
    v_add_f32 v71, v71, v11
    v_lshlrev_b32 v10, 16, v44
    v_and_b32 v11, s21, v44
    v_add_f32 v72, v72, v10
    v_add_f32 v73, v73, v11
    v_lshlrev_b32 v10, 16, v45
    v_and_b32 v11, s21, v45
    v_add_f32 v74, v74, v10
    v_add_f32 v75, v75, v11
    v_lshlrev_b32 v10, 16, v46
    v_and_b32 v11, s21, v46
    v_add_f32 v76, v76, v10
    v_add_f32 v77, v77, v11
    v_lshlrev_b32 v10, 16, v47
    v_and_b32 v11, s21, v47
    v_add_f32 v78, v78, v10
    v_add_f32 v79, v79, v11
    v_lshlrev_b32 v10, 16, v48
    v_and_b32 v11, s21, v48
    v_add_f32 v64, v64, v10
    v_add_f32 v65, v65, v11
    v_lshlrev_b32 v10, 16, v49
    v_and_b32 v11, s21, v49
    v_add_f32 v66, v66, v10
    v_add_f32 v67, v67, v11
    v_lshlrev_b32 v10, 16, v50
    v_and_b32 v11, s21, v50
    v_add_f32 v68, v68, v10
    v_add_f32 v69, v69, v11
    v_lshlrev_b32 v10, 16, v51
    v_and_b32 v11, s21, v51
    v_add_f32 v70, v70, v10
    v_add_f32 v71, v71, v11
    v_lshlrev_b32 v10, 16, v52
    v_and_b32 v11, s21, v52
    v_add_f32 v72, v72, v10
    v_add_f32 v73, v73, v11
    v_lshlrev_b32 v10, 16, v53
    v_and_b32 v11, s21, v53
    v_add_f32 v74, v74, v10
    v_add_f32 v75, v75, v11
    v_lshlrev_b32 v10, 16, v54
    v_and_b32 v11, s21, v54
    v_add_f32 v76, v76, v10
    v_add_f32 v77, v77, v11
    v_lshlrev_b32 v10, 16, v55
    v_and_b32 v11, s21, v55
    v_add_f32 v78, v78, v10
    v_add_f32 v79, v79, v11
    v_lshlrev_b32 v10, 16, v56
    v_and_b32 v11, s21, v56
    v_add_f32 v64, v64, v10
    v_add_f32 v65, v65, v11
    v_lshlrev_b32 v10, 16, v57
    v_and_b32 v11, s21, v57
    v_add_f32 v66, v66, v10
    v_add_f32 v67, v67, v11
    v_lshlrev_b32 v10, 16, v58
    v_and_b32 v11, s21, v58
    v_add_f32 v68, v68, v10
    v_add_f32 v69, v69, v11
    v_lshlrev_b32 v10, 16, v59
    v_and_b32 v11, s21, v59
    v_add_f32 v70, v70, v10
    v_add_f32 v71, v71, v11
    v_lshlrev_b32 v10, 16, v60
    v_and_b32 v11, s21, v60
    v_add_f32 v72, v72, v10
    v_add_f32 v73, v73, v11
    v_lshlrev_b32 v10, 16, v61
    v_and_b32 v11, s21, v61
    v_add_f32 v74, v74, v10
    v_add_f32 v75, v75, v11
    v_lshlrev_b32 v10, 16, v62
    v_and_b32 v11, s21, v62
    v_add_f32 v76, v76, v10
    v_add_f32 v77, v77, v11
    v_lshlrev_b32 v10, 16, v63
    v_and_b32 v11, s21, v63
    v_add_f32 v78, v78, v10
    v_add_f32 v79, v79, v11
    v_cvt_pk_bf16_f32 v80, v64, v65
    v_cvt_pk_bf16_f32 v81, v66, v67
    v_cvt_pk_bf16_f32 v82, v72, v73
    v_cvt_pk_bf16_f32 v83, v74, v75
    v_cvt_pk_bf16_f32 v84, v68, v69
    v_cvt_pk_bf16_f32 v85, v70, v71
    v_cvt_pk_bf16_f32 v86, v76, v77
    v_cvt_pk_bf16_f32 v87, v78, v79
    v_permlane16_swap_b32 v80, v82
    v_permlane16_swap_b32 v81, v83
    v_permlane16_swap_b32 v84, v86
    v_permlane16_swap_b32 v85, v87
    buffer_store_dwordx4 v[80:83], v3, s[68:71], s18 offen
    buffer_store_dwordx4 v[84:87], v3, s[68:71], s19 offen
    s_endpgm
L_compute:
    s_cmp_eq_u32 s3, 1
    s_cbranch_scc0 L_nopf
    s_getpc_b64 s[8:9]
L_pc:
    s_sub_u32 s8, s8, L_pc-concat_heads__mha_block_cached__gqa_block_cached__near_ridge_kernel
    s_subb_u32 s9, s9, 0
    s_lshr_b32 s10, s2, 3
    s_lshl_b32 s10, s10, 11
    v_lshlrev_b32 v1, 7, v255
    v_add_u32 v1, s10, v1
    v_min_u32 v1, L_end-concat_heads__mha_block_cached__gqa_block_cached__near_ridge_kernel, v1
    s_mov_b64 exec, 0xffff
    global_load_dword v128, v1, s[8:9]
    s_mov_b64 exec, -1
L_nopf:
    s_cmp_eq_u32 s4, 0
    s_waitcnt lgkmcnt(0)
    s_cselect_b64 s[44:45], s[16:17], s[26:27]
    s_cselect_b64 s[48:49], s[22:23], s[32:33]
    s_cselect_b64 s[52:53], s[18:19], s[28:29]
    s_cselect_b64 s[56:57], s[20:21], s[30:31]
    s_cselect_b64 s[60:61], s[24:25], s[34:35]
    s_mov_b64 s[64:65], s[40:41]
    s_mov_b64 s[68:69], s[36:37]
    s_mov_b64 s[72:73], s[38:39]
    s_lshl_b32 s17, s4, 5
    s_lshl_b32 s14, s6, 2
    s_add_u32 s17, s17, s14
    s_add_u32 s17, s17, s3
    s_lshl_b32 s17, s17, 5
    s_lshl_b32 s14, s5, 3
    s_add_u32 s17, s17, s14
    s_lshl_b32 s17, s17, 11
    s_lshl_b32 s10, s7, 12
    s_add_u32 s10, s10, s17
    s_and_b32 s16, s3, 1
    s_mul_i32 s14, s16, 4294903808
    s_add_u32 s10, s10, s14
    s_add_u32 s11, s10, 65536
    s_lshl_b32 s9, s16, 8
    s_add_u32 s9, s9, 65536
    s_sub_u32 s12, s2, s5
    s_add_u32 s12, s12, s3
    s_lshl_b32 s12, s12, 2
    s_add_u32 s12, s12, s5
    s_mul_i32 s12, s12, 10240
    s_add_u32 s12, s12, 8388608
    s_cmp_eq_u32 s3, s5
    s_cselect_b32 s12, 0x20000000, s12
    s_cselect_b32 s13, 1, 0
    s_mov_b32 s8, 0x3e0293ee
    s_cmp_eq_u32 s7, 0
    s_cselect_b32 s15, 1, 0
    s_cbranch_scc0 L_noclr
    v_lshlrev_b32 v1, 4, v255
    v_mov_b32 v4, -1
    v_mov_b32 v5, -1
    v_mov_b32 v6, -1
    v_mov_b32 v7, -1
    v_mov_b32 v8, 0
    v_lshlrev_b32 v2, 2, v255
    s_lshl_b32 s16, s3, 3
    s_add_u32 s16, s16, s2
    s_lshl_b32 s16, s16, 7
    s_add_u32 s16, s16, 33554432
    s_mov_b64 exec, 0xffff
    buffer_store_dword v8, v2, s[64:67], s16 offen sc1
    s_mov_b64 exec, -1
    buffer_store_dwordx4 v[4:7], v1, s[64:67], s10 offen sc1
    buffer_store_dwordx4 v[4:7], v1, s[64:67], s10 offen offset:1024 sc1
    buffer_store_dwordx4 v[4:7], v1, s[64:67], s11 offen sc1
    buffer_store_dwordx4 v[4:7], v1, s[64:67], s11 offen offset:1024 sc1
L_noclr:
    v_lshrrev_b32 v1, 4, v255
    v_bfe_u32 v2, v255, 2, 2
    v_and_b32 v3, 3, v255
    v_and_b32 v4, 15, v255
    v_and_b32 v5, 1, v1
    v_lshl_add_u32 v9, v1, 3, v2
    v_lshlrev_b32 v6, 9, v9
    v_lshl_add_u32 v6, v3, 3, v6
    v_add_u32 v6, s9, v6
    v_lshl_add_u32 v7, v5, 2, v2
    v_xor_b32 v8, 0, v7
    v_lshl_add_u32 v240, v8, 5, v6
    v_xor_b32 v8, 1, v7
    v_lshl_add_u32 v241, v8, 5, v6
    v_xor_b32 v8, 2, v7
    v_lshl_add_u32 v242, v8, 5, v6
    v_xor_b32 v8, 3, v7
    v_lshl_add_u32 v243, v8, 5, v6
    v_xor_b32 v8, 4, v7
    v_lshl_add_u32 v244, v8, 5, v6
    v_xor_b32 v8, 5, v7
    v_lshl_add_u32 v245, v8, 5, v6
    v_xor_b32 v8, 6, v7
    v_lshl_add_u32 v246, v8, 5, v6
    v_xor_b32 v8, 7, v7
    v_lshl_add_u32 v247, v8, 5, v6
    s_lshl_b32 s16, s3, 12
    v_lshrrev_b32 v6, 1, v4
    v_xor_b32 v7, v6, v1
    v_lshlrev_b32 v7, 4, v7
    v_lshl_add_u32 v7, v4, 7, v7
    s_andn2_b32 s9, s16, 4096
    v_add_u32 v248, s9, v7
    s_lshr_b32 s9, s6, 2
    s_mul_i32 s42, s9, 0
    v_xor_b32 v248, s42, v248
    v_xor_b32 v249, 64, v248
    v_lshrrev_b32 v7, 1, v1
    v_xor_b32 v7, v6, v7
    v_lshlrev_b32 v7, 4, v7
    v_lshl_add_u32 v7, v4, 7, v7
    v_lshl_add_u32 v7, v5, 3, v7
    v_add_u32 v160, s16, v7
    v_xor_b32 v161, 32, v160
    v_xor_b32 v162, 64, v160
    v_xor_b32 v163, 96, v160
    v_add_u32 v164, 65536, v160
    v_add_u32 v165, 65536, v161
    v_add_u32 v166, 65536, v162
    v_add_u32 v167, 65536, v163
    v_lshlrev_b32 v252, 4, v255
    v_mul_u32_u24 v6, 320, v9
    v_lshl_add_u32 v6, v3, 3, v6
    v_add_u32 v6, 77824, v6
    v_lshl_add_u32 v250, v5, 5, v6
    v_xor_b32 v5, 1, v5
    v_lshl_add_u32 v251, v5, 5, v6
    s_barrier
    v_add_u32 v240, 65536, v240
    v_add_u32 v241, 65536, v241
    v_add_u32 v242, 65536, v242
    v_add_u32 v243, 65536, v243
    v_add_u32 v244, 65536, v244
    v_add_u32 v245, 65536, v245
    v_add_u32 v246, 65536, v246
    v_add_u32 v247, 65536, v247
    ds_read_b64_tr_b16 v[192:193], v240 offset:0
    ds_read_b64_tr_b16 v[194:195], v240 offset:2048
    ds_read_b128 v[208:211], v248 offset:0
    ds_read_b128 v[212:215], v248 offset:2048
    ds_read_b128 v[216:219], v248 offset:4096
    ds_read_b128 v[220:223], v248 offset:6144
    ds_read_b64_tr_b16 v[196:197], v241 offset:0
    ds_read_b64_tr_b16 v[198:199], v241 offset:2048
    ds_read_b64_tr_b16 v[200:201], v242 offset:0
    ds_read_b64_tr_b16 v[202:203], v242 offset:2048
    s_waitcnt lgkmcnt(7)
    v_mfma_f32_16x16x32_bf16 v[0:3], v[192:195], v[208:211], 0
    ds_read_b64_tr_b16 v[204:205], v243 offset:0
    s_waitcnt lgkmcnt(7)
    v_mfma_f32_16x16x32_bf16 v[4:7], v[192:195], v[212:215], 0
    s_waitcnt lgkmcnt(6)
    v_mfma_f32_16x16x32_bf16 v[64:67], v[192:195], v[216:219], 0
    ds_read_b64_tr_b16 v[206:207], v243 offset:2048
    s_waitcnt lgkmcnt(6)
    v_mfma_f32_16x16x32_bf16 v[68:71], v[192:195], v[220:223], 0
    s_waitcnt lgkmcnt(4)
    v_mfma_f32_16x16x32_bf16 v[8:11], v[196:199], v[208:211], 0
    ds_read_b64_tr_b16 v[192:193], v244 offset:0
    v_mfma_f32_16x16x32_bf16 v[12:15], v[196:199], v[212:215], 0
    ds_read_b128 v[224:227], v249 offset:0
    v_mfma_f32_16x16x32_bf16 v[72:75], v[196:199], v[216:219], 0
    ds_read_b64_tr_b16 v[194:195], v244 offset:2048
    v_mfma_f32_16x16x32_bf16 v[76:79], v[196:199], v[220:223], 0
    s_waitcnt lgkmcnt(5)
    v_mfma_f32_16x16x32_bf16 v[16:19], v[200:203], v[208:211], 0
    ds_read_b64_tr_b16 v[196:197], v245 offset:0
    v_mfma_f32_16x16x32_bf16 v[20:23], v[200:203], v[212:215], 0
    ds_read_b128 v[228:231], v249 offset:2048
    v_mfma_f32_16x16x32_bf16 v[80:83], v[200:203], v[216:219], 0
    ds_read_b64_tr_b16 v[198:199], v245 offset:2048
    v_mfma_f32_16x16x32_bf16 v[84:87], v[200:203], v[220:223], 0
    s_waitcnt lgkmcnt(6)
    v_mfma_f32_16x16x32_bf16 v[24:27], v[204:207], v[208:211], 0
    ds_read_b64_tr_b16 v[200:201], v246 offset:0
    v_mfma_f32_16x16x32_bf16 v[28:31], v[204:207], v[212:215], 0
    ds_read_b128 v[232:235], v249 offset:4096
    v_mfma_f32_16x16x32_bf16 v[88:91], v[204:207], v[216:219], 0
    ds_read_b64_tr_b16 v[202:203], v246 offset:2048
    v_mfma_f32_16x16x32_bf16 v[92:95], v[204:207], v[220:223], 0
    s_waitcnt lgkmcnt(6)
    v_mfma_f32_16x16x32_bf16 v[32:35], v[192:195], v[208:211], 0
    ds_read_b64_tr_b16 v[204:205], v247 offset:0
    v_mfma_f32_16x16x32_bf16 v[36:39], v[192:195], v[212:215], 0
    ds_read_b128 v[236:239], v249 offset:6144
    v_mfma_f32_16x16x32_bf16 v[96:99], v[192:195], v[216:219], 0
    ds_read_b64_tr_b16 v[206:207], v247 offset:2048
    v_mfma_f32_16x16x32_bf16 v[100:103], v[192:195], v[220:223], 0
    s_barrier
    s_waitcnt lgkmcnt(6)
    v_mfma_f32_16x16x32_bf16 v[40:43], v[196:199], v[208:211], 0
    ds_read_b64_tr_b16 v[192:193], v240 offset:16384
    v_mfma_f32_16x16x32_bf16 v[44:47], v[196:199], v[212:215], 0
    v_mfma_f32_16x16x32_bf16 v[104:107], v[196:199], v[216:219], 0
    ds_read_b64_tr_b16 v[194:195], v240 offset:18432
    v_mfma_f32_16x16x32_bf16 v[108:111], v[196:199], v[220:223], 0
    s_waitcnt lgkmcnt(5)
    v_mfma_f32_16x16x32_bf16 v[48:51], v[200:203], v[208:211], 0
    ds_read_b64_tr_b16 v[196:197], v241 offset:16384
    v_mfma_f32_16x16x32_bf16 v[52:55], v[200:203], v[212:215], 0
    v_mfma_f32_16x16x32_bf16 v[112:115], v[200:203], v[216:219], 0
    ds_read_b64_tr_b16 v[198:199], v241 offset:18432
    v_mfma_f32_16x16x32_bf16 v[116:119], v[200:203], v[220:223], 0
    s_waitcnt lgkmcnt(4)
    v_mfma_f32_16x16x32_bf16 v[56:59], v[204:207], v[208:211], 0
    ds_read_b64_tr_b16 v[200:201], v242 offset:16384
    v_mfma_f32_16x16x32_bf16 v[60:63], v[204:207], v[212:215], 0
    v_mfma_f32_16x16x32_bf16 v[120:123], v[204:207], v[216:219], 0
    ds_read_b64_tr_b16 v[202:203], v242 offset:18432
    v_mfma_f32_16x16x32_bf16 v[124:127], v[204:207], v[220:223], 0
    s_barrier
    s_waitcnt lgkmcnt(4)
    v_mfma_f32_16x16x32_bf16 v[0:3], v[192:195], v[224:227], v[0:3]
    ds_read_b64_tr_b16 v[204:205], v243 offset:16384
    v_mfma_f32_16x16x32_bf16 v[4:7], v[192:195], v[228:231], v[4:7]
    v_mfma_f32_16x16x32_bf16 v[64:67], v[192:195], v[232:235], v[64:67]
    ds_read_b64_tr_b16 v[206:207], v243 offset:18432
    v_mfma_f32_16x16x32_bf16 v[68:71], v[192:195], v[236:239], v[68:71]
    s_waitcnt lgkmcnt(4)
    v_mfma_f32_16x16x32_bf16 v[8:11], v[196:199], v[224:227], v[8:11]
    ds_read_b64_tr_b16 v[192:193], v244 offset:16384
    v_mfma_f32_16x16x32_bf16 v[12:15], v[196:199], v[228:231], v[12:15]
    ds_read_b128 v[208:211], v248 offset:16384
    v_mfma_f32_16x16x32_bf16 v[72:75], v[196:199], v[232:235], v[72:75]
    ds_read_b64_tr_b16 v[194:195], v244 offset:18432
    v_mfma_f32_16x16x32_bf16 v[76:79], v[196:199], v[236:239], v[76:79]
    s_waitcnt lgkmcnt(5)
    v_mfma_f32_16x16x32_bf16 v[16:19], v[200:203], v[224:227], v[16:19]
    ds_read_b64_tr_b16 v[196:197], v245 offset:16384
    v_mfma_f32_16x16x32_bf16 v[20:23], v[200:203], v[228:231], v[20:23]
    ds_read_b128 v[212:215], v248 offset:18432
    v_mfma_f32_16x16x32_bf16 v[80:83], v[200:203], v[232:235], v[80:83]
    ds_read_b64_tr_b16 v[198:199], v245 offset:18432
    v_mfma_f32_16x16x32_bf16 v[84:87], v[200:203], v[236:239], v[84:87]
    s_waitcnt lgkmcnt(6)
    v_mfma_f32_16x16x32_bf16 v[24:27], v[204:207], v[224:227], v[24:27]
    ds_read_b64_tr_b16 v[200:201], v246 offset:16384
    v_mfma_f32_16x16x32_bf16 v[28:31], v[204:207], v[228:231], v[28:31]
    ds_read_b128 v[216:219], v248 offset:20480
    v_mfma_f32_16x16x32_bf16 v[88:91], v[204:207], v[232:235], v[88:91]
    ds_read_b64_tr_b16 v[202:203], v246 offset:18432
    v_mfma_f32_16x16x32_bf16 v[92:95], v[204:207], v[236:239], v[92:95]
    s_waitcnt lgkmcnt(6)
    v_mfma_f32_16x16x32_bf16 v[32:35], v[192:195], v[224:227], v[32:35]
    ds_read_b64_tr_b16 v[204:205], v247 offset:16384
    v_mfma_f32_16x16x32_bf16 v[36:39], v[192:195], v[228:231], v[36:39]
    ds_read_b128 v[220:223], v248 offset:22528
    v_mfma_f32_16x16x32_bf16 v[96:99], v[192:195], v[232:235], v[96:99]
    ds_read_b64_tr_b16 v[206:207], v247 offset:18432
    v_mfma_f32_16x16x32_bf16 v[100:103], v[192:195], v[236:239], v[100:103]
    s_waitcnt lgkmcnt(6)
    v_mfma_f32_16x16x32_bf16 v[40:43], v[196:199], v[224:227], v[40:43]
    v_add_u32 v240, 4294901760, v240
    v_add_u32 v241, 4294901760, v241
    v_add_u32 v242, 4294901760, v242
    v_add_u32 v243, 4294901760, v243
    v_add_u32 v244, 4294901760, v244
    v_add_u32 v245, 4294901760, v245
    v_add_u32 v246, 4294901760, v246
    v_add_u32 v247, 4294901760, v247
    ds_read_b64_tr_b16 v[192:193], v240 offset:0
    v_mfma_f32_16x16x32_bf16 v[44:47], v[196:199], v[228:231], v[44:47]
    v_mfma_f32_16x16x32_bf16 v[104:107], v[196:199], v[232:235], v[104:107]
    ds_read_b64_tr_b16 v[194:195], v240 offset:2048
    v_mfma_f32_16x16x32_bf16 v[108:111], v[196:199], v[236:239], v[108:111]
    s_waitcnt lgkmcnt(5)
    v_mfma_f32_16x16x32_bf16 v[48:51], v[200:203], v[224:227], v[48:51]
    ds_read_b64_tr_b16 v[196:197], v241 offset:0
    v_mfma_f32_16x16x32_bf16 v[52:55], v[200:203], v[228:231], v[52:55]
    v_mfma_f32_16x16x32_bf16 v[112:115], v[200:203], v[232:235], v[112:115]
    ds_read_b64_tr_b16 v[198:199], v241 offset:2048
    v_mfma_f32_16x16x32_bf16 v[116:119], v[200:203], v[236:239], v[116:119]
    s_waitcnt lgkmcnt(4)
    v_mfma_f32_16x16x32_bf16 v[56:59], v[204:207], v[224:227], v[56:59]
    ds_read_b64_tr_b16 v[200:201], v242 offset:0
    v_mfma_f32_16x16x32_bf16 v[60:63], v[204:207], v[228:231], v[60:63]
    v_mfma_f32_16x16x32_bf16 v[120:123], v[204:207], v[232:235], v[120:123]
    ds_read_b64_tr_b16 v[202:203], v242 offset:2048
    v_mfma_f32_16x16x32_bf16 v[124:127], v[204:207], v[236:239], v[124:127]
    s_barrier
    s_waitcnt lgkmcnt(4)
    v_mfma_f32_16x16x32_bf16 v[0:3], v[192:195], v[208:211], v[0:3]
    ds_read_b64_tr_b16 v[204:205], v243 offset:0
    v_mfma_f32_16x16x32_bf16 v[4:7], v[192:195], v[212:215], v[4:7]
    v_mfma_f32_16x16x32_bf16 v[64:67], v[192:195], v[216:219], v[64:67]
    ds_read_b64_tr_b16 v[206:207], v243 offset:2048
    v_mfma_f32_16x16x32_bf16 v[68:71], v[192:195], v[220:223], v[68:71]
    s_waitcnt lgkmcnt(4)
    v_mfma_f32_16x16x32_bf16 v[8:11], v[196:199], v[208:211], v[8:11]
    ds_read_b64_tr_b16 v[192:193], v244 offset:0
    v_mfma_f32_16x16x32_bf16 v[12:15], v[196:199], v[212:215], v[12:15]
    ds_read_b128 v[224:227], v249 offset:16384
    v_mfma_f32_16x16x32_bf16 v[72:75], v[196:199], v[216:219], v[72:75]
    ds_read_b64_tr_b16 v[194:195], v244 offset:2048
    v_mfma_f32_16x16x32_bf16 v[76:79], v[196:199], v[220:223], v[76:79]
    s_waitcnt lgkmcnt(5)
    v_mfma_f32_16x16x32_bf16 v[16:19], v[200:203], v[208:211], v[16:19]
    ds_read_b64_tr_b16 v[196:197], v245 offset:0
    v_mfma_f32_16x16x32_bf16 v[20:23], v[200:203], v[212:215], v[20:23]
    ds_read_b128 v[228:231], v249 offset:18432
    v_mfma_f32_16x16x32_bf16 v[80:83], v[200:203], v[216:219], v[80:83]
    ds_read_b64_tr_b16 v[198:199], v245 offset:2048
    v_mfma_f32_16x16x32_bf16 v[84:87], v[200:203], v[220:223], v[84:87]
    s_waitcnt lgkmcnt(6)
    v_mfma_f32_16x16x32_bf16 v[24:27], v[204:207], v[208:211], v[24:27]
    ds_read_b64_tr_b16 v[200:201], v246 offset:0
    v_mfma_f32_16x16x32_bf16 v[28:31], v[204:207], v[212:215], v[28:31]
    ds_read_b128 v[232:235], v249 offset:20480
    v_mfma_f32_16x16x32_bf16 v[88:91], v[204:207], v[216:219], v[88:91]
    ds_read_b64_tr_b16 v[202:203], v246 offset:2048
    v_mfma_f32_16x16x32_bf16 v[92:95], v[204:207], v[220:223], v[92:95]
    s_waitcnt lgkmcnt(6)
    v_mfma_f32_16x16x32_bf16 v[32:35], v[192:195], v[208:211], v[32:35]
    ds_read_b64_tr_b16 v[204:205], v247 offset:0
    v_mfma_f32_16x16x32_bf16 v[36:39], v[192:195], v[212:215], v[36:39]
    ds_read_b128 v[236:239], v249 offset:22528
    v_mfma_f32_16x16x32_bf16 v[96:99], v[192:195], v[216:219], v[96:99]
    ds_read_b64_tr_b16 v[206:207], v247 offset:2048
    v_mfma_f32_16x16x32_bf16 v[100:103], v[192:195], v[220:223], v[100:103]
    s_waitcnt lgkmcnt(6)
    v_mfma_f32_16x16x32_bf16 v[40:43], v[196:199], v[208:211], v[40:43]
    ds_read_b64_tr_b16 v[192:193], v240 offset:16384
    v_mfma_f32_16x16x32_bf16 v[44:47], v[196:199], v[212:215], v[44:47]
    v_mfma_f32_16x16x32_bf16 v[104:107], v[196:199], v[216:219], v[104:107]
    ds_read_b64_tr_b16 v[194:195], v240 offset:18432
    v_mfma_f32_16x16x32_bf16 v[108:111], v[196:199], v[220:223], v[108:111]
    s_waitcnt lgkmcnt(5)
    v_mfma_f32_16x16x32_bf16 v[48:51], v[200:203], v[208:211], v[48:51]
    ds_read_b64_tr_b16 v[196:197], v241 offset:16384
    v_mfma_f32_16x16x32_bf16 v[52:55], v[200:203], v[212:215], v[52:55]
    v_mfma_f32_16x16x32_bf16 v[112:115], v[200:203], v[216:219], v[112:115]
    ds_read_b64_tr_b16 v[198:199], v241 offset:18432
    v_mfma_f32_16x16x32_bf16 v[116:119], v[200:203], v[220:223], v[116:119]
    s_waitcnt lgkmcnt(4)
    v_mfma_f32_16x16x32_bf16 v[56:59], v[204:207], v[208:211], v[56:59]
    ds_read_b64_tr_b16 v[200:201], v242 offset:16384
    v_mfma_f32_16x16x32_bf16 v[60:63], v[204:207], v[212:215], v[60:63]
    v_mfma_f32_16x16x32_bf16 v[120:123], v[204:207], v[216:219], v[120:123]
    ds_read_b64_tr_b16 v[202:203], v242 offset:18432
    v_mfma_f32_16x16x32_bf16 v[124:127], v[204:207], v[220:223], v[124:127]
    s_barrier
    s_waitcnt lgkmcnt(4)
    v_mfma_f32_16x16x32_bf16 v[0:3], v[192:195], v[224:227], v[0:3]
    ds_read_b64_tr_b16 v[204:205], v243 offset:16384
    v_mfma_f32_16x16x32_bf16 v[4:7], v[192:195], v[228:231], v[4:7]
    v_mfma_f32_16x16x32_bf16 v[64:67], v[192:195], v[232:235], v[64:67]
    ds_read_b64_tr_b16 v[206:207], v243 offset:18432
    v_mfma_f32_16x16x32_bf16 v[68:71], v[192:195], v[236:239], v[68:71]
    s_waitcnt lgkmcnt(4)
    v_mfma_f32_16x16x32_bf16 v[8:11], v[196:199], v[224:227], v[8:11]
    ds_read_b64_tr_b16 v[192:193], v244 offset:16384
    v_mfma_f32_16x16x32_bf16 v[12:15], v[196:199], v[228:231], v[12:15]
    ds_read_b128 v[208:211], v248 offset:32768
    v_mfma_f32_16x16x32_bf16 v[72:75], v[196:199], v[232:235], v[72:75]
    ds_read_b64_tr_b16 v[194:195], v244 offset:18432
    v_mfma_f32_16x16x32_bf16 v[76:79], v[196:199], v[236:239], v[76:79]
    s_waitcnt lgkmcnt(5)
    v_mfma_f32_16x16x32_bf16 v[16:19], v[200:203], v[224:227], v[16:19]
    ds_read_b64_tr_b16 v[196:197], v245 offset:16384
    v_mfma_f32_16x16x32_bf16 v[20:23], v[200:203], v[228:231], v[20:23]
    ds_read_b128 v[212:215], v248 offset:34816
    v_mfma_f32_16x16x32_bf16 v[80:83], v[200:203], v[232:235], v[80:83]
    ds_read_b64_tr_b16 v[198:199], v245 offset:18432
    v_mfma_f32_16x16x32_bf16 v[84:87], v[200:203], v[236:239], v[84:87]
    s_waitcnt lgkmcnt(6)
    v_mfma_f32_16x16x32_bf16 v[24:27], v[204:207], v[224:227], v[24:27]
    ds_read_b64_tr_b16 v[200:201], v246 offset:16384
    v_mfma_f32_16x16x32_bf16 v[28:31], v[204:207], v[228:231], v[28:31]
    ds_read_b128 v[216:219], v248 offset:36864
    v_mfma_f32_16x16x32_bf16 v[88:91], v[204:207], v[232:235], v[88:91]
    ds_read_b64_tr_b16 v[202:203], v246 offset:18432
    v_mfma_f32_16x16x32_bf16 v[92:95], v[204:207], v[236:239], v[92:95]
    s_waitcnt lgkmcnt(6)
    v_mfma_f32_16x16x32_bf16 v[32:35], v[192:195], v[224:227], v[32:35]
    ds_read_b64_tr_b16 v[204:205], v247 offset:16384
    v_mfma_f32_16x16x32_bf16 v[36:39], v[192:195], v[228:231], v[36:39]
    ds_read_b128 v[220:223], v248 offset:38912
    v_mfma_f32_16x16x32_bf16 v[96:99], v[192:195], v[232:235], v[96:99]
    ds_read_b64_tr_b16 v[206:207], v247 offset:18432
    v_mfma_f32_16x16x32_bf16 v[100:103], v[192:195], v[236:239], v[100:103]
    s_waitcnt lgkmcnt(6)
    v_mfma_f32_16x16x32_bf16 v[40:43], v[196:199], v[224:227], v[40:43]
    ds_read_b64_tr_b16 v[192:193], v240 offset:32768
    v_mfma_f32_16x16x32_bf16 v[44:47], v[196:199], v[228:231], v[44:47]
    v_mfma_f32_16x16x32_bf16 v[104:107], v[196:199], v[232:235], v[104:107]
    ds_read_b64_tr_b16 v[194:195], v240 offset:34816
    v_mfma_f32_16x16x32_bf16 v[108:111], v[196:199], v[236:239], v[108:111]
    s_waitcnt lgkmcnt(5)
    v_mfma_f32_16x16x32_bf16 v[48:51], v[200:203], v[224:227], v[48:51]
    ds_read_b64_tr_b16 v[196:197], v241 offset:32768
    v_mfma_f32_16x16x32_bf16 v[52:55], v[200:203], v[228:231], v[52:55]
    v_mfma_f32_16x16x32_bf16 v[112:115], v[200:203], v[232:235], v[112:115]
    ds_read_b64_tr_b16 v[198:199], v241 offset:34816
    v_mfma_f32_16x16x32_bf16 v[116:119], v[200:203], v[236:239], v[116:119]
    s_waitcnt lgkmcnt(4)
    v_mfma_f32_16x16x32_bf16 v[56:59], v[204:207], v[224:227], v[56:59]
    ds_read_b64_tr_b16 v[200:201], v242 offset:32768
    v_mfma_f32_16x16x32_bf16 v[60:63], v[204:207], v[228:231], v[60:63]
    v_mfma_f32_16x16x32_bf16 v[120:123], v[204:207], v[232:235], v[120:123]
    ds_read_b64_tr_b16 v[202:203], v242 offset:34816
    v_mfma_f32_16x16x32_bf16 v[124:127], v[204:207], v[236:239], v[124:127]
    s_barrier
    s_waitcnt lgkmcnt(4)
    v_mfma_f32_16x16x32_bf16 v[0:3], v[192:195], v[208:211], v[0:3]
    ds_read_b64_tr_b16 v[204:205], v243 offset:32768
    v_mfma_f32_16x16x32_bf16 v[4:7], v[192:195], v[212:215], v[4:7]
    v_mfma_f32_16x16x32_bf16 v[64:67], v[192:195], v[216:219], v[64:67]
    ds_read_b64_tr_b16 v[206:207], v243 offset:34816
    v_mfma_f32_16x16x32_bf16 v[68:71], v[192:195], v[220:223], v[68:71]
    s_waitcnt lgkmcnt(4)
    v_mfma_f32_16x16x32_bf16 v[8:11], v[196:199], v[208:211], v[8:11]
    ds_read_b64_tr_b16 v[192:193], v244 offset:32768
    v_mfma_f32_16x16x32_bf16 v[12:15], v[196:199], v[212:215], v[12:15]
    ds_read_b128 v[224:227], v249 offset:32768
    v_mfma_f32_16x16x32_bf16 v[72:75], v[196:199], v[216:219], v[72:75]
    ds_read_b64_tr_b16 v[194:195], v244 offset:34816
    v_mfma_f32_16x16x32_bf16 v[76:79], v[196:199], v[220:223], v[76:79]
    s_waitcnt lgkmcnt(5)
    v_mfma_f32_16x16x32_bf16 v[16:19], v[200:203], v[208:211], v[16:19]
    ds_read_b64_tr_b16 v[196:197], v245 offset:32768
    v_mfma_f32_16x16x32_bf16 v[20:23], v[200:203], v[212:215], v[20:23]
    ds_read_b128 v[228:231], v249 offset:34816
    v_mfma_f32_16x16x32_bf16 v[80:83], v[200:203], v[216:219], v[80:83]
    ds_read_b64_tr_b16 v[198:199], v245 offset:34816
    v_mfma_f32_16x16x32_bf16 v[84:87], v[200:203], v[220:223], v[84:87]
    s_waitcnt lgkmcnt(6)
    v_mfma_f32_16x16x32_bf16 v[24:27], v[204:207], v[208:211], v[24:27]
    ds_read_b64_tr_b16 v[200:201], v246 offset:32768
    v_mfma_f32_16x16x32_bf16 v[28:31], v[204:207], v[212:215], v[28:31]
    ds_read_b128 v[232:235], v249 offset:36864
    v_mfma_f32_16x16x32_bf16 v[88:91], v[204:207], v[216:219], v[88:91]
    ds_read_b64_tr_b16 v[202:203], v246 offset:34816
    v_mfma_f32_16x16x32_bf16 v[92:95], v[204:207], v[220:223], v[92:95]
    s_waitcnt lgkmcnt(6)
    v_mfma_f32_16x16x32_bf16 v[32:35], v[192:195], v[208:211], v[32:35]
    ds_read_b64_tr_b16 v[204:205], v247 offset:32768
    v_mfma_f32_16x16x32_bf16 v[36:39], v[192:195], v[212:215], v[36:39]
    ds_read_b128 v[236:239], v249 offset:38912
    v_mfma_f32_16x16x32_bf16 v[96:99], v[192:195], v[216:219], v[96:99]
    ds_read_b64_tr_b16 v[206:207], v247 offset:34816
    v_mfma_f32_16x16x32_bf16 v[100:103], v[192:195], v[220:223], v[100:103]
    s_waitcnt lgkmcnt(6)
    v_mfma_f32_16x16x32_bf16 v[40:43], v[196:199], v[208:211], v[40:43]
    ds_read_b64_tr_b16 v[192:193], v240 offset:49152
    v_mfma_f32_16x16x32_bf16 v[44:47], v[196:199], v[212:215], v[44:47]
    v_mfma_f32_16x16x32_bf16 v[104:107], v[196:199], v[216:219], v[104:107]
    ds_read_b64_tr_b16 v[194:195], v240 offset:51200
    v_mfma_f32_16x16x32_bf16 v[108:111], v[196:199], v[220:223], v[108:111]
    s_waitcnt lgkmcnt(5)
    v_mfma_f32_16x16x32_bf16 v[48:51], v[200:203], v[208:211], v[48:51]
    ds_read_b64_tr_b16 v[196:197], v241 offset:49152
    v_mfma_f32_16x16x32_bf16 v[52:55], v[200:203], v[212:215], v[52:55]
    v_mfma_f32_16x16x32_bf16 v[112:115], v[200:203], v[216:219], v[112:115]
    ds_read_b64_tr_b16 v[198:199], v241 offset:51200
    v_mfma_f32_16x16x32_bf16 v[116:119], v[200:203], v[220:223], v[116:119]
    s_waitcnt lgkmcnt(4)
    v_mfma_f32_16x16x32_bf16 v[56:59], v[204:207], v[208:211], v[56:59]
    ds_read_b64_tr_b16 v[200:201], v242 offset:49152
    v_mfma_f32_16x16x32_bf16 v[60:63], v[204:207], v[212:215], v[60:63]
    v_mfma_f32_16x16x32_bf16 v[120:123], v[204:207], v[216:219], v[120:123]
    ds_read_b64_tr_b16 v[202:203], v242 offset:51200
    v_mfma_f32_16x16x32_bf16 v[124:127], v[204:207], v[220:223], v[124:127]
    s_waitcnt vmcnt(0)
    s_barrier
    s_lshl_b32 s14, s3, 1
    s_or_b32 s14, s14, s15
    s_cmp_eq_u32 s14, 1
    s_cbranch_scc0 L_nomark
    s_and_b32 s14, s2, 7
    s_lshl_b32 s14, s14, 3
    s_add_u32 s14, s14, s6
    s_lshl_b32 s14, s14, 2
    v_mov_b32 v253, 1
    buffer_store_dword v253, off, s[72:75], s14 sc1
L_nomark:
    s_waitcnt lgkmcnt(4)
    v_mfma_f32_16x16x32_bf16 v[0:3], v[192:195], v[224:227], v[0:3]
    ds_read_b64_tr_b16 v[204:205], v243 offset:49152
    v_mfma_f32_16x16x32_bf16 v[4:7], v[192:195], v[228:231], v[4:7]
    v_mfma_f32_16x16x32_bf16 v[64:67], v[192:195], v[232:235], v[64:67]
    ds_read_b64_tr_b16 v[206:207], v243 offset:51200
    v_mfma_f32_16x16x32_bf16 v[68:71], v[192:195], v[236:239], v[68:71]
    s_waitcnt lgkmcnt(4)
    v_mfma_f32_16x16x32_bf16 v[8:11], v[196:199], v[224:227], v[8:11]
    ds_read_b64_tr_b16 v[192:193], v244 offset:49152
    v_mfma_f32_16x16x32_bf16 v[12:15], v[196:199], v[228:231], v[12:15]
    ds_read_b128 v[208:211], v248 offset:49152
    v_mfma_f32_16x16x32_bf16 v[72:75], v[196:199], v[232:235], v[72:75]
    ds_read_b64_tr_b16 v[194:195], v244 offset:51200
    v_mfma_f32_16x16x32_bf16 v[76:79], v[196:199], v[236:239], v[76:79]
    s_waitcnt lgkmcnt(5)
    v_mfma_f32_16x16x32_bf16 v[16:19], v[200:203], v[224:227], v[16:19]
    ds_read_b64_tr_b16 v[196:197], v245 offset:49152
    v_mfma_f32_16x16x32_bf16 v[20:23], v[200:203], v[228:231], v[20:23]
    ds_read_b128 v[212:215], v248 offset:51200
    v_mfma_f32_16x16x32_bf16 v[80:83], v[200:203], v[232:235], v[80:83]
    ds_read_b64_tr_b16 v[198:199], v245 offset:51200
    v_mfma_f32_16x16x32_bf16 v[84:87], v[200:203], v[236:239], v[84:87]
    s_waitcnt lgkmcnt(6)
    v_mfma_f32_16x16x32_bf16 v[24:27], v[204:207], v[224:227], v[24:27]
    ds_read_b64_tr_b16 v[200:201], v246 offset:49152
    v_mfma_f32_16x16x32_bf16 v[28:31], v[204:207], v[228:231], v[28:31]
    ds_read_b128 v[216:219], v248 offset:53248
    v_mfma_f32_16x16x32_bf16 v[88:91], v[204:207], v[232:235], v[88:91]
    ds_read_b64_tr_b16 v[202:203], v246 offset:51200
    v_mfma_f32_16x16x32_bf16 v[92:95], v[204:207], v[236:239], v[92:95]
    s_waitcnt lgkmcnt(6)
    v_mfma_f32_16x16x32_bf16 v[32:35], v[192:195], v[224:227], v[32:35]
    ds_read_b64_tr_b16 v[204:205], v247 offset:49152
    v_mfma_f32_16x16x32_bf16 v[36:39], v[192:195], v[228:231], v[36:39]
    ds_read_b128 v[220:223], v248 offset:55296
    v_mfma_f32_16x16x32_bf16 v[96:99], v[192:195], v[232:235], v[96:99]
    ds_read_b64_tr_b16 v[206:207], v247 offset:51200
    v_mfma_f32_16x16x32_bf16 v[100:103], v[192:195], v[236:239], v[100:103]
    s_waitcnt lgkmcnt(6)
    v_mfma_f32_16x16x32_bf16 v[40:43], v[196:199], v[224:227], v[40:43]
    v_add_u32 v240, 65536, v240
    v_add_u32 v241, 65536, v241
    v_add_u32 v242, 65536, v242
    v_add_u32 v243, 65536, v243
    v_add_u32 v244, 65536, v244
    v_add_u32 v245, 65536, v245
    v_add_u32 v246, 65536, v246
    v_add_u32 v247, 65536, v247
    ds_read_b64_tr_b16 v[192:193], v240 offset:0
    v_mfma_f32_16x16x32_bf16 v[44:47], v[196:199], v[228:231], v[44:47]
    v_mfma_f32_16x16x32_bf16 v[104:107], v[196:199], v[232:235], v[104:107]
    ds_read_b64_tr_b16 v[194:195], v240 offset:2048
    v_mfma_f32_16x16x32_bf16 v[108:111], v[196:199], v[236:239], v[108:111]
    s_waitcnt lgkmcnt(5)
    v_mfma_f32_16x16x32_bf16 v[48:51], v[200:203], v[224:227], v[48:51]
    ds_read_b64_tr_b16 v[196:197], v241 offset:0
    v_mfma_f32_16x16x32_bf16 v[52:55], v[200:203], v[228:231], v[52:55]
    v_mfma_f32_16x16x32_bf16 v[112:115], v[200:203], v[232:235], v[112:115]
    ds_read_b64_tr_b16 v[198:199], v241 offset:2048
    v_mfma_f32_16x16x32_bf16 v[116:119], v[200:203], v[236:239], v[116:119]
    s_waitcnt lgkmcnt(4)
    v_mfma_f32_16x16x32_bf16 v[56:59], v[204:207], v[224:227], v[56:59]
    ds_read_b64_tr_b16 v[200:201], v242 offset:0
    v_mfma_f32_16x16x32_bf16 v[60:63], v[204:207], v[228:231], v[60:63]
    v_mfma_f32_16x16x32_bf16 v[120:123], v[204:207], v[232:235], v[120:123]
    ds_read_b64_tr_b16 v[202:203], v242 offset:2048
    v_mfma_f32_16x16x32_bf16 v[124:127], v[204:207], v[236:239], v[124:127]
    s_barrier
    s_waitcnt lgkmcnt(4)
    v_mfma_f32_16x16x32_bf16 v[0:3], v[192:195], v[208:211], v[0:3]
    ds_read_b64_tr_b16 v[204:205], v243 offset:0
    v_mfma_f32_16x16x32_bf16 v[4:7], v[192:195], v[212:215], v[4:7]
    v_mfma_f32_16x16x32_bf16 v[64:67], v[192:195], v[216:219], v[64:67]
    ds_read_b64_tr_b16 v[206:207], v243 offset:2048
    v_mfma_f32_16x16x32_bf16 v[68:71], v[192:195], v[220:223], v[68:71]
    s_waitcnt lgkmcnt(4)
    v_mfma_f32_16x16x32_bf16 v[8:11], v[196:199], v[208:211], v[8:11]
    ds_read_b64_tr_b16 v[192:193], v244 offset:0
    v_mfma_f32_16x16x32_bf16 v[12:15], v[196:199], v[212:215], v[12:15]
    ds_read_b128 v[224:227], v249 offset:49152
    v_mfma_f32_16x16x32_bf16 v[72:75], v[196:199], v[216:219], v[72:75]
    ds_read_b64_tr_b16 v[194:195], v244 offset:2048
    v_mfma_f32_16x16x32_bf16 v[76:79], v[196:199], v[220:223], v[76:79]
    s_waitcnt lgkmcnt(5)
    v_mfma_f32_16x16x32_bf16 v[16:19], v[200:203], v[208:211], v[16:19]
    ds_read_b64_tr_b16 v[196:197], v245 offset:0
    v_mfma_f32_16x16x32_bf16 v[20:23], v[200:203], v[212:215], v[20:23]
    ds_read_b128 v[228:231], v249 offset:51200
    v_mfma_f32_16x16x32_bf16 v[80:83], v[200:203], v[216:219], v[80:83]
    ds_read_b64_tr_b16 v[198:199], v245 offset:2048
    v_mfma_f32_16x16x32_bf16 v[84:87], v[200:203], v[220:223], v[84:87]
    s_waitcnt lgkmcnt(6)
    v_mfma_f32_16x16x32_bf16 v[24:27], v[204:207], v[208:211], v[24:27]
    ds_read_b64_tr_b16 v[200:201], v246 offset:0
    v_mfma_f32_16x16x32_bf16 v[28:31], v[204:207], v[212:215], v[28:31]
    ds_read_b128 v[232:235], v249 offset:53248
    v_mfma_f32_16x16x32_bf16 v[88:91], v[204:207], v[216:219], v[88:91]
    ds_read_b64_tr_b16 v[202:203], v246 offset:2048
    v_mfma_f32_16x16x32_bf16 v[92:95], v[204:207], v[220:223], v[92:95]
    s_waitcnt lgkmcnt(6)
    v_mfma_f32_16x16x32_bf16 v[32:35], v[192:195], v[208:211], v[32:35]
    ds_read_b64_tr_b16 v[204:205], v247 offset:0
    v_mfma_f32_16x16x32_bf16 v[36:39], v[192:195], v[212:215], v[36:39]
    ds_read_b128 v[236:239], v249 offset:55296
    v_mfma_f32_16x16x32_bf16 v[96:99], v[192:195], v[216:219], v[96:99]
    ds_read_b64_tr_b16 v[206:207], v247 offset:2048
    v_mfma_f32_16x16x32_bf16 v[100:103], v[192:195], v[220:223], v[100:103]
    s_waitcnt lgkmcnt(6)
    v_mfma_f32_16x16x32_bf16 v[40:43], v[196:199], v[208:211], v[40:43]
    ds_read_b64_tr_b16 v[192:193], v240 offset:16384
    v_mfma_f32_16x16x32_bf16 v[44:47], v[196:199], v[212:215], v[44:47]
    v_mfma_f32_16x16x32_bf16 v[104:107], v[196:199], v[216:219], v[104:107]
    ds_read_b64_tr_b16 v[194:195], v240 offset:18432
    v_mfma_f32_16x16x32_bf16 v[108:111], v[196:199], v[220:223], v[108:111]
    s_waitcnt lgkmcnt(5)
    v_mfma_f32_16x16x32_bf16 v[48:51], v[200:203], v[208:211], v[48:51]
    ds_read_b64_tr_b16 v[196:197], v241 offset:16384
    v_mfma_f32_16x16x32_bf16 v[52:55], v[200:203], v[212:215], v[52:55]
    v_mfma_f32_16x16x32_bf16 v[112:115], v[200:203], v[216:219], v[112:115]
    ds_read_b64_tr_b16 v[198:199], v241 offset:18432
    v_mfma_f32_16x16x32_bf16 v[116:119], v[200:203], v[220:223], v[116:119]
    s_waitcnt lgkmcnt(4)
    v_mfma_f32_16x16x32_bf16 v[56:59], v[204:207], v[208:211], v[56:59]
    ds_read_b64_tr_b16 v[200:201], v242 offset:16384
    v_mfma_f32_16x16x32_bf16 v[60:63], v[204:207], v[212:215], v[60:63]
    v_mfma_f32_16x16x32_bf16 v[120:123], v[204:207], v[216:219], v[120:123]
    ds_read_b64_tr_b16 v[202:203], v242 offset:18432
    v_mfma_f32_16x16x32_bf16 v[124:127], v[204:207], v[220:223], v[124:127]
    s_barrier
    s_waitcnt lgkmcnt(4)
    v_mfma_f32_16x16x32_bf16 v[0:3], v[192:195], v[224:227], v[0:3]
    ds_read_b64_tr_b16 v[204:205], v243 offset:16384
    v_mfma_f32_16x16x32_bf16 v[4:7], v[192:195], v[228:231], v[4:7]
    v_mfma_f32_16x16x32_bf16 v[64:67], v[192:195], v[232:235], v[64:67]
    ds_read_b64_tr_b16 v[206:207], v243 offset:18432
    v_mfma_f32_16x16x32_bf16 v[68:71], v[192:195], v[236:239], v[68:71]
    s_waitcnt lgkmcnt(4)
    v_mfma_f32_16x16x32_bf16 v[8:11], v[196:199], v[224:227], v[8:11]
    ds_read_b64_tr_b16 v[192:193], v244 offset:16384
    v_mfma_f32_16x16x32_bf16 v[12:15], v[196:199], v[228:231], v[12:15]
    ds_read_b128 v[208:211], v248 offset:0
    v_mfma_f32_16x16x32_bf16 v[72:75], v[196:199], v[232:235], v[72:75]
    ds_read_b64_tr_b16 v[194:195], v244 offset:18432
    v_mfma_f32_16x16x32_bf16 v[76:79], v[196:199], v[236:239], v[76:79]
    s_waitcnt lgkmcnt(5)
    v_mfma_f32_16x16x32_bf16 v[16:19], v[200:203], v[224:227], v[16:19]
    ds_read_b64_tr_b16 v[196:197], v245 offset:16384
    v_mfma_f32_16x16x32_bf16 v[20:23], v[200:203], v[228:231], v[20:23]
    ds_read_b128 v[212:215], v248 offset:2048
    v_mfma_f32_16x16x32_bf16 v[80:83], v[200:203], v[232:235], v[80:83]
    ds_read_b64_tr_b16 v[198:199], v245 offset:18432
    v_mfma_f32_16x16x32_bf16 v[84:87], v[200:203], v[236:239], v[84:87]
    s_waitcnt lgkmcnt(6)
    v_mfma_f32_16x16x32_bf16 v[24:27], v[204:207], v[224:227], v[24:27]
    ds_read_b64_tr_b16 v[200:201], v246 offset:16384
    v_mfma_f32_16x16x32_bf16 v[28:31], v[204:207], v[228:231], v[28:31]
    ds_read_b128 v[216:219], v248 offset:4096
    v_mfma_f32_16x16x32_bf16 v[88:91], v[204:207], v[232:235], v[88:91]
    ds_read_b64_tr_b16 v[202:203], v246 offset:18432
    v_mfma_f32_16x16x32_bf16 v[92:95], v[204:207], v[236:239], v[92:95]
    s_waitcnt lgkmcnt(6)
    v_mfma_f32_16x16x32_bf16 v[32:35], v[192:195], v[224:227], v[32:35]
    ds_read_b64_tr_b16 v[204:205], v247 offset:16384
    v_mfma_f32_16x16x32_bf16 v[36:39], v[192:195], v[228:231], v[36:39]
    ds_read_b128 v[220:223], v248 offset:6144
    v_mfma_f32_16x16x32_bf16 v[96:99], v[192:195], v[232:235], v[96:99]
    ds_read_b64_tr_b16 v[206:207], v247 offset:18432
    v_mfma_f32_16x16x32_bf16 v[100:103], v[192:195], v[236:239], v[100:103]
    s_waitcnt lgkmcnt(6)
    v_mfma_f32_16x16x32_bf16 v[40:43], v[196:199], v[224:227], v[40:43]
    v_add_u32 v240, 4294901760, v240
    v_add_u32 v241, 4294901760, v241
    v_add_u32 v242, 4294901760, v242
    v_add_u32 v243, 4294901760, v243
    v_add_u32 v244, 4294901760, v244
    v_add_u32 v245, 4294901760, v245
    v_add_u32 v246, 4294901760, v246
    v_add_u32 v247, 4294901760, v247
    ds_read_b64_tr_b16 v[192:193], v240 offset:0
    v_mfma_f32_16x16x32_bf16 v[44:47], v[196:199], v[228:231], v[44:47]
    v_mfma_f32_16x16x32_bf16 v[104:107], v[196:199], v[232:235], v[104:107]
    ds_read_b64_tr_b16 v[194:195], v240 offset:2048
    v_mfma_f32_16x16x32_bf16 v[108:111], v[196:199], v[236:239], v[108:111]
    s_waitcnt lgkmcnt(5)
    v_mfma_f32_16x16x32_bf16 v[48:51], v[200:203], v[224:227], v[48:51]
    ds_read_b64_tr_b16 v[196:197], v241 offset:0
    v_mfma_f32_16x16x32_bf16 v[52:55], v[200:203], v[228:231], v[52:55]
    v_mfma_f32_16x16x32_bf16 v[112:115], v[200:203], v[232:235], v[112:115]
    ds_read_b64_tr_b16 v[198:199], v241 offset:2048
    v_mfma_f32_16x16x32_bf16 v[116:119], v[200:203], v[236:239], v[116:119]
    s_waitcnt lgkmcnt(4)
    v_mfma_f32_16x16x32_bf16 v[56:59], v[204:207], v[224:227], v[56:59]
    ds_read_b64_tr_b16 v[200:201], v242 offset:0
    v_mfma_f32_16x16x32_bf16 v[60:63], v[204:207], v[228:231], v[60:63]
    v_mfma_f32_16x16x32_bf16 v[120:123], v[204:207], v[232:235], v[120:123]
    ds_read_b64_tr_b16 v[202:203], v242 offset:2048
    v_mfma_f32_16x16x32_bf16 v[124:127], v[204:207], v[236:239], v[124:127]
    s_barrier
    s_waitcnt lgkmcnt(4)
    v_mfma_f32_16x16x32_bf16 v[0:3], v[192:195], v[208:211], v[0:3]
    ds_read_b64_tr_b16 v[204:205], v243 offset:0
    v_mfma_f32_16x16x32_bf16 v[4:7], v[192:195], v[212:215], v[4:7]
    v_mfma_f32_16x16x32_bf16 v[64:67], v[192:195], v[216:219], v[64:67]
    ds_read_b64_tr_b16 v[206:207], v243 offset:2048
    v_mfma_f32_16x16x32_bf16 v[68:71], v[192:195], v[220:223], v[68:71]
    s_waitcnt lgkmcnt(4)
    v_mfma_f32_16x16x32_bf16 v[8:11], v[196:199], v[208:211], v[8:11]
    ds_read_b64_tr_b16 v[192:193], v244 offset:0
    v_mfma_f32_16x16x32_bf16 v[12:15], v[196:199], v[212:215], v[12:15]
    ds_read_b128 v[224:227], v249 offset:0
    v_mfma_f32_16x16x32_bf16 v[72:75], v[196:199], v[216:219], v[72:75]
    ds_read_b64_tr_b16 v[194:195], v244 offset:2048
    v_mfma_f32_16x16x32_bf16 v[76:79], v[196:199], v[220:223], v[76:79]
    s_waitcnt lgkmcnt(5)
    v_mfma_f32_16x16x32_bf16 v[16:19], v[200:203], v[208:211], v[16:19]
    ds_read_b64_tr_b16 v[196:197], v245 offset:0
    v_mfma_f32_16x16x32_bf16 v[20:23], v[200:203], v[212:215], v[20:23]
    ds_read_b128 v[228:231], v249 offset:2048
    v_mfma_f32_16x16x32_bf16 v[80:83], v[200:203], v[216:219], v[80:83]
    ds_read_b64_tr_b16 v[198:199], v245 offset:2048
    v_mfma_f32_16x16x32_bf16 v[84:87], v[200:203], v[220:223], v[84:87]
    s_waitcnt lgkmcnt(6)
    v_mfma_f32_16x16x32_bf16 v[24:27], v[204:207], v[208:211], v[24:27]
    ds_read_b64_tr_b16 v[200:201], v246 offset:0
    v_mfma_f32_16x16x32_bf16 v[28:31], v[204:207], v[212:215], v[28:31]
    ds_read_b128 v[232:235], v249 offset:4096
    v_mfma_f32_16x16x32_bf16 v[88:91], v[204:207], v[216:219], v[88:91]
    ds_read_b64_tr_b16 v[202:203], v246 offset:2048
    v_mfma_f32_16x16x32_bf16 v[92:95], v[204:207], v[220:223], v[92:95]
    s_waitcnt lgkmcnt(6)
    v_mfma_f32_16x16x32_bf16 v[32:35], v[192:195], v[208:211], v[32:35]
    ds_read_b64_tr_b16 v[204:205], v247 offset:0
    v_mfma_f32_16x16x32_bf16 v[36:39], v[192:195], v[212:215], v[36:39]
    ds_read_b128 v[236:239], v249 offset:6144
    v_mfma_f32_16x16x32_bf16 v[96:99], v[192:195], v[216:219], v[96:99]
    ds_read_b64_tr_b16 v[206:207], v247 offset:2048
    v_mfma_f32_16x16x32_bf16 v[100:103], v[192:195], v[220:223], v[100:103]
    s_waitcnt lgkmcnt(6)
    v_mfma_f32_16x16x32_bf16 v[40:43], v[196:199], v[208:211], v[40:43]
    ds_read_b64_tr_b16 v[192:193], v240 offset:16384
    v_mfma_f32_16x16x32_bf16 v[44:47], v[196:199], v[212:215], v[44:47]
    v_mfma_f32_16x16x32_bf16 v[104:107], v[196:199], v[216:219], v[104:107]
    ds_read_b64_tr_b16 v[194:195], v240 offset:18432
    v_mfma_f32_16x16x32_bf16 v[108:111], v[196:199], v[220:223], v[108:111]
    s_waitcnt lgkmcnt(5)
    v_mfma_f32_16x16x32_bf16 v[48:51], v[200:203], v[208:211], v[48:51]
    ds_read_b64_tr_b16 v[196:197], v241 offset:16384
    v_mfma_f32_16x16x32_bf16 v[52:55], v[200:203], v[212:215], v[52:55]
    v_mfma_f32_16x16x32_bf16 v[112:115], v[200:203], v[216:219], v[112:115]
    ds_read_b64_tr_b16 v[198:199], v241 offset:18432
    v_mfma_f32_16x16x32_bf16 v[116:119], v[200:203], v[220:223], v[116:119]
    s_waitcnt lgkmcnt(4)
    v_mfma_f32_16x16x32_bf16 v[56:59], v[204:207], v[208:211], v[56:59]
    ds_read_b64_tr_b16 v[200:201], v242 offset:16384
    v_mfma_f32_16x16x32_bf16 v[60:63], v[204:207], v[212:215], v[60:63]
    v_mfma_f32_16x16x32_bf16 v[120:123], v[204:207], v[216:219], v[120:123]
    ds_read_b64_tr_b16 v[202:203], v242 offset:18432
    v_mfma_f32_16x16x32_bf16 v[124:127], v[204:207], v[220:223], v[124:127]
    s_barrier
    s_waitcnt lgkmcnt(4)
    v_mfma_f32_16x16x32_bf16 v[0:3], v[192:195], v[224:227], v[0:3]
    ds_read_b64_tr_b16 v[204:205], v243 offset:16384
    v_mfma_f32_16x16x32_bf16 v[4:7], v[192:195], v[228:231], v[4:7]
    v_mfma_f32_16x16x32_bf16 v[64:67], v[192:195], v[232:235], v[64:67]
    ds_read_b64_tr_b16 v[206:207], v243 offset:18432
    v_mfma_f32_16x16x32_bf16 v[68:71], v[192:195], v[236:239], v[68:71]
    s_waitcnt lgkmcnt(4)
    v_mfma_f32_16x16x32_bf16 v[8:11], v[196:199], v[224:227], v[8:11]
    ds_read_b64_tr_b16 v[192:193], v244 offset:16384
    v_mfma_f32_16x16x32_bf16 v[12:15], v[196:199], v[228:231], v[12:15]
    ds_read_b128 v[208:211], v248 offset:16384
    v_mfma_f32_16x16x32_bf16 v[72:75], v[196:199], v[232:235], v[72:75]
    ds_read_b64_tr_b16 v[194:195], v244 offset:18432
    v_mfma_f32_16x16x32_bf16 v[76:79], v[196:199], v[236:239], v[76:79]
    s_waitcnt lgkmcnt(5)
    v_mfma_f32_16x16x32_bf16 v[16:19], v[200:203], v[224:227], v[16:19]
    ds_read_b64_tr_b16 v[196:197], v245 offset:16384
    v_mfma_f32_16x16x32_bf16 v[20:23], v[200:203], v[228:231], v[20:23]
    ds_read_b128 v[212:215], v248 offset:18432
    v_mfma_f32_16x16x32_bf16 v[80:83], v[200:203], v[232:235], v[80:83]
    ds_read_b64_tr_b16 v[198:199], v245 offset:18432
    v_mfma_f32_16x16x32_bf16 v[84:87], v[200:203], v[236:239], v[84:87]
    s_waitcnt lgkmcnt(6)
    v_mfma_f32_16x16x32_bf16 v[24:27], v[204:207], v[224:227], v[24:27]
    ds_read_b64_tr_b16 v[200:201], v246 offset:16384
    v_mfma_f32_16x16x32_bf16 v[28:31], v[204:207], v[228:231], v[28:31]
    ds_read_b128 v[216:219], v248 offset:20480
    v_mfma_f32_16x16x32_bf16 v[88:91], v[204:207], v[232:235], v[88:91]
    ds_read_b64_tr_b16 v[202:203], v246 offset:18432
    v_mfma_f32_16x16x32_bf16 v[92:95], v[204:207], v[236:239], v[92:95]
    s_waitcnt lgkmcnt(6)
    v_mfma_f32_16x16x32_bf16 v[32:35], v[192:195], v[224:227], v[32:35]
    ds_read_b64_tr_b16 v[204:205], v247 offset:16384
    v_mfma_f32_16x16x32_bf16 v[36:39], v[192:195], v[228:231], v[36:39]
    ds_read_b128 v[220:223], v248 offset:22528
    v_mfma_f32_16x16x32_bf16 v[96:99], v[192:195], v[232:235], v[96:99]
    ds_read_b64_tr_b16 v[206:207], v247 offset:18432
    v_mfma_f32_16x16x32_bf16 v[100:103], v[192:195], v[236:239], v[100:103]
    s_waitcnt lgkmcnt(6)
    v_mfma_f32_16x16x32_bf16 v[40:43], v[196:199], v[224:227], v[40:43]
    ds_read_b64_tr_b16 v[192:193], v240 offset:32768
    v_mfma_f32_16x16x32_bf16 v[44:47], v[196:199], v[228:231], v[44:47]
    v_mfma_f32_16x16x32_bf16 v[104:107], v[196:199], v[232:235], v[104:107]
    ds_read_b64_tr_b16 v[194:195], v240 offset:34816
    v_mfma_f32_16x16x32_bf16 v[108:111], v[196:199], v[236:239], v[108:111]
    s_waitcnt lgkmcnt(5)
    v_mfma_f32_16x16x32_bf16 v[48:51], v[200:203], v[224:227], v[48:51]
    ds_read_b64_tr_b16 v[196:197], v241 offset:32768
    v_mfma_f32_16x16x32_bf16 v[52:55], v[200:203], v[228:231], v[52:55]
    v_mfma_f32_16x16x32_bf16 v[112:115], v[200:203], v[232:235], v[112:115]
    ds_read_b64_tr_b16 v[198:199], v241 offset:34816
    v_mfma_f32_16x16x32_bf16 v[116:119], v[200:203], v[236:239], v[116:119]
    s_waitcnt lgkmcnt(4)
    v_mfma_f32_16x16x32_bf16 v[56:59], v[204:207], v[224:227], v[56:59]
    ds_read_b64_tr_b16 v[200:201], v242 offset:32768
    v_mfma_f32_16x16x32_bf16 v[60:63], v[204:207], v[228:231], v[60:63]
    v_mfma_f32_16x16x32_bf16 v[120:123], v[204:207], v[232:235], v[120:123]
    ds_read_b64_tr_b16 v[202:203], v242 offset:34816
    v_mfma_f32_16x16x32_bf16 v[124:127], v[204:207], v[236:239], v[124:127]
    s_barrier
    s_waitcnt lgkmcnt(4)
    v_mfma_f32_16x16x32_bf16 v[0:3], v[192:195], v[208:211], v[0:3]
    ds_read_b64_tr_b16 v[204:205], v243 offset:32768
    v_mfma_f32_16x16x32_bf16 v[4:7], v[192:195], v[212:215], v[4:7]
    v_mfma_f32_16x16x32_bf16 v[64:67], v[192:195], v[216:219], v[64:67]
    ds_read_b64_tr_b16 v[206:207], v243 offset:34816
    v_mfma_f32_16x16x32_bf16 v[68:71], v[192:195], v[220:223], v[68:71]
    s_waitcnt lgkmcnt(4)
    v_mfma_f32_16x16x32_bf16 v[8:11], v[196:199], v[208:211], v[8:11]
    ds_read_b64_tr_b16 v[192:193], v244 offset:32768
    v_mfma_f32_16x16x32_bf16 v[12:15], v[196:199], v[212:215], v[12:15]
    ds_read_b128 v[224:227], v249 offset:16384
    v_mfma_f32_16x16x32_bf16 v[72:75], v[196:199], v[216:219], v[72:75]
    ds_read_b64_tr_b16 v[194:195], v244 offset:34816
    v_mfma_f32_16x16x32_bf16 v[76:79], v[196:199], v[220:223], v[76:79]
    s_waitcnt lgkmcnt(5)
    v_mfma_f32_16x16x32_bf16 v[16:19], v[200:203], v[208:211], v[16:19]
    ds_read_b64_tr_b16 v[196:197], v245 offset:32768
    v_mfma_f32_16x16x32_bf16 v[20:23], v[200:203], v[212:215], v[20:23]
    ds_read_b128 v[228:231], v249 offset:18432
    v_mfma_f32_16x16x32_bf16 v[80:83], v[200:203], v[216:219], v[80:83]
    ds_read_b64_tr_b16 v[198:199], v245 offset:34816
    v_mfma_f32_16x16x32_bf16 v[84:87], v[200:203], v[220:223], v[84:87]
    s_waitcnt lgkmcnt(6)
    v_mfma_f32_16x16x32_bf16 v[24:27], v[204:207], v[208:211], v[24:27]
    ds_read_b64_tr_b16 v[200:201], v246 offset:32768
    v_mfma_f32_16x16x32_bf16 v[28:31], v[204:207], v[212:215], v[28:31]
    ds_read_b128 v[232:235], v249 offset:20480
    v_mfma_f32_16x16x32_bf16 v[88:91], v[204:207], v[216:219], v[88:91]
    ds_read_b64_tr_b16 v[202:203], v246 offset:34816
    v_mfma_f32_16x16x32_bf16 v[92:95], v[204:207], v[220:223], v[92:95]
    s_waitcnt lgkmcnt(6)
    v_mfma_f32_16x16x32_bf16 v[32:35], v[192:195], v[208:211], v[32:35]
    ds_read_b64_tr_b16 v[204:205], v247 offset:32768
    v_mfma_f32_16x16x32_bf16 v[36:39], v[192:195], v[212:215], v[36:39]
    ds_read_b128 v[236:239], v249 offset:22528
    v_mfma_f32_16x16x32_bf16 v[96:99], v[192:195], v[216:219], v[96:99]
    ds_read_b64_tr_b16 v[206:207], v247 offset:34816
    v_mfma_f32_16x16x32_bf16 v[100:103], v[192:195], v[220:223], v[100:103]
    s_waitcnt lgkmcnt(6)
    v_mfma_f32_16x16x32_bf16 v[40:43], v[196:199], v[208:211], v[40:43]
    ds_read_b64_tr_b16 v[192:193], v240 offset:49152
    v_mfma_f32_16x16x32_bf16 v[44:47], v[196:199], v[212:215], v[44:47]
    v_mfma_f32_16x16x32_bf16 v[104:107], v[196:199], v[216:219], v[104:107]
    ds_read_b64_tr_b16 v[194:195], v240 offset:51200
    v_mfma_f32_16x16x32_bf16 v[108:111], v[196:199], v[220:223], v[108:111]
    s_waitcnt lgkmcnt(5)
    v_mfma_f32_16x16x32_bf16 v[48:51], v[200:203], v[208:211], v[48:51]
    ds_read_b64_tr_b16 v[196:197], v241 offset:49152
    v_mfma_f32_16x16x32_bf16 v[52:55], v[200:203], v[212:215], v[52:55]
    v_mfma_f32_16x16x32_bf16 v[112:115], v[200:203], v[216:219], v[112:115]
    ds_read_b64_tr_b16 v[198:199], v241 offset:51200
    v_mfma_f32_16x16x32_bf16 v[116:119], v[200:203], v[220:223], v[116:119]
    s_waitcnt lgkmcnt(4)
    v_mfma_f32_16x16x32_bf16 v[56:59], v[204:207], v[208:211], v[56:59]
    ds_read_b64_tr_b16 v[200:201], v242 offset:49152
    v_mfma_f32_16x16x32_bf16 v[60:63], v[204:207], v[212:215], v[60:63]
    v_mfma_f32_16x16x32_bf16 v[120:123], v[204:207], v[216:219], v[120:123]
    ds_read_b64_tr_b16 v[202:203], v242 offset:51200
    v_mfma_f32_16x16x32_bf16 v[124:127], v[204:207], v[220:223], v[124:127]
    s_barrier
    s_waitcnt lgkmcnt(4)
    v_mfma_f32_16x16x32_bf16 v[0:3], v[192:195], v[224:227], v[0:3]
    ds_read_b64_tr_b16 v[204:205], v243 offset:49152
    v_mfma_f32_16x16x32_bf16 v[4:7], v[192:195], v[228:231], v[4:7]
    v_mfma_f32_16x16x32_bf16 v[64:67], v[192:195], v[232:235], v[64:67]
    ds_read_b64_tr_b16 v[206:207], v243 offset:51200
    v_mfma_f32_16x16x32_bf16 v[68:71], v[192:195], v[236:239], v[68:71]
    s_waitcnt lgkmcnt(4)
    v_mfma_f32_16x16x32_bf16 v[8:11], v[196:199], v[224:227], v[8:11]
    ds_read_b64_tr_b16 v[192:193], v244 offset:49152
    v_mfma_f32_16x16x32_bf16 v[12:15], v[196:199], v[228:231], v[12:15]
    ds_read_b128 v[208:211], v248 offset:32768
    v_mfma_f32_16x16x32_bf16 v[72:75], v[196:199], v[232:235], v[72:75]
    ds_read_b64_tr_b16 v[194:195], v244 offset:51200
    v_mfma_f32_16x16x32_bf16 v[76:79], v[196:199], v[236:239], v[76:79]
    s_waitcnt lgkmcnt(5)
    v_mfma_f32_16x16x32_bf16 v[16:19], v[200:203], v[224:227], v[16:19]
    ds_read_b64_tr_b16 v[196:197], v245 offset:49152
    v_mfma_f32_16x16x32_bf16 v[20:23], v[200:203], v[228:231], v[20:23]
    ds_read_b128 v[212:215], v248 offset:34816
    v_mfma_f32_16x16x32_bf16 v[80:83], v[200:203], v[232:235], v[80:83]
    ds_read_b64_tr_b16 v[198:199], v245 offset:51200
    v_mfma_f32_16x16x32_bf16 v[84:87], v[200:203], v[236:239], v[84:87]
    s_waitcnt lgkmcnt(6)
    v_mfma_f32_16x16x32_bf16 v[24:27], v[204:207], v[224:227], v[24:27]
    ds_read_b64_tr_b16 v[200:201], v246 offset:49152
    v_mfma_f32_16x16x32_bf16 v[28:31], v[204:207], v[228:231], v[28:31]
    ds_read_b128 v[216:219], v248 offset:36864
    v_mfma_f32_16x16x32_bf16 v[88:91], v[204:207], v[232:235], v[88:91]
    ds_read_b64_tr_b16 v[202:203], v246 offset:51200
    v_mfma_f32_16x16x32_bf16 v[92:95], v[204:207], v[236:239], v[92:95]
    s_waitcnt lgkmcnt(6)
    v_mfma_f32_16x16x32_bf16 v[32:35], v[192:195], v[224:227], v[32:35]
    ds_read_b64_tr_b16 v[204:205], v247 offset:49152
    v_mfma_f32_16x16x32_bf16 v[36:39], v[192:195], v[228:231], v[36:39]
    ds_read_b128 v[220:223], v248 offset:38912
    v_mfma_f32_16x16x32_bf16 v[96:99], v[192:195], v[232:235], v[96:99]
    ds_read_b64_tr_b16 v[206:207], v247 offset:51200
    v_mfma_f32_16x16x32_bf16 v[100:103], v[192:195], v[236:239], v[100:103]
    s_waitcnt lgkmcnt(6)
    v_mfma_f32_16x16x32_bf16 v[40:43], v[196:199], v[224:227], v[40:43]
    v_add_u32 v240, 65536, v240
    v_add_u32 v241, 65536, v241
    v_add_u32 v242, 65536, v242
    v_add_u32 v243, 65536, v243
    v_add_u32 v244, 65536, v244
    v_add_u32 v245, 65536, v245
    v_add_u32 v246, 65536, v246
    v_add_u32 v247, 65536, v247
    ds_read_b64_tr_b16 v[192:193], v240 offset:0
    v_mfma_f32_16x16x32_bf16 v[44:47], v[196:199], v[228:231], v[44:47]
    v_mfma_f32_16x16x32_bf16 v[104:107], v[196:199], v[232:235], v[104:107]
    ds_read_b64_tr_b16 v[194:195], v240 offset:2048
    v_mfma_f32_16x16x32_bf16 v[108:111], v[196:199], v[236:239], v[108:111]
    s_waitcnt lgkmcnt(5)
    v_mfma_f32_16x16x32_bf16 v[48:51], v[200:203], v[224:227], v[48:51]
    ds_read_b64_tr_b16 v[196:197], v241 offset:0
    v_mfma_f32_16x16x32_bf16 v[52:55], v[200:203], v[228:231], v[52:55]
    v_mfma_f32_16x16x32_bf16 v[112:115], v[200:203], v[232:235], v[112:115]
    ds_read_b64_tr_b16 v[198:199], v241 offset:2048
    v_mfma_f32_16x16x32_bf16 v[116:119], v[200:203], v[236:239], v[116:119]
    s_waitcnt lgkmcnt(4)
    v_mfma_f32_16x16x32_bf16 v[56:59], v[204:207], v[224:227], v[56:59]
    ds_read_b64_tr_b16 v[200:201], v242 offset:0
    v_mfma_f32_16x16x32_bf16 v[60:63], v[204:207], v[228:231], v[60:63]
    v_mfma_f32_16x16x32_bf16 v[120:123], v[204:207], v[232:235], v[120:123]
    ds_read_b64_tr_b16 v[202:203], v242 offset:2048
    v_mfma_f32_16x16x32_bf16 v[124:127], v[204:207], v[236:239], v[124:127]
L_at_B12:
    s_barrier
    s_waitcnt lgkmcnt(4)
    v_mfma_f32_16x16x32_bf16 v[0:3], v[192:195], v[208:211], v[0:3]
    ds_read_b64_tr_b16 v[204:205], v243 offset:0
    v_mfma_f32_16x16x32_bf16 v[4:7], v[192:195], v[212:215], v[4:7]
    v_mfma_f32_16x16x32_bf16 v[64:67], v[192:195], v[216:219], v[64:67]
    ds_read_b64_tr_b16 v[206:207], v243 offset:2048
    v_mfma_f32_16x16x32_bf16 v[68:71], v[192:195], v[220:223], v[68:71]
    s_waitcnt lgkmcnt(4)
    v_mfma_f32_16x16x32_bf16 v[8:11], v[196:199], v[208:211], v[8:11]
    ds_read_b64_tr_b16 v[192:193], v244 offset:0
    v_mfma_f32_16x16x32_bf16 v[12:15], v[196:199], v[212:215], v[12:15]
    ds_read_b128 v[224:227], v249 offset:32768
    v_mfma_f32_16x16x32_bf16 v[72:75], v[196:199], v[216:219], v[72:75]
    ds_read_b64_tr_b16 v[194:195], v244 offset:2048
    v_mfma_f32_16x16x32_bf16 v[76:79], v[196:199], v[220:223], v[76:79]
    s_waitcnt lgkmcnt(5)
    v_mfma_f32_16x16x32_bf16 v[16:19], v[200:203], v[208:211], v[16:19]
    ds_read_b64_tr_b16 v[196:197], v245 offset:0
    v_mfma_f32_16x16x32_bf16 v[20:23], v[200:203], v[212:215], v[20:23]
    ds_read_b128 v[228:231], v249 offset:34816
    v_mfma_f32_16x16x32_bf16 v[80:83], v[200:203], v[216:219], v[80:83]
    ds_read_b64_tr_b16 v[198:199], v245 offset:2048
    v_mfma_f32_16x16x32_bf16 v[84:87], v[200:203], v[220:223], v[84:87]
    s_waitcnt lgkmcnt(6)
    v_mfma_f32_16x16x32_bf16 v[24:27], v[204:207], v[208:211], v[24:27]
    ds_read_b64_tr_b16 v[200:201], v246 offset:0
    v_mfma_f32_16x16x32_bf16 v[28:31], v[204:207], v[212:215], v[28:31]
    ds_read_b128 v[232:235], v249 offset:36864
    v_mfma_f32_16x16x32_bf16 v[88:91], v[204:207], v[216:219], v[88:91]
    ds_read_b64_tr_b16 v[202:203], v246 offset:2048
    v_mfma_f32_16x16x32_bf16 v[92:95], v[204:207], v[220:223], v[92:95]
    s_waitcnt lgkmcnt(6)
    v_mfma_f32_16x16x32_bf16 v[32:35], v[192:195], v[208:211], v[32:35]
    ds_read_b64_tr_b16 v[204:205], v247 offset:0
    v_mfma_f32_16x16x32_bf16 v[36:39], v[192:195], v[212:215], v[36:39]
    ds_read_b128 v[236:239], v249 offset:38912
    v_mfma_f32_16x16x32_bf16 v[96:99], v[192:195], v[216:219], v[96:99]
    ds_read_b64_tr_b16 v[206:207], v247 offset:2048
    v_mfma_f32_16x16x32_bf16 v[100:103], v[192:195], v[220:223], v[100:103]
    s_waitcnt lgkmcnt(6)
    v_mfma_f32_16x16x32_bf16 v[40:43], v[196:199], v[208:211], v[40:43]
    ds_read_b64_tr_b16 v[192:193], v240 offset:16384
    v_mfma_f32_16x16x32_bf16 v[44:47], v[196:199], v[212:215], v[44:47]
    v_mfma_f32_16x16x32_bf16 v[104:107], v[196:199], v[216:219], v[104:107]
    ds_read_b64_tr_b16 v[194:195], v240 offset:18432
    v_mfma_f32_16x16x32_bf16 v[108:111], v[196:199], v[220:223], v[108:111]
    s_waitcnt lgkmcnt(5)
    v_mfma_f32_16x16x32_bf16 v[48:51], v[200:203], v[208:211], v[48:51]
    ds_read_b64_tr_b16 v[196:197], v241 offset:16384
    v_mfma_f32_16x16x32_bf16 v[52:55], v[200:203], v[212:215], v[52:55]
    v_mfma_f32_16x16x32_bf16 v[112:115], v[200:203], v[216:219], v[112:115]
    ds_read_b64_tr_b16 v[198:199], v241 offset:18432
    v_mfma_f32_16x16x32_bf16 v[116:119], v[200:203], v[220:223], v[116:119]
    s_waitcnt lgkmcnt(4)
    v_mfma_f32_16x16x32_bf16 v[56:59], v[204:207], v[208:211], v[56:59]
    ds_read_b64_tr_b16 v[200:201], v242 offset:16384
    v_mfma_f32_16x16x32_bf16 v[60:63], v[204:207], v[212:215], v[60:63]
    v_mfma_f32_16x16x32_bf16 v[120:123], v[204:207], v[216:219], v[120:123]
    ds_read_b64_tr_b16 v[202:203], v242 offset:18432
    v_mfma_f32_16x16x32_bf16 v[124:127], v[204:207], v[220:223], v[124:127]
    s_barrier
    s_waitcnt lgkmcnt(4)
    v_mfma_f32_16x16x32_bf16 v[0:3], v[192:195], v[224:227], v[0:3]
    ds_read_b64_tr_b16 v[204:205], v243 offset:16384
    v_mfma_f32_16x16x32_bf16 v[4:7], v[192:195], v[228:231], v[4:7]
    v_mfma_f32_16x16x32_bf16 v[64:67], v[192:195], v[232:235], v[64:67]
    ds_read_b64_tr_b16 v[206:207], v243 offset:18432
    v_mfma_f32_16x16x32_bf16 v[68:71], v[192:195], v[236:239], v[68:71]
    s_waitcnt lgkmcnt(4)
    v_mfma_f32_16x16x32_bf16 v[8:11], v[196:199], v[224:227], v[8:11]
    ds_read_b64_tr_b16 v[192:193], v244 offset:16384
    v_mfma_f32_16x16x32_bf16 v[12:15], v[196:199], v[228:231], v[12:15]
    ds_read_b128 v[208:211], v248 offset:49152
    v_mfma_f32_16x16x32_bf16 v[72:75], v[196:199], v[232:235], v[72:75]
    ds_read_b64_tr_b16 v[194:195], v244 offset:18432
    v_mfma_f32_16x16x32_bf16 v[76:79], v[196:199], v[236:239], v[76:79]
    s_waitcnt lgkmcnt(5)
    v_mfma_f32_16x16x32_bf16 v[16:19], v[200:203], v[224:227], v[16:19]
    ds_read_b64_tr_b16 v[196:197], v245 offset:16384
    v_mfma_f32_16x16x32_bf16 v[20:23], v[200:203], v[228:231], v[20:23]
    ds_read_b128 v[212:215], v248 offset:51200
    v_mfma_f32_16x16x32_bf16 v[80:83], v[200:203], v[232:235], v[80:83]
    ds_read_b64_tr_b16 v[198:199], v245 offset:18432
    v_mfma_f32_16x16x32_bf16 v[84:87], v[200:203], v[236:239], v[84:87]
    s_waitcnt lgkmcnt(6)
    v_mfma_f32_16x16x32_bf16 v[24:27], v[204:207], v[224:227], v[24:27]
    ds_read_b64_tr_b16 v[200:201], v246 offset:16384
    v_mfma_f32_16x16x32_bf16 v[28:31], v[204:207], v[228:231], v[28:31]
    ds_read_b128 v[216:219], v248 offset:53248
    v_mfma_f32_16x16x32_bf16 v[88:91], v[204:207], v[232:235], v[88:91]
    ds_read_b64_tr_b16 v[202:203], v246 offset:18432
    v_mfma_f32_16x16x32_bf16 v[92:95], v[204:207], v[236:239], v[92:95]
    s_waitcnt lgkmcnt(6)
    v_mfma_f32_16x16x32_bf16 v[32:35], v[192:195], v[224:227], v[32:35]
    ds_read_b64_tr_b16 v[204:205], v247 offset:16384
    v_mfma_f32_16x16x32_bf16 v[36:39], v[192:195], v[228:231], v[36:39]
    ds_read_b128 v[220:223], v248 offset:55296
    v_mfma_f32_16x16x32_bf16 v[96:99], v[192:195], v[232:235], v[96:99]
    ds_read_b64_tr_b16 v[206:207], v247 offset:18432
    v_mfma_f32_16x16x32_bf16 v[100:103], v[192:195], v[236:239], v[100:103]
    s_waitcnt lgkmcnt(6)
    v_mfma_f32_16x16x32_bf16 v[40:43], v[196:199], v[224:227], v[40:43]
    v_add_u32 v240, 4294901760, v240
    v_add_u32 v241, 4294901760, v241
    v_add_u32 v242, 4294901760, v242
    v_add_u32 v243, 4294901760, v243
    v_add_u32 v244, 4294901760, v244
    v_add_u32 v245, 4294901760, v245
    v_add_u32 v246, 4294901760, v246
    v_add_u32 v247, 4294901760, v247
    ds_read_b64_tr_b16 v[192:193], v240 offset:0
    v_mfma_f32_16x16x32_bf16 v[44:47], v[196:199], v[228:231], v[44:47]
    v_mfma_f32_16x16x32_bf16 v[104:107], v[196:199], v[232:235], v[104:107]
    ds_read_b64_tr_b16 v[194:195], v240 offset:2048
    v_mfma_f32_16x16x32_bf16 v[108:111], v[196:199], v[236:239], v[108:111]
    s_waitcnt lgkmcnt(5)
    v_mfma_f32_16x16x32_bf16 v[48:51], v[200:203], v[224:227], v[48:51]
    ds_read_b64_tr_b16 v[196:197], v241 offset:0
    v_mfma_f32_16x16x32_bf16 v[52:55], v[200:203], v[228:231], v[52:55]
    v_mfma_f32_16x16x32_bf16 v[112:115], v[200:203], v[232:235], v[112:115]
    ds_read_b64_tr_b16 v[198:199], v241 offset:2048
    v_mfma_f32_16x16x32_bf16 v[116:119], v[200:203], v[236:239], v[116:119]
    s_waitcnt lgkmcnt(4)
    v_mfma_f32_16x16x32_bf16 v[56:59], v[204:207], v[224:227], v[56:59]
    ds_read_b64_tr_b16 v[200:201], v242 offset:0
    v_mfma_f32_16x16x32_bf16 v[60:63], v[204:207], v[228:231], v[60:63]
    v_mfma_f32_16x16x32_bf16 v[120:123], v[204:207], v[232:235], v[120:123]
    ds_read_b64_tr_b16 v[202:203], v242 offset:2048
    v_mfma_f32_16x16x32_bf16 v[124:127], v[204:207], v[236:239], v[124:127]
    s_barrier
    s_waitcnt lgkmcnt(4)
    v_mfma_f32_16x16x32_bf16 v[0:3], v[192:195], v[208:211], v[0:3]
    ds_read_b64_tr_b16 v[204:205], v243 offset:0
    v_mfma_f32_16x16x32_bf16 v[4:7], v[192:195], v[212:215], v[4:7]
    v_mfma_f32_16x16x32_bf16 v[64:67], v[192:195], v[216:219], v[64:67]
    ds_read_b64_tr_b16 v[206:207], v243 offset:2048
    v_mfma_f32_16x16x32_bf16 v[68:71], v[192:195], v[220:223], v[68:71]
    s_waitcnt lgkmcnt(4)
    v_mfma_f32_16x16x32_bf16 v[8:11], v[196:199], v[208:211], v[8:11]
    ds_read_b64_tr_b16 v[192:193], v244 offset:0
    v_mfma_f32_16x16x32_bf16 v[12:15], v[196:199], v[212:215], v[12:15]
    ds_read_b128 v[224:227], v249 offset:49152
    v_mfma_f32_16x16x32_bf16 v[72:75], v[196:199], v[216:219], v[72:75]
    ds_read_b64_tr_b16 v[194:195], v244 offset:2048
    v_mfma_f32_16x16x32_bf16 v[76:79], v[196:199], v[220:223], v[76:79]
    s_waitcnt lgkmcnt(5)
    v_mfma_f32_16x16x32_bf16 v[16:19], v[200:203], v[208:211], v[16:19]
    ds_read_b64_tr_b16 v[196:197], v245 offset:0
    v_mfma_f32_16x16x32_bf16 v[20:23], v[200:203], v[212:215], v[20:23]
    ds_read_b128 v[228:231], v249 offset:51200
    v_mfma_f32_16x16x32_bf16 v[80:83], v[200:203], v[216:219], v[80:83]
    ds_read_b64_tr_b16 v[198:199], v245 offset:2048
    v_mfma_f32_16x16x32_bf16 v[84:87], v[200:203], v[220:223], v[84:87]
    s_waitcnt lgkmcnt(6)
    v_mfma_f32_16x16x32_bf16 v[24:27], v[204:207], v[208:211], v[24:27]
    ds_read_b64_tr_b16 v[200:201], v246 offset:0
    v_mfma_f32_16x16x32_bf16 v[28:31], v[204:207], v[212:215], v[28:31]
    ds_read_b128 v[232:235], v249 offset:53248
    v_mfma_f32_16x16x32_bf16 v[88:91], v[204:207], v[216:219], v[88:91]
    ds_read_b64_tr_b16 v[202:203], v246 offset:2048
    v_mfma_f32_16x16x32_bf16 v[92:95], v[204:207], v[220:223], v[92:95]
    s_waitcnt lgkmcnt(6)
    v_mfma_f32_16x16x32_bf16 v[32:35], v[192:195], v[208:211], v[32:35]
    ds_read_b64_tr_b16 v[204:205], v247 offset:0
    v_mfma_f32_16x16x32_bf16 v[36:39], v[192:195], v[212:215], v[36:39]
    ds_read_b128 v[236:239], v249 offset:55296
    v_mfma_f32_16x16x32_bf16 v[96:99], v[192:195], v[216:219], v[96:99]
    ds_read_b64_tr_b16 v[206:207], v247 offset:2048
    v_mfma_f32_16x16x32_bf16 v[100:103], v[192:195], v[220:223], v[100:103]
    s_waitcnt lgkmcnt(6)
    v_mfma_f32_16x16x32_bf16 v[40:43], v[196:199], v[208:211], v[40:43]
    ds_read_b64_tr_b16 v[192:193], v240 offset:16384
    v_mfma_f32_16x16x32_bf16 v[44:47], v[196:199], v[212:215], v[44:47]
    v_mfma_f32_16x16x32_bf16 v[104:107], v[196:199], v[216:219], v[104:107]
    ds_read_b64_tr_b16 v[194:195], v240 offset:18432
    v_mfma_f32_16x16x32_bf16 v[108:111], v[196:199], v[220:223], v[108:111]
    s_waitcnt lgkmcnt(5)
    v_mfma_f32_16x16x32_bf16 v[48:51], v[200:203], v[208:211], v[48:51]
    ds_read_b64_tr_b16 v[196:197], v241 offset:16384
    v_mfma_f32_16x16x32_bf16 v[52:55], v[200:203], v[212:215], v[52:55]
    v_mfma_f32_16x16x32_bf16 v[112:115], v[200:203], v[216:219], v[112:115]
    ds_read_b64_tr_b16 v[198:199], v241 offset:18432
    v_mfma_f32_16x16x32_bf16 v[116:119], v[200:203], v[220:223], v[116:119]
    s_waitcnt lgkmcnt(4)
    v_mfma_f32_16x16x32_bf16 v[56:59], v[204:207], v[208:211], v[56:59]
    ds_read_b64_tr_b16 v[200:201], v242 offset:16384
    v_mfma_f32_16x16x32_bf16 v[60:63], v[204:207], v[212:215], v[60:63]
    v_mfma_f32_16x16x32_bf16 v[120:123], v[204:207], v[216:219], v[120:123]
    ds_read_b64_tr_b16 v[202:203], v242 offset:18432
    v_mfma_f32_16x16x32_bf16 v[124:127], v[204:207], v[220:223], v[124:127]
    s_barrier
    s_waitcnt lgkmcnt(4)
    v_mfma_f32_16x16x32_bf16 v[0:3], v[192:195], v[224:227], v[0:3]
    ds_read_b64_tr_b16 v[204:205], v243 offset:16384
    v_mfma_f32_16x16x32_bf16 v[4:7], v[192:195], v[228:231], v[4:7]
    v_mfma_f32_16x16x32_bf16 v[64:67], v[192:195], v[232:235], v[64:67]
    ds_read_b64_tr_b16 v[206:207], v243 offset:18432
    v_mfma_f32_16x16x32_bf16 v[68:71], v[192:195], v[236:239], v[68:71]
    s_waitcnt lgkmcnt(4)
    v_mfma_f32_16x16x32_bf16 v[8:11], v[196:199], v[224:227], v[8:11]
    ds_read_b64_tr_b16 v[192:193], v244 offset:16384
    v_mfma_f32_16x16x32_bf16 v[12:15], v[196:199], v[228:231], v[12:15]
    ds_read_b128 v[208:211], v248 offset:0
    v_mfma_f32_16x16x32_bf16 v[72:75], v[196:199], v[232:235], v[72:75]
    ds_read_b64_tr_b16 v[194:195], v244 offset:18432
    v_mfma_f32_16x16x32_bf16 v[76:79], v[196:199], v[236:239], v[76:79]
    s_waitcnt lgkmcnt(5)
    v_mfma_f32_16x16x32_bf16 v[16:19], v[200:203], v[224:227], v[16:19]
    ds_read_b64_tr_b16 v[196:197], v245 offset:16384
    v_mfma_f32_16x16x32_bf16 v[20:23], v[200:203], v[228:231], v[20:23]
    ds_read_b128 v[212:215], v248 offset:2048
    v_mfma_f32_16x16x32_bf16 v[80:83], v[200:203], v[232:235], v[80:83]
    ds_read_b64_tr_b16 v[198:199], v245 offset:18432
    v_mfma_f32_16x16x32_bf16 v[84:87], v[200:203], v[236:239], v[84:87]
    s_waitcnt lgkmcnt(6)
    v_mfma_f32_16x16x32_bf16 v[24:27], v[204:207], v[224:227], v[24:27]
    ds_read_b64_tr_b16 v[200:201], v246 offset:16384
    v_mfma_f32_16x16x32_bf16 v[28:31], v[204:207], v[228:231], v[28:31]
    ds_read_b128 v[216:219], v248 offset:4096
    v_mfma_f32_16x16x32_bf16 v[88:91], v[204:207], v[232:235], v[88:91]
    ds_read_b64_tr_b16 v[202:203], v246 offset:18432
    v_mfma_f32_16x16x32_bf16 v[92:95], v[204:207], v[236:239], v[92:95]
    s_waitcnt lgkmcnt(6)
    v_mfma_f32_16x16x32_bf16 v[32:35], v[192:195], v[224:227], v[32:35]
    ds_read_b64_tr_b16 v[204:205], v247 offset:16384
    v_mfma_f32_16x16x32_bf16 v[36:39], v[192:195], v[228:231], v[36:39]
    ds_read_b128 v[220:223], v248 offset:6144
    v_mfma_f32_16x16x32_bf16 v[96:99], v[192:195], v[232:235], v[96:99]
    ds_read_b64_tr_b16 v[206:207], v247 offset:18432
    v_mfma_f32_16x16x32_bf16 v[100:103], v[192:195], v[236:239], v[100:103]
    s_waitcnt lgkmcnt(6)
    v_mfma_f32_16x16x32_bf16 v[40:43], v[196:199], v[224:227], v[40:43]
    ds_read_b64_tr_b16 v[192:193], v240 offset:32768
    v_mfma_f32_16x16x32_bf16 v[44:47], v[196:199], v[228:231], v[44:47]
    v_mfma_f32_16x16x32_bf16 v[104:107], v[196:199], v[232:235], v[104:107]
    ds_read_b64_tr_b16 v[194:195], v240 offset:34816
    v_mfma_f32_16x16x32_bf16 v[108:111], v[196:199], v[236:239], v[108:111]
    s_waitcnt lgkmcnt(5)
    v_mfma_f32_16x16x32_bf16 v[48:51], v[200:203], v[224:227], v[48:51]
    ds_read_b64_tr_b16 v[196:197], v241 offset:32768
    v_mfma_f32_16x16x32_bf16 v[52:55], v[200:203], v[228:231], v[52:55]
    v_mfma_f32_16x16x32_bf16 v[112:115], v[200:203], v[232:235], v[112:115]
    ds_read_b64_tr_b16 v[198:199], v241 offset:34816
    v_mfma_f32_16x16x32_bf16 v[116:119], v[200:203], v[236:239], v[116:119]
    s_waitcnt lgkmcnt(4)
    v_mfma_f32_16x16x32_bf16 v[56:59], v[204:207], v[224:227], v[56:59]
    ds_read_b64_tr_b16 v[200:201], v242 offset:32768
    v_mfma_f32_16x16x32_bf16 v[60:63], v[204:207], v[228:231], v[60:63]
    v_mfma_f32_16x16x32_bf16 v[120:123], v[204:207], v[232:235], v[120:123]
    ds_read_b64_tr_b16 v[202:203], v242 offset:34816
    v_mfma_f32_16x16x32_bf16 v[124:127], v[204:207], v[236:239], v[124:127]
    s_barrier
    s_waitcnt lgkmcnt(4)
    v_mfma_f32_16x16x32_bf16 v[0:3], v[192:195], v[208:211], v[0:3]
    ds_read_b64_tr_b16 v[204:205], v243 offset:32768
    v_mfma_f32_16x16x32_bf16 v[4:7], v[192:195], v[212:215], v[4:7]
    v_mfma_f32_16x16x32_bf16 v[64:67], v[192:195], v[216:219], v[64:67]
    ds_read_b64_tr_b16 v[206:207], v243 offset:34816
    v_mfma_f32_16x16x32_bf16 v[68:71], v[192:195], v[220:223], v[68:71]
    s_waitcnt lgkmcnt(4)
    v_mfma_f32_16x16x32_bf16 v[8:11], v[196:199], v[208:211], v[8:11]
    ds_read_b64_tr_b16 v[192:193], v244 offset:32768
    v_mfma_f32_16x16x32_bf16 v[12:15], v[196:199], v[212:215], v[12:15]
    ds_read_b128 v[224:227], v249 offset:0
    v_mfma_f32_16x16x32_bf16 v[72:75], v[196:199], v[216:219], v[72:75]
    ds_read_b64_tr_b16 v[194:195], v244 offset:34816
    v_mfma_f32_16x16x32_bf16 v[76:79], v[196:199], v[220:223], v[76:79]
    s_waitcnt lgkmcnt(5)
    v_mfma_f32_16x16x32_bf16 v[16:19], v[200:203], v[208:211], v[16:19]
    ds_read_b64_tr_b16 v[196:197], v245 offset:32768
    v_mfma_f32_16x16x32_bf16 v[20:23], v[200:203], v[212:215], v[20:23]
    ds_read_b128 v[228:231], v249 offset:2048
    v_mfma_f32_16x16x32_bf16 v[80:83], v[200:203], v[216:219], v[80:83]
    ds_read_b64_tr_b16 v[198:199], v245 offset:34816
    v_mfma_f32_16x16x32_bf16 v[84:87], v[200:203], v[220:223], v[84:87]
    s_waitcnt lgkmcnt(6)
    v_mfma_f32_16x16x32_bf16 v[24:27], v[204:207], v[208:211], v[24:27]
    ds_read_b64_tr_b16 v[200:201], v246 offset:32768
    v_mfma_f32_16x16x32_bf16 v[28:31], v[204:207], v[212:215], v[28:31]
    ds_read_b128 v[232:235], v249 offset:4096
    v_mfma_f32_16x16x32_bf16 v[88:91], v[204:207], v[216:219], v[88:91]
    ds_read_b64_tr_b16 v[202:203], v246 offset:34816
    v_mfma_f32_16x16x32_bf16 v[92:95], v[204:207], v[220:223], v[92:95]
    s_waitcnt lgkmcnt(6)
    v_mfma_f32_16x16x32_bf16 v[32:35], v[192:195], v[208:211], v[32:35]
    ds_read_b64_tr_b16 v[204:205], v247 offset:32768
    v_mfma_f32_16x16x32_bf16 v[36:39], v[192:195], v[212:215], v[36:39]
    ds_read_b128 v[236:239], v249 offset:6144
    v_mfma_f32_16x16x32_bf16 v[96:99], v[192:195], v[216:219], v[96:99]
    ds_read_b64_tr_b16 v[206:207], v247 offset:34816
    v_mfma_f32_16x16x32_bf16 v[100:103], v[192:195], v[220:223], v[100:103]
    s_waitcnt lgkmcnt(6)
    v_mfma_f32_16x16x32_bf16 v[40:43], v[196:199], v[208:211], v[40:43]
    ds_read_b64_tr_b16 v[192:193], v240 offset:49152
    v_mfma_f32_16x16x32_bf16 v[44:47], v[196:199], v[212:215], v[44:47]
    v_mfma_f32_16x16x32_bf16 v[104:107], v[196:199], v[216:219], v[104:107]
    ds_read_b64_tr_b16 v[194:195], v240 offset:51200
    v_mfma_f32_16x16x32_bf16 v[108:111], v[196:199], v[220:223], v[108:111]
    s_waitcnt lgkmcnt(5)
    v_mfma_f32_16x16x32_bf16 v[48:51], v[200:203], v[208:211], v[48:51]
    ds_read_b64_tr_b16 v[196:197], v241 offset:49152
    v_mfma_f32_16x16x32_bf16 v[52:55], v[200:203], v[212:215], v[52:55]
    v_mfma_f32_16x16x32_bf16 v[112:115], v[200:203], v[216:219], v[112:115]
    ds_read_b64_tr_b16 v[198:199], v241 offset:51200
    v_mfma_f32_16x16x32_bf16 v[116:119], v[200:203], v[220:223], v[116:119]
    s_waitcnt lgkmcnt(4)
    v_mfma_f32_16x16x32_bf16 v[56:59], v[204:207], v[208:211], v[56:59]
    ds_read_b64_tr_b16 v[200:201], v242 offset:49152
    v_mfma_f32_16x16x32_bf16 v[60:63], v[204:207], v[212:215], v[60:63]
    v_mfma_f32_16x16x32_bf16 v[120:123], v[204:207], v[216:219], v[120:123]
    ds_read_b64_tr_b16 v[202:203], v242 offset:51200
    v_mfma_f32_16x16x32_bf16 v[124:127], v[204:207], v[220:223], v[124:127]
    s_barrier
    s_waitcnt lgkmcnt(4)
    v_mfma_f32_16x16x32_bf16 v[0:3], v[192:195], v[224:227], v[0:3]
    ds_read_b64_tr_b16 v[204:205], v243 offset:49152
    v_mfma_f32_16x16x32_bf16 v[4:7], v[192:195], v[228:231], v[4:7]
    v_mfma_f32_16x16x32_bf16 v[64:67], v[192:195], v[232:235], v[64:67]
    ds_read_b64_tr_b16 v[206:207], v243 offset:51200
    v_mfma_f32_16x16x32_bf16 v[68:71], v[192:195], v[236:239], v[68:71]
    s_waitcnt lgkmcnt(4)
    v_mfma_f32_16x16x32_bf16 v[8:11], v[196:199], v[224:227], v[8:11]
    ds_read_b64_tr_b16 v[192:193], v244 offset:49152
    v_mfma_f32_16x16x32_bf16 v[12:15], v[196:199], v[228:231], v[12:15]
    ds_read_b128 v[208:211], v248 offset:16384
    v_mfma_f32_16x16x32_bf16 v[72:75], v[196:199], v[232:235], v[72:75]
    ds_read_b64_tr_b16 v[194:195], v244 offset:51200
    v_mfma_f32_16x16x32_bf16 v[76:79], v[196:199], v[236:239], v[76:79]
    s_waitcnt lgkmcnt(5)
    v_mfma_f32_16x16x32_bf16 v[16:19], v[200:203], v[224:227], v[16:19]
    ds_read_b64_tr_b16 v[196:197], v245 offset:49152
    v_mfma_f32_16x16x32_bf16 v[20:23], v[200:203], v[228:231], v[20:23]
    ds_read_b128 v[212:215], v248 offset:18432
    v_mfma_f32_16x16x32_bf16 v[80:83], v[200:203], v[232:235], v[80:83]
    ds_read_b64_tr_b16 v[198:199], v245 offset:51200
    v_mfma_f32_16x16x32_bf16 v[84:87], v[200:203], v[236:239], v[84:87]
    s_waitcnt lgkmcnt(6)
    v_mfma_f32_16x16x32_bf16 v[24:27], v[204:207], v[224:227], v[24:27]
    ds_read_b64_tr_b16 v[200:201], v246 offset:49152
    v_mfma_f32_16x16x32_bf16 v[28:31], v[204:207], v[228:231], v[28:31]
    ds_read_b128 v[216:219], v248 offset:20480
    v_mfma_f32_16x16x32_bf16 v[88:91], v[204:207], v[232:235], v[88:91]
    ds_read_b64_tr_b16 v[202:203], v246 offset:51200
    v_mfma_f32_16x16x32_bf16 v[92:95], v[204:207], v[236:239], v[92:95]
    s_waitcnt lgkmcnt(6)
    v_mfma_f32_16x16x32_bf16 v[32:35], v[192:195], v[224:227], v[32:35]
    ds_read_b64_tr_b16 v[204:205], v247 offset:49152
    v_mfma_f32_16x16x32_bf16 v[36:39], v[192:195], v[228:231], v[36:39]
    ds_read_b128 v[220:223], v248 offset:22528
    v_mfma_f32_16x16x32_bf16 v[96:99], v[192:195], v[232:235], v[96:99]
    ds_read_b64_tr_b16 v[206:207], v247 offset:51200
    v_mfma_f32_16x16x32_bf16 v[100:103], v[192:195], v[236:239], v[100:103]
    s_waitcnt lgkmcnt(6)
    v_mfma_f32_16x16x32_bf16 v[40:43], v[196:199], v[224:227], v[40:43]
    v_add_u32 v240, 65536, v240
    v_add_u32 v241, 65536, v241
    v_add_u32 v242, 65536, v242
    v_add_u32 v243, 65536, v243
    v_add_u32 v244, 65536, v244
    v_add_u32 v245, 65536, v245
    v_add_u32 v246, 65536, v246
    v_add_u32 v247, 65536, v247
    ds_read_b64_tr_b16 v[192:193], v240 offset:0
    v_mfma_f32_16x16x32_bf16 v[44:47], v[196:199], v[228:231], v[44:47]
    v_mfma_f32_16x16x32_bf16 v[104:107], v[196:199], v[232:235], v[104:107]
    ds_read_b64_tr_b16 v[194:195], v240 offset:2048
    v_mfma_f32_16x16x32_bf16 v[108:111], v[196:199], v[236:239], v[108:111]
    s_waitcnt lgkmcnt(5)
    v_mfma_f32_16x16x32_bf16 v[48:51], v[200:203], v[224:227], v[48:51]
    ds_read_b64_tr_b16 v[196:197], v241 offset:0
    v_mfma_f32_16x16x32_bf16 v[52:55], v[200:203], v[228:231], v[52:55]
    v_mfma_f32_16x16x32_bf16 v[112:115], v[200:203], v[232:235], v[112:115]
    ds_read_b64_tr_b16 v[198:199], v241 offset:2048
    v_mfma_f32_16x16x32_bf16 v[116:119], v[200:203], v[236:239], v[116:119]
    s_waitcnt lgkmcnt(4)
    v_mfma_f32_16x16x32_bf16 v[56:59], v[204:207], v[224:227], v[56:59]
    ds_read_b64_tr_b16 v[200:201], v242 offset:0
    v_mfma_f32_16x16x32_bf16 v[60:63], v[204:207], v[228:231], v[60:63]
    v_mfma_f32_16x16x32_bf16 v[120:123], v[204:207], v[232:235], v[120:123]
    ds_read_b64_tr_b16 v[202:203], v242 offset:2048
    v_mfma_f32_16x16x32_bf16 v[124:127], v[204:207], v[236:239], v[124:127]
    s_barrier
    s_waitcnt lgkmcnt(4)
    v_mfma_f32_16x16x32_bf16 v[0:3], v[192:195], v[208:211], v[0:3]
    ds_read_b64_tr_b16 v[204:205], v243 offset:0
    v_mfma_f32_16x16x32_bf16 v[4:7], v[192:195], v[212:215], v[4:7]
    v_mfma_f32_16x16x32_bf16 v[64:67], v[192:195], v[216:219], v[64:67]
    ds_read_b64_tr_b16 v[206:207], v243 offset:2048
    v_mfma_f32_16x16x32_bf16 v[68:71], v[192:195], v[220:223], v[68:71]
    s_waitcnt lgkmcnt(4)
    v_mfma_f32_16x16x32_bf16 v[8:11], v[196:199], v[208:211], v[8:11]
    ds_read_b64_tr_b16 v[192:193], v244 offset:0
    v_mfma_f32_16x16x32_bf16 v[12:15], v[196:199], v[212:215], v[12:15]
    ds_read_b128 v[224:227], v249 offset:16384
    v_mfma_f32_16x16x32_bf16 v[72:75], v[196:199], v[216:219], v[72:75]
    ds_read_b64_tr_b16 v[194:195], v244 offset:2048
    v_mfma_f32_16x16x32_bf16 v[76:79], v[196:199], v[220:223], v[76:79]
    s_waitcnt lgkmcnt(5)
    v_mfma_f32_16x16x32_bf16 v[16:19], v[200:203], v[208:211], v[16:19]
    ds_read_b64_tr_b16 v[196:197], v245 offset:0
    v_mfma_f32_16x16x32_bf16 v[20:23], v[200:203], v[212:215], v[20:23]
    ds_read_b128 v[228:231], v249 offset:18432
    v_mfma_f32_16x16x32_bf16 v[80:83], v[200:203], v[216:219], v[80:83]
    ds_read_b64_tr_b16 v[198:199], v245 offset:2048
    v_mfma_f32_16x16x32_bf16 v[84:87], v[200:203], v[220:223], v[84:87]
    s_waitcnt lgkmcnt(6)
    v_mfma_f32_16x16x32_bf16 v[24:27], v[204:207], v[208:211], v[24:27]
    ds_read_b64_tr_b16 v[200:201], v246 offset:0
    v_mfma_f32_16x16x32_bf16 v[28:31], v[204:207], v[212:215], v[28:31]
    ds_read_b128 v[232:235], v249 offset:20480
    v_mfma_f32_16x16x32_bf16 v[88:91], v[204:207], v[216:219], v[88:91]
    ds_read_b64_tr_b16 v[202:203], v246 offset:2048
    v_mfma_f32_16x16x32_bf16 v[92:95], v[204:207], v[220:223], v[92:95]
    s_waitcnt lgkmcnt(6)
    v_mfma_f32_16x16x32_bf16 v[32:35], v[192:195], v[208:211], v[32:35]
    ds_read_b64_tr_b16 v[204:205], v247 offset:0
    v_mfma_f32_16x16x32_bf16 v[36:39], v[192:195], v[212:215], v[36:39]
    ds_read_b128 v[236:239], v249 offset:22528
    v_mfma_f32_16x16x32_bf16 v[96:99], v[192:195], v[216:219], v[96:99]
    ds_read_b64_tr_b16 v[206:207], v247 offset:2048
    v_mfma_f32_16x16x32_bf16 v[100:103], v[192:195], v[220:223], v[100:103]
    s_waitcnt lgkmcnt(6)
    v_mfma_f32_16x16x32_bf16 v[40:43], v[196:199], v[208:211], v[40:43]
    ds_read_b64_tr_b16 v[192:193], v240 offset:16384
    v_mfma_f32_16x16x32_bf16 v[44:47], v[196:199], v[212:215], v[44:47]
    v_mfma_f32_16x16x32_bf16 v[104:107], v[196:199], v[216:219], v[104:107]
    ds_read_b64_tr_b16 v[194:195], v240 offset:18432
    v_mfma_f32_16x16x32_bf16 v[108:111], v[196:199], v[220:223], v[108:111]
    s_waitcnt lgkmcnt(5)
    v_mfma_f32_16x16x32_bf16 v[48:51], v[200:203], v[208:211], v[48:51]
    ds_read_b64_tr_b16 v[196:197], v241 offset:16384
    v_mfma_f32_16x16x32_bf16 v[52:55], v[200:203], v[212:215], v[52:55]
    v_mfma_f32_16x16x32_bf16 v[112:115], v[200:203], v[216:219], v[112:115]
    ds_read_b64_tr_b16 v[198:199], v241 offset:18432
    v_mfma_f32_16x16x32_bf16 v[116:119], v[200:203], v[220:223], v[116:119]
    s_waitcnt lgkmcnt(4)
    v_mfma_f32_16x16x32_bf16 v[56:59], v[204:207], v[208:211], v[56:59]
    ds_read_b64_tr_b16 v[200:201], v242 offset:16384
    v_mfma_f32_16x16x32_bf16 v[60:63], v[204:207], v[212:215], v[60:63]
    v_mfma_f32_16x16x32_bf16 v[120:123], v[204:207], v[216:219], v[120:123]
    ds_read_b64_tr_b16 v[202:203], v242 offset:18432
    v_mfma_f32_16x16x32_bf16 v[124:127], v[204:207], v[220:223], v[124:127]
    s_barrier
    s_waitcnt lgkmcnt(4)
    v_mfma_f32_16x16x32_bf16 v[0:3], v[192:195], v[224:227], v[0:3]
    ds_read_b64_tr_b16 v[204:205], v243 offset:16384
    v_mfma_f32_16x16x32_bf16 v[4:7], v[192:195], v[228:231], v[4:7]
    v_mfma_f32_16x16x32_bf16 v[64:67], v[192:195], v[232:235], v[64:67]
    ds_read_b64_tr_b16 v[206:207], v243 offset:18432
    v_mfma_f32_16x16x32_bf16 v[68:71], v[192:195], v[236:239], v[68:71]
    s_waitcnt lgkmcnt(4)
    v_mfma_f32_16x16x32_bf16 v[8:11], v[196:199], v[224:227], v[8:11]
    ds_read_b64_tr_b16 v[192:193], v244 offset:16384
    v_mfma_f32_16x16x32_bf16 v[12:15], v[196:199], v[228:231], v[12:15]
    v_mfma_f32_16x16x32_bf16 v[72:75], v[196:199], v[232:235], v[72:75]
    ds_read_b64_tr_b16 v[194:195], v244 offset:18432
    v_mfma_f32_16x16x32_bf16 v[76:79], v[196:199], v[236:239], v[76:79]
    v_cvt_pk_bf16_f32 v0, v0, v1
    v_cvt_pk_bf16_f32 v1, v2, v3
    s_waitcnt lgkmcnt(4)
    v_mfma_f32_16x16x32_bf16 v[16:19], v[200:203], v[224:227], v[16:19]
    ds_read_b64_tr_b16 v[196:197], v245 offset:16384
    v_mfma_f32_16x16x32_bf16 v[20:23], v[200:203], v[228:231], v[20:23]
    v_cvt_pk_bf16_f32 v2, v8, v9
    v_cvt_pk_bf16_f32 v3, v10, v11
    v_mfma_f32_16x16x32_bf16 v[80:83], v[200:203], v[232:235], v[80:83]
    ds_read_b64_tr_b16 v[198:199], v245 offset:18432
    v_cvt_pk_bf16_f32 v4, v4, v5
    v_mfma_f32_16x16x32_bf16 v[84:87], v[200:203], v[236:239], v[84:87]
    v_cvt_pk_bf16_f32 v5, v6, v7
    v_cvt_pk_bf16_f32 v6, v12, v13
    s_waitcnt lgkmcnt(4)
    v_mfma_f32_16x16x32_bf16 v[24:27], v[204:207], v[224:227], v[24:27]
    ds_read_b64_tr_b16 v[200:201], v246 offset:16384
    v_mfma_f32_16x16x32_bf16 v[28:31], v[204:207], v[228:231], v[28:31]
    v_cvt_pk_bf16_f32 v7, v14, v15
    v_cvt_pk_bf16_f32 v64, v64, v65
    v_mfma_f32_16x16x32_bf16 v[88:91], v[204:207], v[232:235], v[88:91]
    ds_read_b64_tr_b16 v[202:203], v246 offset:18432
    v_cvt_pk_bf16_f32 v65, v66, v67
    v_mfma_f32_16x16x32_bf16 v[92:95], v[204:207], v[236:239], v[92:95]
    v_cvt_pk_bf16_f32 v66, v72, v73
    v_cvt_pk_bf16_f32 v67, v74, v75
    s_waitcnt lgkmcnt(4)
    v_mfma_f32_16x16x32_bf16 v[32:35], v[192:195], v[224:227], v[32:35]
    ds_read_b64_tr_b16 v[204:205], v247 offset:16384
    v_mfma_f32_16x16x32_bf16 v[36:39], v[192:195], v[228:231], v[36:39]
    v_cvt_pk_bf16_f32 v68, v68, v69
    v_cvt_pk_bf16_f32 v69, v70, v71
    v_mfma_f32_16x16x32_bf16 v[96:99], v[192:195], v[232:235], v[96:99]
    ds_read_b64_tr_b16 v[206:207], v247 offset:18432
    v_cvt_pk_bf16_f32 v70, v76, v77
    v_mfma_f32_16x16x32_bf16 v[100:103], v[192:195], v[236:239], v[100:103]
    v_cvt_pk_bf16_f32 v71, v78, v79
    v_cvt_pk_bf16_f32 v16, v16, v17
    s_waitcnt lgkmcnt(4)
    v_mfma_f32_16x16x32_bf16 v[40:43], v[196:199], v[224:227], v[40:43]
    v_cvt_pk_bf16_f32 v17, v18, v19
    v_mfma_f32_16x16x32_bf16 v[44:47], v[196:199], v[228:231], v[44:47]
    v_cvt_pk_bf16_f32 v18, v24, v25
    v_cvt_pk_bf16_f32 v19, v26, v27
    v_mfma_f32_16x16x32_bf16 v[104:107], v[196:199], v[232:235], v[104:107]
    v_cvt_pk_bf16_f32 v20, v20, v21
    v_cvt_pk_bf16_f32 v21, v22, v23
    v_mfma_f32_16x16x32_bf16 v[108:111], v[196:199], v[236:239], v[108:111]
    v_cvt_pk_bf16_f32 v22, v28, v29
    v_cvt_pk_bf16_f32 v23, v30, v31
    s_waitcnt lgkmcnt(2)
    v_mfma_f32_16x16x32_bf16 v[48:51], v[200:203], v[224:227], v[48:51]
    v_cvt_pk_bf16_f32 v80, v80, v81
    v_mfma_f32_16x16x32_bf16 v[52:55], v[200:203], v[228:231], v[52:55]
    v_cvt_pk_bf16_f32 v81, v82, v83
    v_cvt_pk_bf16_f32 v82, v88, v89
    v_mfma_f32_16x16x32_bf16 v[112:115], v[200:203], v[232:235], v[112:115]
    v_cvt_pk_bf16_f32 v83, v90, v91
    v_cvt_pk_bf16_f32 v84, v84, v85
    v_mfma_f32_16x16x32_bf16 v[116:119], v[200:203], v[236:239], v[116:119]
    v_cvt_pk_bf16_f32 v85, v86, v87
    v_cvt_pk_bf16_f32 v86, v92, v93
    s_waitcnt lgkmcnt(0)
    v_mfma_f32_16x16x32_bf16 v[56:59], v[204:207], v[224:227], v[56:59]
    v_cvt_pk_bf16_f32 v87, v94, v95
    v_mfma_f32_16x16x32_bf16 v[60:63], v[204:207], v[228:231], v[60:63]
    v_cvt_pk_bf16_f32 v32, v32, v33
    v_cvt_pk_bf16_f32 v33, v34, v35
    v_mfma_f32_16x16x32_bf16 v[120:123], v[204:207], v[232:235], v[120:123]
    v_cvt_pk_bf16_f32 v34, v40, v41
    v_cvt_pk_bf16_f32 v35, v42, v43
    v_mfma_f32_16x16x32_bf16 v[124:127], v[204:207], v[236:239], v[124:127]
    v_cvt_pk_bf16_f32 v36, v36, v37
    v_cvt_pk_bf16_f32 v37, v38, v39
    s_waitcnt lgkmcnt(0)
    s_barrier
    ds_read_b64 v[128:129], v160 offset:32768
    ds_read_b64 v[130:131], v161 offset:32768
    ds_read_b64 v[144:145], v160 offset:34816
    ds_read_b64 v[146:147], v161 offset:34816
    ds_read_b64 v[132:133], v162 offset:32768
    ds_read_b64 v[134:135], v163 offset:32768
    ds_read_b64 v[148:149], v162 offset:34816
    ds_read_b64 v[150:151], v163 offset:34816
    v_cvt_pk_bf16_f32 v38, v44, v45
    v_cvt_pk_bf16_f32 v39, v46, v47
    v_cvt_pk_bf16_f32 v96, v96, v97
    v_cvt_pk_bf16_f32 v97, v98, v99
    v_cvt_pk_bf16_f32 v98, v104, v105
    v_cvt_pk_bf16_f32 v99, v106, v107
    v_cvt_pk_bf16_f32 v100, v100, v101
    v_cvt_pk_bf16_f32 v101, v102, v103
    v_cvt_pk_bf16_f32 v102, v108, v109
    v_cvt_pk_bf16_f32 v103, v110, v111
    v_cvt_pk_bf16_f32 v48, v48, v49
    v_cvt_pk_bf16_f32 v49, v50, v51
    v_cvt_pk_bf16_f32 v50, v56, v57
    v_cvt_pk_bf16_f32 v51, v58, v59
    v_cvt_pk_bf16_f32 v52, v52, v53
    v_cvt_pk_bf16_f32 v53, v54, v55
    v_cvt_pk_bf16_f32 v54, v60, v61
    v_cvt_pk_bf16_f32 v55, v62, v63
    s_waitcnt lgkmcnt(4)
    v_mfma_f32_16x16x32_bf16 v[192:195], v[128:131], v[0:3], 0
    ds_read_b64 v[136:137], v164 offset:0
    ds_read_b64 v[138:139], v165 offset:0
    v_mfma_f32_16x16x32_bf16 v[200:203], v[128:131], v[4:7], 0
    ds_read_b64 v[152:153], v164 offset:2048
    ds_read_b64 v[154:155], v165 offset:2048
    v_mfma_f32_16x16x32_bf16 v[196:199], v[144:147], v[0:3], 0
    ds_read_b64 v[140:141], v166 offset:0
    ds_read_b64 v[142:143], v167 offset:0
    v_mfma_f32_16x16x32_bf16 v[204:207], v[144:147], v[4:7], 0
    ds_read_b64 v[156:157], v166 offset:2048
    ds_read_b64 v[158:159], v167 offset:2048
    s_waitcnt lgkmcnt(8)
    v_mfma_f32_16x16x32_bf16 v[192:195], v[132:135], v[16:19], v[192:195]
    v_cvt_pk_bf16_f32 v112, v112, v113
    v_mfma_f32_16x16x32_bf16 v[200:203], v[132:135], v[20:23], v[200:203]
    v_cvt_pk_bf16_f32 v113, v114, v115
    v_cvt_pk_bf16_f32 v114, v120, v121
    v_mfma_f32_16x16x32_bf16 v[196:199], v[148:151], v[16:19], v[196:199]
    v_cvt_pk_bf16_f32 v115, v122, v123
    v_cvt_pk_bf16_f32 v116, v116, v117
    v_mfma_f32_16x16x32_bf16 v[204:207], v[148:151], v[20:23], v[204:207]
    v_cvt_pk_bf16_f32 v117, v118, v119
    v_cvt_pk_bf16_f32 v118, v124, v125
    s_waitcnt lgkmcnt(4)
    v_mfma_f32_16x16x32_bf16 v[192:195], v[136:139], v[32:35], v[192:195]
    v_cvt_pk_bf16_f32 v119, v126, v127
    v_mfma_f32_16x16x32_bf16 v[200:203], v[136:139], v[36:39], v[200:203]
    v_mfma_f32_16x16x32_bf16 v[196:199], v[152:155], v[32:35], v[196:199]
    v_mfma_f32_16x16x32_bf16 v[204:207], v[152:155], v[36:39], v[204:207]
    s_waitcnt lgkmcnt(0)
    v_mfma_f32_16x16x32_bf16 v[192:195], v[140:143], v[48:51], v[192:195]
    v_mfma_f32_16x16x32_bf16 v[200:203], v[140:143], v[52:55], v[200:203]
    v_mfma_f32_16x16x32_bf16 v[196:199], v[156:159], v[48:51], v[196:199]
    v_mfma_f32_16x16x32_bf16 v[204:207], v[156:159], v[52:55], v[204:207]
    v_mov_b32 v216, v160
    v_mov_b32 v217, v161
    v_mov_b32 v218, v162
    v_mov_b32 v219, v163
    v_mov_b32 v220, v164
    v_mov_b32 v221, v165
    v_mov_b32 v222, v166
    v_mov_b32 v223, v167
    s_and_b32 s16, s3, 1
    s_lshl_b32 s16, s16, 12
    v_add_u32 v248, s16, v248
    v_xor_b32 v248, s42, v248
    v_xor_b32 v249, 64, v248
    v_max3_f32 v16, v192, v193, v194
    v_max3_f32 v17, v200, v201, v202
    v_max3_f32 v16, v16, v195, v196
    v_max3_f32 v17, v17, v203, v204
    v_max3_f32 v16, v16, v197, v198
    v_max3_f32 v17, v17, v205, v206
    v_max_f32 v16, v16, v199
    v_max_f32 v17, v17, v207
    s_nop 1
    v_permlane16_swap_b32 v16, v17
    v_max_f32 v18, v16, v17
    v_mov_b32 v19, v18
    s_nop 1
    v_permlane32_swap_b32 v18, v19
    v_max_f32 v18, v18, v19
    v_mul_f32 v18, s8, v18
    v_mov_b32 v19, v18
    s_nop 1
    v_permlane16_swap_b32 v18, v19
    v_fma_f32 v192, v192, s8, -v18
    v_fma_f32 v193, v193, s8, -v18
    v_fma_f32 v194, v194, s8, -v18
    v_exp_f32 v192, v192
    v_fma_f32 v195, v195, s8, -v18
    v_exp_f32 v193, v193
    v_fma_f32 v196, v196, s8, -v18
    v_exp_f32 v194, v194
    v_fma_f32 v197, v197, s8, -v18
    v_exp_f32 v195, v195
    v_fma_f32 v198, v198, s8, -v18
    v_exp_f32 v196, v196
    v_fma_f32 v199, v199, s8, -v18
    v_exp_f32 v197, v197
    v_fma_f32 v200, v200, s8, -v19
    v_exp_f32 v198, v198
    v_fma_f32 v201, v201, s8, -v19
    v_exp_f32 v199, v199
    v_fma_f32 v202, v202, s8, -v19
    v_exp_f32 v200, v200
    v_fma_f32 v203, v203, s8, -v19
    v_exp_f32 v201, v201
    v_fma_f32 v204, v204, s8, -v19
    v_exp_f32 v202, v202
    s_barrier
    ds_read_b64 v[160:161], v216 offset:49152
    ds_read_b64 v[162:163], v217 offset:49152
    ds_read_b64 v[176:177], v216 offset:51200
    ds_read_b64 v[178:179], v217 offset:51200
    ds_read_b64 v[164:165], v218 offset:49152
    ds_read_b64 v[166:167], v219 offset:49152
    ds_read_b64 v[180:181], v218 offset:51200
    ds_read_b64 v[182:183], v219 offset:51200
    s_waitcnt lgkmcnt(4)
    v_mfma_f32_16x16x32_bf16 v[0:3], v[160:163], v[64:67], 0
    ds_read_b64 v[168:169], v220 offset:16384
    ds_read_b64 v[170:171], v221 offset:16384
    v_mfma_f32_16x16x32_bf16 v[8:11], v[160:163], v[68:71], 0
    ds_read_b64 v[184:185], v220 offset:18432
    ds_read_b64 v[186:187], v221 offset:18432
    v_mfma_f32_16x16x32_bf16 v[4:7], v[176:179], v[64:67], 0
    ds_read_b64 v[172:173], v222 offset:16384
    ds_read_b64 v[174:175], v223 offset:16384
    v_mfma_f32_16x16x32_bf16 v[12:15], v[176:179], v[68:71], 0
    ds_read_b64 v[188:189], v222 offset:18432
    ds_read_b64 v[190:191], v223 offset:18432
    s_waitcnt lgkmcnt(8)
    v_mfma_f32_16x16x32_bf16 v[0:3], v[164:167], v[80:83], v[0:3]
    v_fma_f32 v205, v205, s8, -v19
    v_mfma_f32_16x16x32_bf16 v[8:11], v[164:167], v[84:87], v[8:11]
    v_exp_f32 v203, v203
    v_mfma_f32_16x16x32_bf16 v[4:7], v[180:183], v[80:83], v[4:7]
    v_fma_f32 v206, v206, s8, -v19
    v_mfma_f32_16x16x32_bf16 v[12:15], v[180:183], v[84:87], v[12:15]
    v_exp_f32 v204, v204
    s_waitcnt lgkmcnt(4)
    v_mfma_f32_16x16x32_bf16 v[0:3], v[168:171], v[96:99], v[0:3]
    v_fma_f32 v207, v207, s8, -v19
    v_mfma_f32_16x16x32_bf16 v[8:11], v[168:171], v[100:103], v[8:11]
    v_exp_f32 v205, v205
    v_mfma_f32_16x16x32_bf16 v[4:7], v[184:187], v[96:99], v[4:7]
    v_exp_f32 v206, v206
    v_mfma_f32_16x16x32_bf16 v[12:15], v[184:187], v[100:103], v[12:15]
    v_exp_f32 v207, v207
    s_waitcnt lgkmcnt(0)
    v_mfma_f32_16x16x32_bf16 v[0:3], v[172:175], v[112:115], v[0:3]
    v_add_f32 v16, v192, v193
    v_mfma_f32_16x16x32_bf16 v[8:11], v[172:175], v[116:119], v[8:11]
    v_add_f32 v17, v200, v201
    v_add_f32 v16, v16, v194
    v_mfma_f32_16x16x32_bf16 v[4:7], v[188:191], v[112:115], v[4:7]
    v_add_f32 v17, v17, v202
    v_add_f32 v16, v16, v195
    v_mfma_f32_16x16x32_bf16 v[12:15], v[188:191], v[116:119], v[12:15]
    v_add_f32 v17, v17, v203
    v_add_f32 v16, v16, v196
    v_add_f32 v17, v17, v204
    v_add_f32 v16, v16, v197
    v_add_f32 v17, v17, v205
    v_add_f32 v16, v16, v198
    v_add_f32 v17, v17, v206
    v_add_f32 v16, v16, v199
    v_add_f32 v17, v17, v207
    s_nop 1
    v_permlane16_swap_b32 v16, v17
    v_add_f32 v18, v16, v17
    v_mov_b32 v19, v18
    s_nop 1
    v_permlane32_swap_b32 v18, v19
    v_add_f32 v18, v18, v19
    v_rcp_f32 v18, v18
    s_nop 0
    v_mov_b32 v19, v18
    s_nop 1
    v_permlane16_swap_b32 v18, v19
    v_mul_f32 v192, v192, v18
    v_mul_f32 v193, v193, v18
    v_mul_f32 v194, v194, v18
    v_mul_f32 v195, v195, v18
    v_cvt_pk_bf16_f32 v24, v192, v193
    v_mul_f32 v196, v196, v18
    v_mul_f32 v197, v197, v18
    v_cvt_pk_bf16_f32 v25, v194, v195
    v_mul_f32 v198, v198, v18
    v_mul_f32 v199, v199, v18
    v_cvt_pk_bf16_f32 v26, v196, v197
    v_mul_f32 v200, v200, v19
    v_mul_f32 v201, v201, v19
    v_cvt_pk_bf16_f32 v27, v198, v199
    v_mul_f32 v202, v202, v19
    v_mul_f32 v203, v203, v19
    v_cvt_pk_bf16_f32 v28, v200, v201
    v_mul_f32 v204, v204, v19
    v_mul_f32 v205, v205, v19
    v_cvt_pk_bf16_f32 v29, v202, v203
    v_mul_f32 v206, v206, v19
    v_mul_f32 v207, v207, v19
    v_cvt_pk_bf16_f32 v30, v204, v205
    v_cvt_pk_bf16_f32 v31, v206, v207
    buffer_store_dwordx4 v[24:27], v252, s[64:67], s10 offen offset:0 sc1
    buffer_store_dwordx4 v[28:31], v252, s[64:67], s10 offen offset:1024 sc1
    v_max3_f32 v20, v0, v1, v2
    v_max3_f32 v21, v8, v9, v10
    v_max3_f32 v20, v20, v3, v4
    v_max3_f32 v21, v21, v11, v12
    v_max3_f32 v20, v20, v5, v6
    v_max3_f32 v21, v21, v13, v14
    v_max_f32 v20, v20, v7
    v_max_f32 v21, v21, v15
    s_nop 1
    v_permlane16_swap_b32 v20, v21
    v_max_f32 v22, v20, v21
    v_mov_b32 v23, v22
    s_nop 1
    v_permlane32_swap_b32 v22, v23
    v_max_f32 v22, v22, v23
    v_mul_f32 v22, s8, v22
    v_mov_b32 v23, v22
    s_nop 1
    v_permlane16_swap_b32 v22, v23
    v_fma_f32 v0, v0, s8, -v22
    v_fma_f32 v1, v1, s8, -v22
    v_fma_f32 v2, v2, s8, -v22
    v_exp_f32 v0, v0
    v_fma_f32 v3, v3, s8, -v22
    v_exp_f32 v1, v1
    v_fma_f32 v4, v4, s8, -v22
    v_exp_f32 v2, v2
    v_fma_f32 v5, v5, s8, -v22
    v_exp_f32 v3, v3
    v_fma_f32 v6, v6, s8, -v22
    v_exp_f32 v4, v4
    v_fma_f32 v7, v7, s8, -v22
    v_exp_f32 v5, v5
    v_fma_f32 v8, v8, s8, -v23
    v_exp_f32 v6, v6
    v_fma_f32 v9, v9, s8, -v23
    v_exp_f32 v7, v7
    v_fma_f32 v10, v10, s8, -v23
    v_exp_f32 v8, v8
    v_fma_f32 v11, v11, s8, -v23
    v_exp_f32 v9, v9
    v_fma_f32 v12, v12, s8, -v23
    v_exp_f32 v10, v10
    v_fma_f32 v13, v13, s8, -v23
    v_exp_f32 v11, v11
    v_fma_f32 v14, v14, s8, -v23
    v_exp_f32 v12, v12
    v_fma_f32 v15, v15, s8, -v23
    v_exp_f32 v13, v13
    v_exp_f32 v14, v14
    v_exp_f32 v15, v15
    v_add_f32 v20, v0, v1
    v_add_f32 v21, v8, v9
L_at_C0:
    s_barrier
    ds_read_b128 v[208:211], v248 offset:0
    ds_read_b128 v[212:215], v248 offset:2048
    ds_read_b64_tr_b16 v[224:225], v250 offset:20480
    ds_read_b64_tr_b16 v[226:227], v250 offset:21760
    ds_read_b64_tr_b16 v[228:229], v251 offset:20480
    ds_read_b64_tr_b16 v[230:231], v251 offset:21760
    ds_read_b64_tr_b16 v[232:233], v250 offset:20544
    ds_read_b64_tr_b16 v[234:235], v250 offset:21824
    ds_read_b64_tr_b16 v[236:237], v251 offset:20544
    ds_read_b64_tr_b16 v[238:239], v251 offset:21824
    ds_read_b64_tr_b16 v[240:241], v250 offset:20608
    ds_read_b64_tr_b16 v[242:243], v250 offset:21888
    s_add_u32 s14, s6, s7
    s_and_b32 s14, s14, 3
    s_lshl_b32 s14, s14, 2
    s_lshr_b32 s18, 0x1010, s14
    s_and_b32 s18, s18, 15
    s_waitcnt lgkmcnt(8)
    v_mfma_f32_16x16x32_bf16 v[80:83], v[208:211], v[224:227], 0
    ds_read_b64_tr_b16 v[244:245], v251 offset:20608
    v_mfma_f32_16x16x32_bf16 v[84:87], v[212:215], v[224:227], 0
    ds_read_b64_tr_b16 v[246:247], v251 offset:21888
    s_waitcnt lgkmcnt(8)
    v_mfma_f32_16x16x32_bf16 v[88:91], v[208:211], v[228:231], 0
    ds_read_b128 v[216:219], v249 offset:0
    ds_read_b64_tr_b16 v[224:225], v250 offset:20672
    v_add_f32 v20, v20, v2
    v_mfma_f32_16x16x32_bf16 v[92:95], v[212:215], v[228:231], 0
    ds_read_b128 v[220:223], v249 offset:2048
    ds_read_b64_tr_b16 v[226:227], v250 offset:21952
    v_add_f32 v21, v21, v10
    v_add_f32 v20, v20, v3
    s_waitcnt lgkmcnt(10)
    v_mfma_f32_16x16x32_bf16 v[96:99], v[208:211], v[232:235], 0
    ds_read_b64_tr_b16 v[228:229], v251 offset:20672
    v_add_f32 v21, v21, v11
    v_add_f32 v20, v20, v4
    v_mfma_f32_16x16x32_bf16 v[100:103], v[212:215], v[232:235], 0
    ds_read_b64_tr_b16 v[230:231], v251 offset:21952
    v_add_f32 v21, v21, v12
    v_add_f32 v20, v20, v5
    v_add_f32 v21, v21, v13
    s_waitcnt lgkmcnt(10)
    v_mfma_f32_16x16x32_bf16 v[104:107], v[208:211], v[236:239], 0
    ds_read_b64_tr_b16 v[232:233], v250 offset:20736
    v_add_f32 v20, v20, v6
    v_add_f32 v21, v21, v14
    v_mfma_f32_16x16x32_bf16 v[108:111], v[212:215], v[236:239], 0
    ds_read_b64_tr_b16 v[234:235], v250 offset:22016
    v_add_f32 v20, v20, v7
    v_add_f32 v21, v21, v15
    s_nop 1
    v_permlane16_swap_b32 v20, v21
    s_waitcnt lgkmcnt(10)
    v_mfma_f32_16x16x32_bf16 v[112:115], v[208:211], v[240:243], 0
    ds_read_b64_tr_b16 v[236:237], v251 offset:20736
    v_add_f32 v22, v20, v21
    v_mov_b32 v23, v22
    v_mfma_f32_16x16x32_bf16 v[116:119], v[212:215], v[240:243], 0
    ds_read_b64_tr_b16 v[238:239], v251 offset:22016
    v_permlane32_swap_b32 v22, v23
    v_add_f32 v22, v22, v23
    s_waitcnt lgkmcnt(10)
    v_mfma_f32_16x16x32_bf16 v[120:123], v[208:211], v[244:247], 0
    ds_read_b64_tr_b16 v[240:241], v250 offset:30720
    v_rcp_f32 v22, v22
    v_mfma_f32_16x16x32_bf16 v[124:127], v[212:215], v[244:247], 0
    ds_read_b64_tr_b16 v[242:243], v250 offset:32000
    v_mov_b32 v23, v22
    s_nop 1
    v_permlane16_swap_b32 v22, v23
    v_mul_f32 v0, v0, v22
    s_waitcnt lgkmcnt(8)
    v_mfma_f32_16x16x32_bf16 v[128:131], v[208:211], v[224:227], 0
    ds_read_b64_tr_b16 v[244:245], v251 offset:30720
    v_mul_f32 v1, v1, v22
    v_mul_f32 v2, v2, v22
    v_mfma_f32_16x16x32_bf16 v[132:135], v[212:215], v[224:227], 0
    ds_read_b64_tr_b16 v[246:247], v251 offset:32000
    v_mul_f32 v3, v3, v22
    v_cvt_pk_bf16_f32 v40, v0, v1
    v_mul_f32 v4, v4, v22
    s_waitcnt lgkmcnt(8)
    v_mfma_f32_16x16x32_bf16 v[136:139], v[208:211], v[228:231], 0
    ds_read_b64_tr_b16 v[224:225], v250 offset:30784
    v_mul_f32 v5, v5, v22
    v_cvt_pk_bf16_f32 v41, v2, v3
    v_mfma_f32_16x16x32_bf16 v[140:143], v[212:215], v[228:231], 0
    ds_read_b64_tr_b16 v[226:227], v250 offset:32064
    v_mul_f32 v6, v6, v22
    v_mul_f32 v7, v7, v22
    v_cvt_pk_bf16_f32 v42, v4, v5
    s_waitcnt lgkmcnt(8)
    v_mfma_f32_16x16x32_bf16 v[144:147], v[208:211], v[232:235], 0
    ds_read_b64_tr_b16 v[228:229], v251 offset:30784
    v_mul_f32 v8, v8, v23
    v_mul_f32 v9, v9, v23
    v_mfma_f32_16x16x32_bf16 v[148:151], v[212:215], v[232:235], 0
    ds_read_b64_tr_b16 v[230:231], v251 offset:32064
    v_cvt_pk_bf16_f32 v43, v6, v7
    v_mul_f32 v10, v10, v23
    v_mul_f32 v11, v11, v23
    s_waitcnt lgkmcnt(8)
    v_mfma_f32_16x16x32_bf16 v[152:155], v[208:211], v[236:239], 0
    ds_read_b64_tr_b16 v[232:233], v250 offset:30848
    v_cvt_pk_bf16_f32 v44, v8, v9
    v_mul_f32 v12, v12, v23
    v_mfma_f32_16x16x32_bf16 v[156:159], v[212:215], v[236:239], 0
    ds_read_b64_tr_b16 v[234:235], v250 offset:32128
    v_mul_f32 v13, v13, v23
    v_cvt_pk_bf16_f32 v45, v10, v11
    v_mul_f32 v14, v14, v23
    s_waitcnt lgkmcnt(8)
    v_mfma_f32_16x16x32_bf16 v[80:83], v[216:219], v[240:243], v[80:83]
    ds_read_b64_tr_b16 v[236:237], v251 offset:30848
    v_mul_f32 v15, v15, v23
    v_cvt_pk_bf16_f32 v46, v12, v13
    v_mfma_f32_16x16x32_bf16 v[84:87], v[220:223], v[240:243], v[84:87]
    ds_read_b64_tr_b16 v[238:239], v251 offset:32128
    v_cvt_pk_bf16_f32 v47, v14, v15
    buffer_store_dwordx4 v[40:43], v252, s[64:67], s11 offen offset:0 sc1
    buffer_store_dwordx4 v[44:47], v252, s[64:67], s11 offen offset:1024 sc1
    s_waitcnt lgkmcnt(8)
    v_mfma_f32_16x16x32_bf16 v[88:91], v[216:219], v[244:247], v[88:91]
    ds_read_b64_tr_b16 v[240:241], v250 offset:30912
    v_mfma_f32_16x16x32_bf16 v[92:95], v[220:223], v[244:247], v[92:95]
    ds_read_b64_tr_b16 v[242:243], v250 offset:32192
    s_barrier
    ds_read_b128 v[208:211], v248 offset:16384
    ds_read_b128 v[212:215], v248 offset:18432
    s_waitcnt lgkmcnt(10)
    v_mfma_f32_16x16x32_bf16 v[96:99], v[216:219], v[224:227], v[96:99]
    ds_read_b64_tr_b16 v[244:245], v251 offset:30912
    v_mfma_f32_16x16x32_bf16 v[100:103], v[220:223], v[224:227], v[100:103]
    ds_read_b64_tr_b16 v[246:247], v251 offset:32192
    s_waitcnt lgkmcnt(10)
    v_mfma_f32_16x16x32_bf16 v[104:107], v[216:219], v[228:231], v[104:107]
    ds_read_b64_tr_b16 v[224:225], v250 offset:30976
    v_mfma_f32_16x16x32_bf16 v[108:111], v[220:223], v[228:231], v[108:111]
    ds_read_b64_tr_b16 v[226:227], v250 offset:32256
    s_waitcnt lgkmcnt(10)
    v_mfma_f32_16x16x32_bf16 v[112:115], v[216:219], v[232:235], v[112:115]
    ds_read_b64_tr_b16 v[228:229], v251 offset:30976
    v_mfma_f32_16x16x32_bf16 v[116:119], v[220:223], v[232:235], v[116:119]
    ds_read_b64_tr_b16 v[230:231], v251 offset:32256
    s_waitcnt lgkmcnt(10)
    v_mfma_f32_16x16x32_bf16 v[120:123], v[216:219], v[236:239], v[120:123]
    ds_read_b64_tr_b16 v[232:233], v250 offset:40960
    v_mfma_f32_16x16x32_bf16 v[124:127], v[220:223], v[236:239], v[124:127]
    ds_read_b64_tr_b16 v[234:235], v250 offset:42240
    s_waitcnt lgkmcnt(10)
    v_mfma_f32_16x16x32_bf16 v[128:131], v[216:219], v[240:243], v[128:131]
    ds_read_b64_tr_b16 v[236:237], v251 offset:40960
    v_mfma_f32_16x16x32_bf16 v[132:135], v[220:223], v[240:243], v[132:135]
    ds_read_b64_tr_b16 v[238:239], v251 offset:42240
    s_waitcnt lgkmcnt(8)
    v_mfma_f32_16x16x32_bf16 v[136:139], v[216:219], v[244:247], v[136:139]
    ds_read_b64_tr_b16 v[240:241], v250 offset:41024
    v_mfma_f32_16x16x32_bf16 v[140:143], v[220:223], v[244:247], v[140:143]
    ds_read_b64_tr_b16 v[242:243], v250 offset:42304
    s_waitcnt lgkmcnt(8)
    v_mfma_f32_16x16x32_bf16 v[144:147], v[216:219], v[224:227], v[144:147]
    ds_read_b64_tr_b16 v[244:245], v251 offset:41024
    v_mfma_f32_16x16x32_bf16 v[148:151], v[220:223], v[224:227], v[148:151]
    ds_read_b64_tr_b16 v[246:247], v251 offset:42304
    s_waitcnt lgkmcnt(8)
    v_mfma_f32_16x16x32_bf16 v[152:155], v[216:219], v[228:231], v[152:155]
    ds_read_b64_tr_b16 v[224:225], v250 offset:41088
    v_mfma_f32_16x16x32_bf16 v[156:159], v[220:223], v[228:231], v[156:159]
    ds_read_b64_tr_b16 v[226:227], v250 offset:42368
    s_barrier
    s_waitcnt lgkmcnt(8)
    v_mfma_f32_16x16x32_bf16 v[80:83], v[208:211], v[232:235], v[80:83]
    ds_read_b64_tr_b16 v[228:229], v251 offset:41088
    v_mfma_f32_16x16x32_bf16 v[84:87], v[212:215], v[232:235], v[84:87]
    ds_read_b64_tr_b16 v[230:231], v251 offset:42368
    s_waitcnt lgkmcnt(8)
    v_mfma_f32_16x16x32_bf16 v[88:91], v[208:211], v[236:239], v[88:91]
    ds_read_b128 v[216:219], v249 offset:16384
    ds_read_b64_tr_b16 v[232:233], v250 offset:41152
    v_mfma_f32_16x16x32_bf16 v[92:95], v[212:215], v[236:239], v[92:95]
    ds_read_b128 v[220:223], v249 offset:18432
    ds_read_b64_tr_b16 v[234:235], v250 offset:42432
    s_waitcnt lgkmcnt(10)
    v_mfma_f32_16x16x32_bf16 v[96:99], v[208:211], v[240:243], v[96:99]
    ds_read_b64_tr_b16 v[236:237], v251 offset:41152
    v_mfma_f32_16x16x32_bf16 v[100:103], v[212:215], v[240:243], v[100:103]
    ds_read_b64_tr_b16 v[238:239], v251 offset:42432
    s_waitcnt lgkmcnt(10)
    v_mfma_f32_16x16x32_bf16 v[104:107], v[208:211], v[244:247], v[104:107]
    ds_read_b64_tr_b16 v[240:241], v250 offset:41216
    v_mfma_f32_16x16x32_bf16 v[108:111], v[212:215], v[244:247], v[108:111]
    ds_read_b64_tr_b16 v[242:243], v250 offset:42496
    s_waitcnt lgkmcnt(10)
    v_mfma_f32_16x16x32_bf16 v[112:115], v[208:211], v[224:227], v[112:115]
    ds_read_b64_tr_b16 v[244:245], v251 offset:41216
    v_mfma_f32_16x16x32_bf16 v[116:119], v[212:215], v[224:227], v[116:119]
    ds_read_b64_tr_b16 v[246:247], v251 offset:42496
    s_waitcnt lgkmcnt(10)
    v_mfma_f32_16x16x32_bf16 v[120:123], v[208:211], v[228:231], v[120:123]
    ds_read_b64_tr_b16 v[224:225], v250 offset:51200
    v_mfma_f32_16x16x32_bf16 v[124:127], v[212:215], v[228:231], v[124:127]
    ds_read_b64_tr_b16 v[226:227], v250 offset:52480
    s_waitcnt lgkmcnt(8)
    v_mfma_f32_16x16x32_bf16 v[128:131], v[208:211], v[232:235], v[128:131]
    ds_read_b64_tr_b16 v[228:229], v251 offset:51200
    v_mfma_f32_16x16x32_bf16 v[132:135], v[212:215], v[232:235], v[132:135]
    ds_read_b64_tr_b16 v[230:231], v251 offset:52480
    s_waitcnt lgkmcnt(8)
    v_mfma_f32_16x16x32_bf16 v[136:139], v[208:211], v[236:239], v[136:139]
    ds_read_b64_tr_b16 v[232:233], v250 offset:51264
    v_mfma_f32_16x16x32_bf16 v[140:143], v[212:215], v[236:239], v[140:143]
    ds_read_b64_tr_b16 v[234:235], v250 offset:52544
    s_waitcnt lgkmcnt(8)
    v_mfma_f32_16x16x32_bf16 v[144:147], v[208:211], v[240:243], v[144:147]
    ds_read_b64_tr_b16 v[236:237], v251 offset:51264
    v_mfma_f32_16x16x32_bf16 v[148:151], v[212:215], v[240:243], v[148:151]
    ds_read_b64_tr_b16 v[238:239], v251 offset:52544
    s_waitcnt lgkmcnt(8)
    v_mfma_f32_16x16x32_bf16 v[152:155], v[208:211], v[244:247], v[152:155]
    ds_read_b64_tr_b16 v[240:241], v250 offset:51328
    v_mfma_f32_16x16x32_bf16 v[156:159], v[212:215], v[244:247], v[156:159]
    ds_read_b64_tr_b16 v[242:243], v250 offset:52608
    s_waitcnt lgkmcnt(8)
    v_mfma_f32_16x16x32_bf16 v[80:83], v[216:219], v[224:227], v[80:83]
    ds_read_b64_tr_b16 v[244:245], v251 offset:51328
    v_mfma_f32_16x16x32_bf16 v[84:87], v[220:223], v[224:227], v[84:87]
    ds_read_b64_tr_b16 v[246:247], v251 offset:52608
    s_waitcnt lgkmcnt(8)
    v_mfma_f32_16x16x32_bf16 v[88:91], v[216:219], v[228:231], v[88:91]
    ds_read_b128 v[208:211], v248 offset:32768
    ds_read_b64_tr_b16 v[224:225], v250 offset:51392
    v_mfma_f32_16x16x32_bf16 v[92:95], v[220:223], v[228:231], v[92:95]
    ds_read_b128 v[212:215], v248 offset:34816
    ds_read_b64_tr_b16 v[226:227], v250 offset:52672
    s_waitcnt lgkmcnt(10)
    v_mfma_f32_16x16x32_bf16 v[96:99], v[216:219], v[232:235], v[96:99]
    ds_read_b64_tr_b16 v[228:229], v251 offset:51392
    v_mfma_f32_16x16x32_bf16 v[100:103], v[220:223], v[232:235], v[100:103]
    ds_read_b64_tr_b16 v[230:231], v251 offset:52672
    v_cvt_pk_bf16_f32 v160, v80, v81
    s_waitcnt lgkmcnt(10)
    v_mfma_f32_16x16x32_bf16 v[104:107], v[216:219], v[236:239], v[104:107]
    ds_read_b64_tr_b16 v[232:233], v250 offset:51456
    v_mfma_f32_16x16x32_bf16 v[108:111], v[220:223], v[236:239], v[108:111]
    ds_read_b64_tr_b16 v[234:235], v250 offset:52736
    v_cvt_pk_bf16_f32 v161, v82, v83
    s_waitcnt lgkmcnt(10)
    v_mfma_f32_16x16x32_bf16 v[112:115], v[216:219], v[240:243], v[112:115]
    ds_read_b64_tr_b16 v[236:237], v251 offset:51456
    v_mfma_f32_16x16x32_bf16 v[116:119], v[220:223], v[240:243], v[116:119]
    ds_read_b64_tr_b16 v[238:239], v251 offset:52736
    v_cvt_pk_bf16_f32 v162, v84, v85
    s_waitcnt lgkmcnt(10)
    v_mfma_f32_16x16x32_bf16 v[120:123], v[216:219], v[244:247], v[120:123]
    ds_read_b64_tr_b16 v[240:241], v250 offset:61440
    v_mfma_f32_16x16x32_bf16 v[124:127], v[220:223], v[244:247], v[124:127]
    ds_read_b64_tr_b16 v[242:243], v250 offset:62720
    v_cvt_pk_bf16_f32 v163, v86, v87
    s_waitcnt lgkmcnt(8)
    v_mfma_f32_16x16x32_bf16 v[128:131], v[216:219], v[224:227], v[128:131]
    ds_read_b64_tr_b16 v[244:245], v251 offset:61440
    v_mfma_f32_16x16x32_bf16 v[132:135], v[220:223], v[224:227], v[132:135]
    ds_read_b64_tr_b16 v[246:247], v251 offset:62720
    v_cvt_pk_bf16_f32 v164, v88, v89
    s_waitcnt lgkmcnt(8)
    v_mfma_f32_16x16x32_bf16 v[136:139], v[216:219], v[228:231], v[136:139]
    ds_read_b64_tr_b16 v[224:225], v250 offset:61504
    v_mfma_f32_16x16x32_bf16 v[140:143], v[220:223], v[228:231], v[140:143]
    ds_read_b64_tr_b16 v[226:227], v250 offset:62784
    v_cvt_pk_bf16_f32 v165, v90, v91
    s_waitcnt lgkmcnt(8)
    v_mfma_f32_16x16x32_bf16 v[144:147], v[216:219], v[232:235], v[144:147]
    ds_read_b64_tr_b16 v[228:229], v251 offset:61504
    v_mfma_f32_16x16x32_bf16 v[148:151], v[220:223], v[232:235], v[148:151]
    ds_read_b64_tr_b16 v[230:231], v251 offset:62784
    v_cvt_pk_bf16_f32 v166, v92, v93
    s_waitcnt lgkmcnt(8)
    v_mfma_f32_16x16x32_bf16 v[152:155], v[216:219], v[236:239], v[152:155]
    ds_read_b64_tr_b16 v[232:233], v250 offset:61568
    v_mfma_f32_16x16x32_bf16 v[156:159], v[220:223], v[236:239], v[156:159]
    ds_read_b64_tr_b16 v[234:235], v250 offset:62848
    v_cvt_pk_bf16_f32 v167, v94, v95
    s_barrier
    s_waitcnt lgkmcnt(8)
    v_mfma_f32_16x16x32_bf16 v[80:83], v[208:211], v[240:243], 0
    ds_read_b64_tr_b16 v[236:237], v251 offset:61568
    v_mfma_f32_16x16x32_bf16 v[84:87], v[212:215], v[240:243], 0
    ds_read_b64_tr_b16 v[238:239], v251 offset:62848
    v_cvt_pk_bf16_f32 v168, v96, v97
    s_waitcnt lgkmcnt(8)
    v_mfma_f32_16x16x32_bf16 v[88:91], v[208:211], v[244:247], 0
    ds_read_b128 v[216:219], v249 offset:32768
    ds_read_b64_tr_b16 v[240:241], v250 offset:61632
    v_mfma_f32_16x16x32_bf16 v[92:95], v[212:215], v[244:247], 0
    ds_read_b128 v[220:223], v249 offset:34816
    ds_read_b64_tr_b16 v[242:243], v250 offset:62912
    v_cvt_pk_bf16_f32 v169, v98, v99
    v_cvt_pk_bf16_f32 v170, v100, v101
    v_cvt_pk_bf16_f32 v171, v102, v103
    s_waitcnt lgkmcnt(10)
    v_mfma_f32_16x16x32_bf16 v[96:99], v[208:211], v[224:227], 0
    ds_read_b64_tr_b16 v[244:245], v251 offset:61632
    v_mfma_f32_16x16x32_bf16 v[100:103], v[212:215], v[224:227], 0
    ds_read_b64_tr_b16 v[246:247], v251 offset:62912
    v_cvt_pk_bf16_f32 v172, v104, v105
    v_cvt_pk_bf16_f32 v173, v106, v107
    v_cvt_pk_bf16_f32 v174, v108, v109
    v_cvt_pk_bf16_f32 v175, v110, v111
    s_waitcnt lgkmcnt(10)
    v_mfma_f32_16x16x32_bf16 v[104:107], v[208:211], v[228:231], 0
    ds_read_b64_tr_b16 v[224:225], v250 offset:61696
    v_mfma_f32_16x16x32_bf16 v[108:111], v[212:215], v[228:231], 0
    ds_read_b64_tr_b16 v[226:227], v250 offset:62976
    v_cvt_pk_bf16_f32 v176, v112, v113
    v_cvt_pk_bf16_f32 v177, v114, v115
    v_cvt_pk_bf16_f32 v178, v116, v117
    v_cvt_pk_bf16_f32 v179, v118, v119
    s_waitcnt lgkmcnt(10)
    v_mfma_f32_16x16x32_bf16 v[112:115], v[208:211], v[232:235], 0
    ds_read_b64_tr_b16 v[228:229], v251 offset:61696
    v_mfma_f32_16x16x32_bf16 v[116:119], v[212:215], v[232:235], 0
    ds_read_b64_tr_b16 v[230:231], v251 offset:62976
    v_cvt_pk_bf16_f32 v180, v120, v121
    s_waitcnt vmcnt(0)
    s_lshl_b32 s16, s2, 7
    s_lshl_b32 s19, s3, 2
    s_add_u32 s16, s16, s19
    s_add_u32 s16, s16, 33554432
    v_mov_b32 v253, 1
    buffer_store_dword v253, off, s[64:67], s16 sc1
    v_cvt_pk_bf16_f32 v181, v122, v123
    v_cvt_pk_bf16_f32 v182, v124, v125
    v_cvt_pk_bf16_f32 v183, v126, v127
    s_waitcnt lgkmcnt(10)
    v_mfma_f32_16x16x32_bf16 v[120:123], v[208:211], v[236:239], 0
    v_add_u32 v250, 20480, v250
    v_add_u32 v251, 20480, v251
    ds_read_b64_tr_b16 v[232:233], v250 offset:51200
    v_mfma_f32_16x16x32_bf16 v[124:127], v[212:215], v[236:239], 0
    ds_read_b64_tr_b16 v[234:235], v250 offset:52480
    v_cvt_pk_bf16_f32 v184, v128, v129
    v_cvt_pk_bf16_f32 v185, v130, v131
    v_cvt_pk_bf16_f32 v186, v132, v133
    v_cvt_pk_bf16_f32 v187, v134, v135
    s_waitcnt lgkmcnt(8)
    v_mfma_f32_16x16x32_bf16 v[128:131], v[208:211], v[240:243], 0
    ds_read_b64_tr_b16 v[236:237], v251 offset:51200
    v_mfma_f32_16x16x32_bf16 v[132:135], v[212:215], v[240:243], 0
    ds_read_b64_tr_b16 v[238:239], v251 offset:52480
    v_cvt_pk_bf16_f32 v188, v136, v137
    v_cvt_pk_bf16_f32 v189, v138, v139
    v_cvt_pk_bf16_f32 v190, v140, v141
    v_cvt_pk_bf16_f32 v191, v142, v143
    s_waitcnt lgkmcnt(8)
    v_mfma_f32_16x16x32_bf16 v[136:139], v[208:211], v[244:247], 0
    ds_read_b64_tr_b16 v[240:241], v250 offset:51264
    v_mfma_f32_16x16x32_bf16 v[140:143], v[212:215], v[244:247], 0
    ds_read_b64_tr_b16 v[242:243], v250 offset:52544
    v_cvt_pk_bf16_f32 v192, v144, v145
    v_cvt_pk_bf16_f32 v193, v146, v147
    v_cvt_pk_bf16_f32 v194, v148, v149
    v_cvt_pk_bf16_f32 v195, v150, v151
    s_waitcnt lgkmcnt(8)
    v_mfma_f32_16x16x32_bf16 v[144:147], v[208:211], v[224:227], 0
    ds_read_b64_tr_b16 v[244:245], v251 offset:51264
    v_mfma_f32_16x16x32_bf16 v[148:151], v[212:215], v[224:227], 0
    ds_read_b64_tr_b16 v[246:247], v251 offset:52544
    v_cvt_pk_bf16_f32 v196, v152, v153
    v_cvt_pk_bf16_f32 v197, v154, v155
    v_cvt_pk_bf16_f32 v198, v156, v157
    v_cvt_pk_bf16_f32 v199, v158, v159
    s_waitcnt lgkmcnt(8)
    v_mfma_f32_16x16x32_bf16 v[152:155], v[208:211], v[228:231], 0
    ds_read_b64_tr_b16 v[224:225], v250 offset:51328
    v_mfma_f32_16x16x32_bf16 v[156:159], v[212:215], v[228:231], 0
    ds_read_b64_tr_b16 v[226:227], v250 offset:52608
    s_xor_b32 s14, s18, 0
    s_and_b32 s14, s14, 7
    s_lshl_b32 s14, s14, 11
    s_add_u32 s14, s14, s17
    buffer_load_dwordx4 v[200:203], v252, s[64:67], s14 offen offset:0 sc1
    buffer_load_dwordx4 v[204:207], v252, s[64:67], s14 offen offset:1024 sc1
    s_waitcnt lgkmcnt(8)
    v_mfma_f32_16x16x32_bf16 v[80:83], v[216:219], v[232:235], v[80:83]
    ds_read_b64_tr_b16 v[228:229], v251 offset:51328
    v_mfma_f32_16x16x32_bf16 v[84:87], v[220:223], v[232:235], v[84:87]
    ds_read_b64_tr_b16 v[230:231], v251 offset:52608
    s_waitcnt lgkmcnt(8)
    v_mfma_f32_16x16x32_bf16 v[88:91], v[216:219], v[236:239], v[88:91]
    ds_read_b128 v[208:211], v248 offset:49152
    ds_read_b64_tr_b16 v[232:233], v250 offset:51392
    v_mfma_f32_16x16x32_bf16 v[92:95], v[220:223], v[236:239], v[92:95]
    ds_read_b128 v[212:215], v248 offset:51200
    ds_read_b64_tr_b16 v[234:235], v250 offset:52672
    s_waitcnt lgkmcnt(10)
    v_mfma_f32_16x16x32_bf16 v[96:99], v[216:219], v[240:243], v[96:99]
    ds_read_b64_tr_b16 v[236:237], v251 offset:51392
    v_mfma_f32_16x16x32_bf16 v[100:103], v[220:223], v[240:243], v[100:103]
    ds_read_b64_tr_b16 v[238:239], v251 offset:52672
    s_waitcnt lgkmcnt(10)
    v_mfma_f32_16x16x32_bf16 v[104:107], v[216:219], v[244:247], v[104:107]
    ds_read_b64_tr_b16 v[240:241], v250 offset:51456
    v_mfma_f32_16x16x32_bf16 v[108:111], v[220:223], v[244:247], v[108:111]
    ds_read_b64_tr_b16 v[242:243], v250 offset:52736
    s_waitcnt lgkmcnt(10)
    v_mfma_f32_16x16x32_bf16 v[112:115], v[216:219], v[224:227], v[112:115]
    ds_read_b64_tr_b16 v[244:245], v251 offset:51456
    v_mfma_f32_16x16x32_bf16 v[116:119], v[220:223], v[224:227], v[116:119]
    ds_read_b64_tr_b16 v[246:247], v251 offset:52736
    s_waitcnt lgkmcnt(10)
    v_mfma_f32_16x16x32_bf16 v[120:123], v[216:219], v[228:231], v[120:123]
    v_add_u32 v250, 4294946816, v250
    v_add_u32 v251, 4294946816, v251
    ds_read_b64_tr_b16 v[224:225], v250 offset:0
    v_mfma_f32_16x16x32_bf16 v[124:127], v[220:223], v[228:231], v[124:127]
    ds_read_b64_tr_b16 v[226:227], v250 offset:1280
    s_waitcnt lgkmcnt(8)
    v_mfma_f32_16x16x32_bf16 v[128:131], v[216:219], v[232:235], v[128:131]
    ds_read_b64_tr_b16 v[228:229], v251 offset:0
    v_mfma_f32_16x16x32_bf16 v[132:135], v[220:223], v[232:235], v[132:135]
    ds_read_b64_tr_b16 v[230:231], v251 offset:1280
    s_waitcnt lgkmcnt(8)
    v_mfma_f32_16x16x32_bf16 v[136:139], v[216:219], v[236:239], v[136:139]
    ds_read_b64_tr_b16 v[232:233], v250 offset:64
    v_mfma_f32_16x16x32_bf16 v[140:143], v[220:223], v[236:239], v[140:143]
    ds_read_b64_tr_b16 v[234:235], v250 offset:1344
    s_waitcnt lgkmcnt(8)
    v_mfma_f32_16x16x32_bf16 v[144:147], v[216:219], v[240:243], v[144:147]
    ds_read_b64_tr_b16 v[236:237], v251 offset:64
    v_mfma_f32_16x16x32_bf16 v[148:151], v[220:223], v[240:243], v[148:151]
    ds_read_b64_tr_b16 v[238:239], v251 offset:1344
    s_waitcnt lgkmcnt(8)
    v_mfma_f32_16x16x32_bf16 v[152:155], v[216:219], v[244:247], v[152:155]
    ds_read_b64_tr_b16 v[240:241], v250 offset:128
    v_mfma_f32_16x16x32_bf16 v[156:159], v[220:223], v[244:247], v[156:159]
    ds_read_b64_tr_b16 v[242:243], v250 offset:1408
    s_barrier
    s_waitcnt lgkmcnt(8)
    v_mfma_f32_16x16x32_bf16 v[80:83], v[208:211], v[224:227], v[80:83]
    ds_read_b64_tr_b16 v[244:245], v251 offset:128
    v_mfma_f32_16x16x32_bf16 v[84:87], v[212:215], v[224:227], v[84:87]
    ds_read_b64_tr_b16 v[246:247], v251 offset:1408
    s_waitcnt lgkmcnt(8)
    v_mfma_f32_16x16x32_bf16 v[88:91], v[208:211], v[228:231], v[88:91]
    ds_read_b128 v[216:219], v249 offset:49152
    ds_read_b64_tr_b16 v[224:225], v250 offset:192
    v_mfma_f32_16x16x32_bf16 v[92:95], v[212:215], v[228:231], v[92:95]
    ds_read_b128 v[220:223], v249 offset:51200
    ds_read_b64_tr_b16 v[226:227], v250 offset:1472
    s_waitcnt lgkmcnt(10)
    v_mfma_f32_16x16x32_bf16 v[96:99], v[208:211], v[232:235], v[96:99]
    ds_read_b64_tr_b16 v[228:229], v251 offset:192
    v_mfma_f32_16x16x32_bf16 v[100:103], v[212:215], v[232:235], v[100:103]
    ds_read_b64_tr_b16 v[230:231], v251 offset:1472
    s_waitcnt lgkmcnt(10)
    v_mfma_f32_16x16x32_bf16 v[104:107], v[208:211], v[236:239], v[104:107]
    ds_read_b64_tr_b16 v[232:233], v250 offset:256
    v_mfma_f32_16x16x32_bf16 v[108:111], v[212:215], v[236:239], v[108:111]
    ds_read_b64_tr_b16 v[234:235], v250 offset:1536
    s_waitcnt lgkmcnt(10)
    v_mfma_f32_16x16x32_bf16 v[112:115], v[208:211], v[240:243], v[112:115]
    ds_read_b64_tr_b16 v[236:237], v251 offset:256
    v_mfma_f32_16x16x32_bf16 v[116:119], v[212:215], v[240:243], v[116:119]
    ds_read_b64_tr_b16 v[238:239], v251 offset:1536
    s_waitcnt lgkmcnt(10)
    v_mfma_f32_16x16x32_bf16 v[120:123], v[208:211], v[244:247], v[120:123]
    ds_read_b64_tr_b16 v[240:241], v250 offset:10240
    v_mfma_f32_16x16x32_bf16 v[124:127], v[212:215], v[244:247], v[124:127]
    ds_read_b64_tr_b16 v[242:243], v250 offset:11520
    s_waitcnt lgkmcnt(8)
    v_mfma_f32_16x16x32_bf16 v[128:131], v[208:211], v[224:227], v[128:131]
    ds_read_b64_tr_b16 v[244:245], v251 offset:10240
    v_mfma_f32_16x16x32_bf16 v[132:135], v[212:215], v[224:227], v[132:135]
    ds_read_b64_tr_b16 v[246:247], v251 offset:11520
    s_waitcnt lgkmcnt(8)
    v_mfma_f32_16x16x32_bf16 v[136:139], v[208:211], v[228:231], v[136:139]
    ds_read_b64_tr_b16 v[224:225], v250 offset:10304
    v_mfma_f32_16x16x32_bf16 v[140:143], v[212:215], v[228:231], v[140:143]
    ds_read_b64_tr_b16 v[226:227], v250 offset:11584
    s_waitcnt lgkmcnt(8)
    v_mfma_f32_16x16x32_bf16 v[144:147], v[208:211], v[232:235], v[144:147]
    ds_read_b64_tr_b16 v[228:229], v251 offset:10304
    v_mfma_f32_16x16x32_bf16 v[148:151], v[212:215], v[232:235], v[148:151]
    ds_read_b64_tr_b16 v[230:231], v251 offset:11584
    s_waitcnt lgkmcnt(8)
    v_mfma_f32_16x16x32_bf16 v[152:155], v[208:211], v[236:239], v[152:155]
    ds_read_b64_tr_b16 v[232:233], v250 offset:10368
    v_mfma_f32_16x16x32_bf16 v[156:159], v[212:215], v[236:239], v[156:159]
    ds_read_b64_tr_b16 v[234:235], v250 offset:11648
    s_waitcnt lgkmcnt(8)
    v_mfma_f32_16x16x32_bf16 v[80:83], v[216:219], v[240:243], v[80:83]
    ds_read_b64_tr_b16 v[236:237], v251 offset:10368
    v_mfma_f32_16x16x32_bf16 v[84:87], v[220:223], v[240:243], v[84:87]
    ds_read_b64_tr_b16 v[238:239], v251 offset:11648
    s_waitcnt lgkmcnt(8)
    v_mfma_f32_16x16x32_bf16 v[88:91], v[216:219], v[244:247], v[88:91]
    ds_read_b128 v[208:211], v248 offset:0
    ds_read_b64_tr_b16 v[240:241], v250 offset:10432
    v_mfma_f32_16x16x32_bf16 v[92:95], v[220:223], v[244:247], v[92:95]
    ds_read_b128 v[212:215], v248 offset:2048
    ds_read_b64_tr_b16 v[242:243], v250 offset:11712
    s_waitcnt lgkmcnt(10)
    v_mfma_f32_16x16x32_bf16 v[96:99], v[216:219], v[224:227], v[96:99]
    ds_read_b64_tr_b16 v[244:245], v251 offset:10432
    v_mfma_f32_16x16x32_bf16 v[100:103], v[220:223], v[224:227], v[100:103]
    ds_read_b64_tr_b16 v[246:247], v251 offset:11712
    s_waitcnt lgkmcnt(10)
    v_mfma_f32_16x16x32_bf16 v[104:107], v[216:219], v[228:231], v[104:107]
    ds_read_b64_tr_b16 v[224:225], v250 offset:10496
    v_mfma_f32_16x16x32_bf16 v[108:111], v[220:223], v[228:231], v[108:111]
    ds_read_b64_tr_b16 v[226:227], v250 offset:11776
    s_waitcnt lgkmcnt(10)
    v_mfma_f32_16x16x32_bf16 v[112:115], v[216:219], v[232:235], v[112:115]
    ds_read_b64_tr_b16 v[228:229], v251 offset:10496
    v_mfma_f32_16x16x32_bf16 v[116:119], v[220:223], v[232:235], v[116:119]
    ds_read_b64_tr_b16 v[230:231], v251 offset:11776
    s_waitcnt lgkmcnt(10)
    v_mfma_f32_16x16x32_bf16 v[120:123], v[216:219], v[236:239], v[120:123]
    ds_read_b64_tr_b16 v[232:233], v250 offset:20480
    v_mfma_f32_16x16x32_bf16 v[124:127], v[220:223], v[236:239], v[124:127]
    ds_read_b64_tr_b16 v[234:235], v250 offset:21760
    s_waitcnt lgkmcnt(8)
    v_mfma_f32_16x16x32_bf16 v[128:131], v[216:219], v[240:243], v[128:131]
    ds_read_b64_tr_b16 v[236:237], v251 offset:20480
    v_mfma_f32_16x16x32_bf16 v[132:135], v[220:223], v[240:243], v[132:135]
    ds_read_b64_tr_b16 v[238:239], v251 offset:21760
    s_waitcnt lgkmcnt(8)
    v_mfma_f32_16x16x32_bf16 v[136:139], v[216:219], v[244:247], v[136:139]
    ds_read_b64_tr_b16 v[240:241], v250 offset:20544
    v_mfma_f32_16x16x32_bf16 v[140:143], v[220:223], v[244:247], v[140:143]
    ds_read_b64_tr_b16 v[242:243], v250 offset:21824
    s_waitcnt lgkmcnt(8)
    v_mfma_f32_16x16x32_bf16 v[144:147], v[216:219], v[224:227], v[144:147]
    ds_read_b64_tr_b16 v[244:245], v251 offset:20544
    v_mfma_f32_16x16x32_bf16 v[148:151], v[220:223], v[224:227], v[148:151]
    ds_read_b64_tr_b16 v[246:247], v251 offset:21824
    s_waitcnt lgkmcnt(8)
    v_mfma_f32_16x16x32_bf16 v[152:155], v[216:219], v[228:231], v[152:155]
    ds_read_b64_tr_b16 v[224:225], v250 offset:20608
    v_mfma_f32_16x16x32_bf16 v[156:159], v[220:223], v[228:231], v[156:159]
    ds_read_b64_tr_b16 v[226:227], v250 offset:21888
    s_waitcnt vmcnt(0)
    v_max3_u32 v253, v200, v201, v202
    v_max3_u32 v253, v253, v203, v204
    v_max3_u32 v253, v253, v205, v206
    v_max_u32 v253, v253, v207
    v_cmp_eq_u32 vcc, -1, v253
    s_cbranch_vccnz L_cs0
L_cd0:
    v_mfma_f32_16x16x32_bf16 v[0:3], v[160:163], v[200:203], 0
    v_mfma_f32_16x16x32_bf16 v[4:7], v[160:163], v[204:207], 0
    v_mfma_f32_16x16x32_bf16 v[8:11], v[164:167], v[200:203], 0
    v_cvt_pk_bf16_f32 v160, v80, v81
    v_cvt_pk_bf16_f32 v161, v82, v83
    v_mfma_f32_16x16x32_bf16 v[12:15], v[164:167], v[204:207], 0
    v_cvt_pk_bf16_f32 v162, v84, v85
    v_cvt_pk_bf16_f32 v163, v86, v87
    v_mfma_f32_16x16x32_bf16 v[16:19], v[168:171], v[200:203], 0
    v_cvt_pk_bf16_f32 v164, v88, v89
    v_cvt_pk_bf16_f32 v165, v90, v91
    v_mfma_f32_16x16x32_bf16 v[20:23], v[168:171], v[204:207], 0
    v_cvt_pk_bf16_f32 v166, v92, v93
    v_cvt_pk_bf16_f32 v167, v94, v95
    v_mfma_f32_16x16x32_bf16 v[24:27], v[172:175], v[200:203], 0
    v_cvt_pk_bf16_f32 v168, v96, v97
    v_cvt_pk_bf16_f32 v169, v98, v99
    v_mfma_f32_16x16x32_bf16 v[28:31], v[172:175], v[204:207], 0
    v_cvt_pk_bf16_f32 v170, v100, v101
    v_cvt_pk_bf16_f32 v171, v102, v103
    v_mfma_f32_16x16x32_bf16 v[32:35], v[176:179], v[200:203], 0
    v_cvt_pk_bf16_f32 v172, v104, v105
    v_cvt_pk_bf16_f32 v173, v106, v107
    v_mfma_f32_16x16x32_bf16 v[36:39], v[176:179], v[204:207], 0
    v_cvt_pk_bf16_f32 v174, v108, v109
    v_cvt_pk_bf16_f32 v175, v110, v111
    v_mfma_f32_16x16x32_bf16 v[40:43], v[180:183], v[200:203], 0
    v_cvt_pk_bf16_f32 v176, v112, v113
    v_cvt_pk_bf16_f32 v177, v114, v115
    v_mfma_f32_16x16x32_bf16 v[44:47], v[180:183], v[204:207], 0
    v_cvt_pk_bf16_f32 v178, v116, v117
    v_cvt_pk_bf16_f32 v179, v118, v119
    v_mfma_f32_16x16x32_bf16 v[48:51], v[184:187], v[200:203], 0
    v_cvt_pk_bf16_f32 v180, v120, v121
    v_cvt_pk_bf16_f32 v181, v122, v123
    v_mfma_f32_16x16x32_bf16 v[52:55], v[184:187], v[204:207], 0
    v_cvt_pk_bf16_f32 v182, v124, v125
    v_cvt_pk_bf16_f32 v183, v126, v127
    v_mfma_f32_16x16x32_bf16 v[56:59], v[188:191], v[200:203], 0
    v_cvt_pk_bf16_f32 v184, v128, v129
    v_cvt_pk_bf16_f32 v185, v130, v131
    v_mfma_f32_16x16x32_bf16 v[60:63], v[188:191], v[204:207], 0
    v_cvt_pk_bf16_f32 v186, v132, v133
    v_cvt_pk_bf16_f32 v187, v134, v135
    v_mfma_f32_16x16x32_bf16 v[64:67], v[192:195], v[200:203], 0
    v_cvt_pk_bf16_f32 v188, v136, v137
    v_cvt_pk_bf16_f32 v189, v138, v139
    v_mfma_f32_16x16x32_bf16 v[68:71], v[192:195], v[204:207], 0
    v_cvt_pk_bf16_f32 v190, v140, v141
    v_cvt_pk_bf16_f32 v191, v142, v143
    v_mfma_f32_16x16x32_bf16 v[72:75], v[196:199], v[200:203], 0
    v_cvt_pk_bf16_f32 v192, v144, v145
    v_cvt_pk_bf16_f32 v193, v146, v147
    v_mfma_f32_16x16x32_bf16 v[76:79], v[196:199], v[204:207], 0
    v_cvt_pk_bf16_f32 v194, v148, v149
    v_cvt_pk_bf16_f32 v195, v150, v151
    s_xor_b32 s14, s18, 1
    s_and_b32 s14, s14, 7
    s_lshl_b32 s14, s14, 11
    s_add_u32 s14, s14, s17
    buffer_load_dwordx4 v[200:203], v252, s[64:67], s14 offen offset:0 sc1
    buffer_load_dwordx4 v[204:207], v252, s[64:67], s14 offen offset:1024 sc1
    s_barrier
    s_waitcnt lgkmcnt(8)
    v_mfma_f32_16x16x32_bf16 v[80:83], v[208:211], v[232:235], 0
    ds_read_b64_tr_b16 v[228:229], v251 offset:20608
    v_mfma_f32_16x16x32_bf16 v[84:87], v[212:215], v[232:235], 0
    ds_read_b64_tr_b16 v[230:231], v251 offset:21888
    v_cvt_pk_bf16_f32 v196, v152, v153
    s_waitcnt lgkmcnt(8)
    v_mfma_f32_16x16x32_bf16 v[88:91], v[208:211], v[236:239], 0
    ds_read_b128 v[216:219], v249 offset:0
    ds_read_b64_tr_b16 v[232:233], v250 offset:20672
    v_mfma_f32_16x16x32_bf16 v[92:95], v[212:215], v[236:239], 0
    ds_read_b128 v[220:223], v249 offset:2048
    ds_read_b64_tr_b16 v[234:235], v250 offset:21952
    s_waitcnt lgkmcnt(10)
    v_mfma_f32_16x16x32_bf16 v[96:99], v[208:211], v[240:243], 0
    ds_read_b64_tr_b16 v[236:237], v251 offset:20672
    v_mfma_f32_16x16x32_bf16 v[100:103], v[212:215], v[240:243], 0
    ds_read_b64_tr_b16 v[238:239], v251 offset:21952
    v_cvt_pk_bf16_f32 v197, v154, v155
    s_waitcnt lgkmcnt(10)
    v_mfma_f32_16x16x32_bf16 v[104:107], v[208:211], v[244:247], 0
    ds_read_b64_tr_b16 v[240:241], v250 offset:20736
    v_mfma_f32_16x16x32_bf16 v[108:111], v[212:215], v[244:247], 0
    ds_read_b64_tr_b16 v[242:243], v250 offset:22016
    v_cvt_pk_bf16_f32 v198, v156, v157
    s_waitcnt lgkmcnt(10)
    v_mfma_f32_16x16x32_bf16 v[112:115], v[208:211], v[224:227], 0
    ds_read_b64_tr_b16 v[244:245], v251 offset:20736
    v_mfma_f32_16x16x32_bf16 v[116:119], v[212:215], v[224:227], 0
    ds_read_b64_tr_b16 v[246:247], v251 offset:22016
    v_cvt_pk_bf16_f32 v199, v158, v159
    s_waitcnt lgkmcnt(10)
    v_mfma_f32_16x16x32_bf16 v[120:123], v[208:211], v[228:231], 0
    ds_read_b64_tr_b16 v[224:225], v250 offset:30720
    v_mfma_f32_16x16x32_bf16 v[124:127], v[212:215], v[228:231], 0
    ds_read_b64_tr_b16 v[226:227], v250 offset:32000
    s_waitcnt lgkmcnt(8)
    v_mfma_f32_16x16x32_bf16 v[128:131], v[208:211], v[232:235], 0
    ds_read_b64_tr_b16 v[228:229], v251 offset:30720
    v_mfma_f32_16x16x32_bf16 v[132:135], v[212:215], v[232:235], 0
    ds_read_b64_tr_b16 v[230:231], v251 offset:32000
    s_waitcnt lgkmcnt(8)
    v_mfma_f32_16x16x32_bf16 v[136:139], v[208:211], v[236:239], 0
    ds_read_b64_tr_b16 v[232:233], v250 offset:30784
    v_mfma_f32_16x16x32_bf16 v[140:143], v[212:215], v[236:239], 0
    ds_read_b64_tr_b16 v[234:235], v250 offset:32064
    s_waitcnt lgkmcnt(8)
    v_mfma_f32_16x16x32_bf16 v[144:147], v[208:211], v[240:243], 0
    ds_read_b64_tr_b16 v[236:237], v251 offset:30784
    v_mfma_f32_16x16x32_bf16 v[148:151], v[212:215], v[240:243], 0
    ds_read_b64_tr_b16 v[238:239], v251 offset:32064
    s_waitcnt lgkmcnt(8)
    v_mfma_f32_16x16x32_bf16 v[152:155], v[208:211], v[244:247], 0
    ds_read_b64_tr_b16 v[240:241], v250 offset:30848
    v_mfma_f32_16x16x32_bf16 v[156:159], v[212:215], v[244:247], 0
    ds_read_b64_tr_b16 v[242:243], v250 offset:32128
    s_waitcnt lgkmcnt(8)
    v_mfma_f32_16x16x32_bf16 v[80:83], v[216:219], v[224:227], v[80:83]
    ds_read_b64_tr_b16 v[244:245], v251 offset:30848
    v_mfma_f32_16x16x32_bf16 v[84:87], v[220:223], v[224:227], v[84:87]
    ds_read_b64_tr_b16 v[246:247], v251 offset:32128
    s_waitcnt lgkmcnt(8)
    v_mfma_f32_16x16x32_bf16 v[88:91], v[216:219], v[228:231], v[88:91]
    ds_read_b128 v[208:211], v248 offset:16384
    ds_read_b64_tr_b16 v[224:225], v250 offset:30912
    v_mfma_f32_16x16x32_bf16 v[92:95], v[220:223], v[228:231], v[92:95]
    ds_read_b128 v[212:215], v248 offset:18432
    ds_read_b64_tr_b16 v[226:227], v250 offset:32192
    s_waitcnt lgkmcnt(10)
    v_mfma_f32_16x16x32_bf16 v[96:99], v[216:219], v[232:235], v[96:99]
    ds_read_b64_tr_b16 v[228:229], v251 offset:30912
    v_mfma_f32_16x16x32_bf16 v[100:103], v[220:223], v[232:235], v[100:103]
    ds_read_b64_tr_b16 v[230:231], v251 offset:32192
    s_waitcnt lgkmcnt(10)
    v_mfma_f32_16x16x32_bf16 v[104:107], v[216:219], v[236:239], v[104:107]
    ds_read_b64_tr_b16 v[232:233], v250 offset:30976
    v_mfma_f32_16x16x32_bf16 v[108:111], v[220:223], v[236:239], v[108:111]
    ds_read_b64_tr_b16 v[234:235], v250 offset:32256
    s_waitcnt lgkmcnt(10)
    v_mfma_f32_16x16x32_bf16 v[112:115], v[216:219], v[240:243], v[112:115]
    ds_read_b64_tr_b16 v[236:237], v251 offset:30976
    v_mfma_f32_16x16x32_bf16 v[116:119], v[220:223], v[240:243], v[116:119]
    ds_read_b64_tr_b16 v[238:239], v251 offset:32256
    s_waitcnt lgkmcnt(10)
    v_mfma_f32_16x16x32_bf16 v[120:123], v[216:219], v[244:247], v[120:123]
    ds_read_b64_tr_b16 v[240:241], v250 offset:40960
    v_mfma_f32_16x16x32_bf16 v[124:127], v[220:223], v[244:247], v[124:127]
    ds_read_b64_tr_b16 v[242:243], v250 offset:42240
    s_waitcnt lgkmcnt(8)
    v_mfma_f32_16x16x32_bf16 v[128:131], v[216:219], v[224:227], v[128:131]
    ds_read_b64_tr_b16 v[244:245], v251 offset:40960
    v_mfma_f32_16x16x32_bf16 v[132:135], v[220:223], v[224:227], v[132:135]
    ds_read_b64_tr_b16 v[246:247], v251 offset:42240
    s_waitcnt lgkmcnt(8)
    v_mfma_f32_16x16x32_bf16 v[136:139], v[216:219], v[228:231], v[136:139]
    ds_read_b64_tr_b16 v[224:225], v250 offset:41024
    v_mfma_f32_16x16x32_bf16 v[140:143], v[220:223], v[228:231], v[140:143]
    ds_read_b64_tr_b16 v[226:227], v250 offset:42304
    s_waitcnt lgkmcnt(8)
    v_mfma_f32_16x16x32_bf16 v[144:147], v[216:219], v[232:235], v[144:147]
    ds_read_b64_tr_b16 v[228:229], v251 offset:41024
    v_mfma_f32_16x16x32_bf16 v[148:151], v[220:223], v[232:235], v[148:151]
    ds_read_b64_tr_b16 v[230:231], v251 offset:42304
    s_waitcnt lgkmcnt(8)
    v_mfma_f32_16x16x32_bf16 v[152:155], v[216:219], v[236:239], v[152:155]
    ds_read_b64_tr_b16 v[232:233], v250 offset:41088
    v_mfma_f32_16x16x32_bf16 v[156:159], v[220:223], v[236:239], v[156:159]
    ds_read_b64_tr_b16 v[234:235], v250 offset:42368
L_at_C5:
    s_barrier
    s_waitcnt lgkmcnt(8)
    v_mfma_f32_16x16x32_bf16 v[80:83], v[208:211], v[240:243], v[80:83]
    ds_read_b64_tr_b16 v[236:237], v251 offset:41088
    v_mfma_f32_16x16x32_bf16 v[84:87], v[212:215], v[240:243], v[84:87]
    ds_read_b64_tr_b16 v[238:239], v251 offset:42368
    s_waitcnt lgkmcnt(8)
    v_mfma_f32_16x16x32_bf16 v[88:91], v[208:211], v[244:247], v[88:91]
    ds_read_b128 v[216:219], v249 offset:16384
    ds_read_b64_tr_b16 v[240:241], v250 offset:41152
    v_mfma_f32_16x16x32_bf16 v[92:95], v[212:215], v[244:247], v[92:95]
    ds_read_b128 v[220:223], v249 offset:18432
    ds_read_b64_tr_b16 v[242:243], v250 offset:42432
    s_waitcnt lgkmcnt(10)
    v_mfma_f32_16x16x32_bf16 v[96:99], v[208:211], v[224:227], v[96:99]
    ds_read_b64_tr_b16 v[244:245], v251 offset:41152
    v_mfma_f32_16x16x32_bf16 v[100:103], v[212:215], v[224:227], v[100:103]
    ds_read_b64_tr_b16 v[246:247], v251 offset:42432
    s_waitcnt lgkmcnt(10)
    v_mfma_f32_16x16x32_bf16 v[104:107], v[208:211], v[228:231], v[104:107]
    ds_read_b64_tr_b16 v[224:225], v250 offset:41216
    v_mfma_f32_16x16x32_bf16 v[108:111], v[212:215], v[228:231], v[108:111]
    ds_read_b64_tr_b16 v[226:227], v250 offset:42496
    s_waitcnt lgkmcnt(10)
    v_mfma_f32_16x16x32_bf16 v[112:115], v[208:211], v[232:235], v[112:115]
    ds_read_b64_tr_b16 v[228:229], v251 offset:41216
    v_mfma_f32_16x16x32_bf16 v[116:119], v[212:215], v[232:235], v[116:119]
    ds_read_b64_tr_b16 v[230:231], v251 offset:42496
    s_waitcnt lgkmcnt(10)
    v_mfma_f32_16x16x32_bf16 v[120:123], v[208:211], v[236:239], v[120:123]
    ds_read_b64_tr_b16 v[232:233], v250 offset:51200
    v_mfma_f32_16x16x32_bf16 v[124:127], v[212:215], v[236:239], v[124:127]
    ds_read_b64_tr_b16 v[234:235], v250 offset:52480
    s_waitcnt lgkmcnt(8)
    v_mfma_f32_16x16x32_bf16 v[128:131], v[208:211], v[240:243], v[128:131]
    ds_read_b64_tr_b16 v[236:237], v251 offset:51200
    v_mfma_f32_16x16x32_bf16 v[132:135], v[212:215], v[240:243], v[132:135]
    ds_read_b64_tr_b16 v[238:239], v251 offset:52480
    s_waitcnt lgkmcnt(8)
    v_mfma_f32_16x16x32_bf16 v[136:139], v[208:211], v[244:247], v[136:139]
    ds_read_b64_tr_b16 v[240:241], v250 offset:51264
    v_mfma_f32_16x16x32_bf16 v[140:143], v[212:215], v[244:247], v[140:143]
    ds_read_b64_tr_b16 v[242:243], v250 offset:52544
    s_waitcnt lgkmcnt(8)
    v_mfma_f32_16x16x32_bf16 v[144:147], v[208:211], v[224:227], v[144:147]
    ds_read_b64_tr_b16 v[244:245], v251 offset:51264
    v_mfma_f32_16x16x32_bf16 v[148:151], v[212:215], v[224:227], v[148:151]
    ds_read_b64_tr_b16 v[246:247], v251 offset:52544
    s_waitcnt lgkmcnt(8)
    v_mfma_f32_16x16x32_bf16 v[152:155], v[208:211], v[228:231], v[152:155]
    ds_read_b64_tr_b16 v[224:225], v250 offset:51328
    v_mfma_f32_16x16x32_bf16 v[156:159], v[212:215], v[228:231], v[156:159]
    ds_read_b64_tr_b16 v[226:227], v250 offset:52608
    s_waitcnt lgkmcnt(8)
    v_mfma_f32_16x16x32_bf16 v[80:83], v[216:219], v[232:235], v[80:83]
    ds_read_b64_tr_b16 v[228:229], v251 offset:51328
    v_mfma_f32_16x16x32_bf16 v[84:87], v[220:223], v[232:235], v[84:87]
    ds_read_b64_tr_b16 v[230:231], v251 offset:52608
    s_waitcnt lgkmcnt(8)
    v_mfma_f32_16x16x32_bf16 v[88:91], v[216:219], v[236:239], v[88:91]
    ds_read_b128 v[208:211], v248 offset:32768
    ds_read_b64_tr_b16 v[232:233], v250 offset:51392
    v_mfma_f32_16x16x32_bf16 v[92:95], v[220:223], v[236:239], v[92:95]
    ds_read_b128 v[212:215], v248 offset:34816
    ds_read_b64_tr_b16 v[234:235], v250 offset:52672
    s_waitcnt lgkmcnt(10)
    v_mfma_f32_16x16x32_bf16 v[96:99], v[216:219], v[240:243], v[96:99]
    ds_read_b64_tr_b16 v[236:237], v251 offset:51392
    v_mfma_f32_16x16x32_bf16 v[100:103], v[220:223], v[240:243], v[100:103]
    ds_read_b64_tr_b16 v[238:239], v251 offset:52672
    s_waitcnt lgkmcnt(10)
    v_mfma_f32_16x16x32_bf16 v[104:107], v[216:219], v[244:247], v[104:107]
    ds_read_b64_tr_b16 v[240:241], v250 offset:51456
    v_mfma_f32_16x16x32_bf16 v[108:111], v[220:223], v[244:247], v[108:111]
    ds_read_b64_tr_b16 v[242:243], v250 offset:52736
    s_waitcnt lgkmcnt(10)
    v_mfma_f32_16x16x32_bf16 v[112:115], v[216:219], v[224:227], v[112:115]
    ds_read_b64_tr_b16 v[244:245], v251 offset:51456
    v_mfma_f32_16x16x32_bf16 v[116:119], v[220:223], v[224:227], v[116:119]
    ds_read_b64_tr_b16 v[246:247], v251 offset:52736
    s_waitcnt lgkmcnt(10)
    v_mfma_f32_16x16x32_bf16 v[120:123], v[216:219], v[228:231], v[120:123]
    ds_read_b64_tr_b16 v[224:225], v250 offset:61440
    v_mfma_f32_16x16x32_bf16 v[124:127], v[220:223], v[228:231], v[124:127]
    ds_read_b64_tr_b16 v[226:227], v250 offset:62720
    s_waitcnt lgkmcnt(8)
    v_mfma_f32_16x16x32_bf16 v[128:131], v[216:219], v[232:235], v[128:131]
    ds_read_b64_tr_b16 v[228:229], v251 offset:61440
    v_mfma_f32_16x16x32_bf16 v[132:135], v[220:223], v[232:235], v[132:135]
    ds_read_b64_tr_b16 v[230:231], v251 offset:62720
    s_waitcnt lgkmcnt(8)
    v_mfma_f32_16x16x32_bf16 v[136:139], v[216:219], v[236:239], v[136:139]
    ds_read_b64_tr_b16 v[232:233], v250 offset:61504
    v_mfma_f32_16x16x32_bf16 v[140:143], v[220:223], v[236:239], v[140:143]
    ds_read_b64_tr_b16 v[234:235], v250 offset:62784
    s_waitcnt lgkmcnt(8)
    v_mfma_f32_16x16x32_bf16 v[144:147], v[216:219], v[240:243], v[144:147]
    ds_read_b64_tr_b16 v[236:237], v251 offset:61504
    v_mfma_f32_16x16x32_bf16 v[148:151], v[220:223], v[240:243], v[148:151]
    ds_read_b64_tr_b16 v[238:239], v251 offset:62784
    s_waitcnt lgkmcnt(8)
    v_mfma_f32_16x16x32_bf16 v[152:155], v[216:219], v[244:247], v[152:155]
    ds_read_b64_tr_b16 v[240:241], v250 offset:61568
    v_mfma_f32_16x16x32_bf16 v[156:159], v[220:223], v[244:247], v[156:159]
    ds_read_b64_tr_b16 v[242:243], v250 offset:62848
    s_waitcnt vmcnt(0)
    v_max3_u32 v253, v200, v201, v202
    v_max3_u32 v253, v253, v203, v204
    v_max3_u32 v253, v253, v205, v206
    v_max_u32 v253, v253, v207
    v_cmp_eq_u32 vcc, -1, v253
    s_cbranch_vccnz L_cs1
L_cd1:
    v_mfma_f32_16x16x32_bf16 v[0:3], v[160:163], v[200:203], v[0:3]
    v_mfma_f32_16x16x32_bf16 v[4:7], v[160:163], v[204:207], v[4:7]
    v_mfma_f32_16x16x32_bf16 v[8:11], v[164:167], v[200:203], v[8:11]
    v_cvt_pk_bf16_f32 v160, v80, v81
    v_cvt_pk_bf16_f32 v161, v82, v83
    v_mfma_f32_16x16x32_bf16 v[12:15], v[164:167], v[204:207], v[12:15]
    v_cvt_pk_bf16_f32 v162, v84, v85
    v_cvt_pk_bf16_f32 v163, v86, v87
    v_mfma_f32_16x16x32_bf16 v[16:19], v[168:171], v[200:203], v[16:19]
    v_cvt_pk_bf16_f32 v164, v88, v89
    v_cvt_pk_bf16_f32 v165, v90, v91
    v_mfma_f32_16x16x32_bf16 v[20:23], v[168:171], v[204:207], v[20:23]
    v_cvt_pk_bf16_f32 v166, v92, v93
    v_cvt_pk_bf16_f32 v167, v94, v95
    v_mfma_f32_16x16x32_bf16 v[24:27], v[172:175], v[200:203], v[24:27]
    v_cvt_pk_bf16_f32 v168, v96, v97
    v_cvt_pk_bf16_f32 v169, v98, v99
    v_mfma_f32_16x16x32_bf16 v[28:31], v[172:175], v[204:207], v[28:31]
    v_cvt_pk_bf16_f32 v170, v100, v101
    v_cvt_pk_bf16_f32 v171, v102, v103
    v_mfma_f32_16x16x32_bf16 v[32:35], v[176:179], v[200:203], v[32:35]
    v_cvt_pk_bf16_f32 v172, v104, v105
    v_cvt_pk_bf16_f32 v173, v106, v107
    v_mfma_f32_16x16x32_bf16 v[36:39], v[176:179], v[204:207], v[36:39]
    v_cvt_pk_bf16_f32 v174, v108, v109
    v_cvt_pk_bf16_f32 v175, v110, v111
    v_mfma_f32_16x16x32_bf16 v[40:43], v[180:183], v[200:203], v[40:43]
    v_cvt_pk_bf16_f32 v176, v112, v113
    v_cvt_pk_bf16_f32 v177, v114, v115
    v_mfma_f32_16x16x32_bf16 v[44:47], v[180:183], v[204:207], v[44:47]
    v_cvt_pk_bf16_f32 v178, v116, v117
    v_cvt_pk_bf16_f32 v179, v118, v119
    v_mfma_f32_16x16x32_bf16 v[48:51], v[184:187], v[200:203], v[48:51]
    v_cvt_pk_bf16_f32 v180, v120, v121
    v_cvt_pk_bf16_f32 v181, v122, v123
    v_mfma_f32_16x16x32_bf16 v[52:55], v[184:187], v[204:207], v[52:55]
    v_cvt_pk_bf16_f32 v182, v124, v125
    v_cvt_pk_bf16_f32 v183, v126, v127
    v_mfma_f32_16x16x32_bf16 v[56:59], v[188:191], v[200:203], v[56:59]
    v_cvt_pk_bf16_f32 v184, v128, v129
    v_cvt_pk_bf16_f32 v185, v130, v131
    v_mfma_f32_16x16x32_bf16 v[60:63], v[188:191], v[204:207], v[60:63]
    v_cvt_pk_bf16_f32 v186, v132, v133
    v_cvt_pk_bf16_f32 v187, v134, v135
    v_mfma_f32_16x16x32_bf16 v[64:67], v[192:195], v[200:203], v[64:67]
    v_cvt_pk_bf16_f32 v188, v136, v137
    v_cvt_pk_bf16_f32 v189, v138, v139
    v_mfma_f32_16x16x32_bf16 v[68:71], v[192:195], v[204:207], v[68:71]
    v_cvt_pk_bf16_f32 v190, v140, v141
    v_cvt_pk_bf16_f32 v191, v142, v143
    v_mfma_f32_16x16x32_bf16 v[72:75], v[196:199], v[200:203], v[72:75]
    v_cvt_pk_bf16_f32 v192, v144, v145
    v_cvt_pk_bf16_f32 v193, v146, v147
    v_mfma_f32_16x16x32_bf16 v[76:79], v[196:199], v[204:207], v[76:79]
    v_cvt_pk_bf16_f32 v194, v148, v149
    v_cvt_pk_bf16_f32 v195, v150, v151
    s_xor_b32 s14, s18, 2
    s_and_b32 s14, s14, 7
    s_lshl_b32 s14, s14, 11
    s_add_u32 s14, s14, s17
    buffer_load_dwordx4 v[200:203], v252, s[64:67], s14 offen offset:0 sc1
    buffer_load_dwordx4 v[204:207], v252, s[64:67], s14 offen offset:1024 sc1
    s_barrier
    s_waitcnt lgkmcnt(8)
    v_mfma_f32_16x16x32_bf16 v[80:83], v[208:211], v[224:227], 0
    ds_read_b64_tr_b16 v[244:245], v251 offset:61568
    v_mfma_f32_16x16x32_bf16 v[84:87], v[212:215], v[224:227], 0
    ds_read_b64_tr_b16 v[246:247], v251 offset:62848
    v_cvt_pk_bf16_f32 v196, v152, v153
    s_waitcnt lgkmcnt(8)
    v_mfma_f32_16x16x32_bf16 v[88:91], v[208:211], v[228:231], 0
    ds_read_b128 v[216:219], v249 offset:32768
    ds_read_b64_tr_b16 v[224:225], v250 offset:61632
    v_mfma_f32_16x16x32_bf16 v[92:95], v[212:215], v[228:231], 0
    ds_read_b128 v[220:223], v249 offset:34816
    ds_read_b64_tr_b16 v[226:227], v250 offset:62912
    s_waitcnt lgkmcnt(10)
    v_mfma_f32_16x16x32_bf16 v[96:99], v[208:211], v[232:235], 0
    ds_read_b64_tr_b16 v[228:229], v251 offset:61632
    v_mfma_f32_16x16x32_bf16 v[100:103], v[212:215], v[232:235], 0
    ds_read_b64_tr_b16 v[230:231], v251 offset:62912
    v_cvt_pk_bf16_f32 v197, v154, v155
    s_waitcnt lgkmcnt(10)
    v_mfma_f32_16x16x32_bf16 v[104:107], v[208:211], v[236:239], 0
    ds_read_b64_tr_b16 v[232:233], v250 offset:61696
    v_mfma_f32_16x16x32_bf16 v[108:111], v[212:215], v[236:239], 0
    ds_read_b64_tr_b16 v[234:235], v250 offset:62976
    v_cvt_pk_bf16_f32 v198, v156, v157
    s_waitcnt lgkmcnt(10)
    v_mfma_f32_16x16x32_bf16 v[112:115], v[208:211], v[240:243], 0
    ds_read_b64_tr_b16 v[236:237], v251 offset:61696
    v_mfma_f32_16x16x32_bf16 v[116:119], v[212:215], v[240:243], 0
    ds_read_b64_tr_b16 v[238:239], v251 offset:62976
    v_cvt_pk_bf16_f32 v199, v158, v159
    s_waitcnt lgkmcnt(10)
    v_mfma_f32_16x16x32_bf16 v[120:123], v[208:211], v[244:247], 0
    v_add_u32 v250, 20480, v250
    v_add_u32 v251, 20480, v251
    ds_read_b64_tr_b16 v[240:241], v250 offset:51200
    v_mfma_f32_16x16x32_bf16 v[124:127], v[212:215], v[244:247], 0
    ds_read_b64_tr_b16 v[242:243], v250 offset:52480
    s_waitcnt lgkmcnt(8)
    v_mfma_f32_16x16x32_bf16 v[128:131], v[208:211], v[224:227], 0
    ds_read_b64_tr_b16 v[244:245], v251 offset:51200
    v_mfma_f32_16x16x32_bf16 v[132:135], v[212:215], v[224:227], 0
    ds_read_b64_tr_b16 v[246:247], v251 offset:52480
    s_waitcnt lgkmcnt(8)
    v_mfma_f32_16x16x32_bf16 v[136:139], v[208:211], v[228:231], 0
    ds_read_b64_tr_b16 v[224:225], v250 offset:51264
    v_mfma_f32_16x16x32_bf16 v[140:143], v[212:215], v[228:231], 0
    ds_read_b64_tr_b16 v[226:227], v250 offset:52544
    s_waitcnt lgkmcnt(8)
    v_mfma_f32_16x16x32_bf16 v[144:147], v[208:211], v[232:235], 0
    ds_read_b64_tr_b16 v[228:229], v251 offset:51264
    v_mfma_f32_16x16x32_bf16 v[148:151], v[212:215], v[232:235], 0
    ds_read_b64_tr_b16 v[230:231], v251 offset:52544
    s_waitcnt lgkmcnt(8)
    v_mfma_f32_16x16x32_bf16 v[152:155], v[208:211], v[236:239], 0
    ds_read_b64_tr_b16 v[232:233], v250 offset:51328
    v_mfma_f32_16x16x32_bf16 v[156:159], v[212:215], v[236:239], 0
    ds_read_b64_tr_b16 v[234:235], v250 offset:52608
    s_waitcnt lgkmcnt(8)
    v_mfma_f32_16x16x32_bf16 v[80:83], v[216:219], v[240:243], v[80:83]
    ds_read_b64_tr_b16 v[236:237], v251 offset:51328
    v_mfma_f32_16x16x32_bf16 v[84:87], v[220:223], v[240:243], v[84:87]
    ds_read_b64_tr_b16 v[238:239], v251 offset:52608
    s_waitcnt lgkmcnt(8)
    v_mfma_f32_16x16x32_bf16 v[88:91], v[216:219], v[244:247], v[88:91]
    ds_read_b128 v[208:211], v248 offset:49152
    ds_read_b64_tr_b16 v[240:241], v250 offset:51392
    v_mfma_f32_16x16x32_bf16 v[92:95], v[220:223], v[244:247], v[92:95]
    ds_read_b128 v[212:215], v248 offset:51200
    ds_read_b64_tr_b16 v[242:243], v250 offset:52672
    s_waitcnt lgkmcnt(10)
    v_mfma_f32_16x16x32_bf16 v[96:99], v[216:219], v[224:227], v[96:99]
    ds_read_b64_tr_b16 v[244:245], v251 offset:51392
    v_mfma_f32_16x16x32_bf16 v[100:103], v[220:223], v[224:227], v[100:103]
    ds_read_b64_tr_b16 v[246:247], v251 offset:52672
    s_waitcnt lgkmcnt(10)
    v_mfma_f32_16x16x32_bf16 v[104:107], v[216:219], v[228:231], v[104:107]
    ds_read_b64_tr_b16 v[224:225], v250 offset:51456
    v_mfma_f32_16x16x32_bf16 v[108:111], v[220:223], v[228:231], v[108:111]
    ds_read_b64_tr_b16 v[226:227], v250 offset:52736
    s_waitcnt lgkmcnt(10)
    v_mfma_f32_16x16x32_bf16 v[112:115], v[216:219], v[232:235], v[112:115]
    ds_read_b64_tr_b16 v[228:229], v251 offset:51456
    v_mfma_f32_16x16x32_bf16 v[116:119], v[220:223], v[232:235], v[116:119]
    ds_read_b64_tr_b16 v[230:231], v251 offset:52736
    s_waitcnt lgkmcnt(10)
    v_mfma_f32_16x16x32_bf16 v[120:123], v[216:219], v[236:239], v[120:123]
    v_add_u32 v250, 4294946816, v250
    v_add_u32 v251, 4294946816, v251
    ds_read_b64_tr_b16 v[232:233], v250 offset:0
    v_mfma_f32_16x16x32_bf16 v[124:127], v[220:223], v[236:239], v[124:127]
    ds_read_b64_tr_b16 v[234:235], v250 offset:1280
    s_waitcnt lgkmcnt(8)
    v_mfma_f32_16x16x32_bf16 v[128:131], v[216:219], v[240:243], v[128:131]
    ds_read_b64_tr_b16 v[236:237], v251 offset:0
    v_mfma_f32_16x16x32_bf16 v[132:135], v[220:223], v[240:243], v[132:135]
    ds_read_b64_tr_b16 v[238:239], v251 offset:1280
    s_waitcnt lgkmcnt(8)
    v_mfma_f32_16x16x32_bf16 v[136:139], v[216:219], v[244:247], v[136:139]
    ds_read_b64_tr_b16 v[240:241], v250 offset:64
    v_mfma_f32_16x16x32_bf16 v[140:143], v[220:223], v[244:247], v[140:143]
    ds_read_b64_tr_b16 v[242:243], v250 offset:1344
    s_waitcnt lgkmcnt(8)
    v_mfma_f32_16x16x32_bf16 v[144:147], v[216:219], v[224:227], v[144:147]
    ds_read_b64_tr_b16 v[244:245], v251 offset:64
    v_mfma_f32_16x16x32_bf16 v[148:151], v[220:223], v[224:227], v[148:151]
    ds_read_b64_tr_b16 v[246:247], v251 offset:1344
    s_waitcnt lgkmcnt(8)
    v_mfma_f32_16x16x32_bf16 v[152:155], v[216:219], v[228:231], v[152:155]
    ds_read_b64_tr_b16 v[224:225], v250 offset:128
    v_mfma_f32_16x16x32_bf16 v[156:159], v[220:223], v[228:231], v[156:159]
    ds_read_b64_tr_b16 v[226:227], v250 offset:1408
    s_barrier
    s_waitcnt lgkmcnt(8)
    v_mfma_f32_16x16x32_bf16 v[80:83], v[208:211], v[232:235], v[80:83]
    ds_read_b64_tr_b16 v[228:229], v251 offset:128
    v_mfma_f32_16x16x32_bf16 v[84:87], v[212:215], v[232:235], v[84:87]
    ds_read_b64_tr_b16 v[230:231], v251 offset:1408
    s_waitcnt lgkmcnt(8)
    v_mfma_f32_16x16x32_bf16 v[88:91], v[208:211], v[236:239], v[88:91]
    ds_read_b128 v[216:219], v249 offset:49152
    ds_read_b64_tr_b16 v[232:233], v250 offset:192
    v_mfma_f32_16x16x32_bf16 v[92:95], v[212:215], v[236:239], v[92:95]
    ds_read_b128 v[220:223], v249 offset:51200
    ds_read_b64_tr_b16 v[234:235], v250 offset:1472
    s_waitcnt lgkmcnt(10)
    v_mfma_f32_16x16x32_bf16 v[96:99], v[208:211], v[240:243], v[96:99]
    ds_read_b64_tr_b16 v[236:237], v251 offset:192
    v_mfma_f32_16x16x32_bf16 v[100:103], v[212:215], v[240:243], v[100:103]
    ds_read_b64_tr_b16 v[238:239], v251 offset:1472
    s_waitcnt lgkmcnt(10)
    v_mfma_f32_16x16x32_bf16 v[104:107], v[208:211], v[244:247], v[104:107]
    ds_read_b64_tr_b16 v[240:241], v250 offset:256
    v_mfma_f32_16x16x32_bf16 v[108:111], v[212:215], v[244:247], v[108:111]
    ds_read_b64_tr_b16 v[242:243], v250 offset:1536
    s_waitcnt lgkmcnt(10)
    v_mfma_f32_16x16x32_bf16 v[112:115], v[208:211], v[224:227], v[112:115]
    ds_read_b64_tr_b16 v[244:245], v251 offset:256
    v_mfma_f32_16x16x32_bf16 v[116:119], v[212:215], v[224:227], v[116:119]
    ds_read_b64_tr_b16 v[246:247], v251 offset:1536
    s_waitcnt lgkmcnt(10)
    v_mfma_f32_16x16x32_bf16 v[120:123], v[208:211], v[228:231], v[120:123]
    ds_read_b64_tr_b16 v[224:225], v250 offset:10240
    v_mfma_f32_16x16x32_bf16 v[124:127], v[212:215], v[228:231], v[124:127]
    ds_read_b64_tr_b16 v[226:227], v250 offset:11520
    s_waitcnt lgkmcnt(8)
    v_mfma_f32_16x16x32_bf16 v[128:131], v[208:211], v[232:235], v[128:131]
    ds_read_b64_tr_b16 v[228:229], v251 offset:10240
    v_mfma_f32_16x16x32_bf16 v[132:135], v[212:215], v[232:235], v[132:135]
    ds_read_b64_tr_b16 v[230:231], v251 offset:11520
    s_waitcnt lgkmcnt(8)
    v_mfma_f32_16x16x32_bf16 v[136:139], v[208:211], v[236:239], v[136:139]
    ds_read_b64_tr_b16 v[232:233], v250 offset:10304
    v_mfma_f32_16x16x32_bf16 v[140:143], v[212:215], v[236:239], v[140:143]
    ds_read_b64_tr_b16 v[234:235], v250 offset:11584
    s_waitcnt lgkmcnt(8)
    v_mfma_f32_16x16x32_bf16 v[144:147], v[208:211], v[240:243], v[144:147]
    ds_read_b64_tr_b16 v[236:237], v251 offset:10304
    v_mfma_f32_16x16x32_bf16 v[148:151], v[212:215], v[240:243], v[148:151]
    ds_read_b64_tr_b16 v[238:239], v251 offset:11584
    s_waitcnt lgkmcnt(8)
    v_mfma_f32_16x16x32_bf16 v[152:155], v[208:211], v[244:247], v[152:155]
    ds_read_b64_tr_b16 v[240:241], v250 offset:10368
    v_mfma_f32_16x16x32_bf16 v[156:159], v[212:215], v[244:247], v[156:159]
    ds_read_b64_tr_b16 v[242:243], v250 offset:11648
    s_waitcnt lgkmcnt(8)
    v_mfma_f32_16x16x32_bf16 v[80:83], v[216:219], v[224:227], v[80:83]
    ds_read_b64_tr_b16 v[244:245], v251 offset:10368
    v_mfma_f32_16x16x32_bf16 v[84:87], v[220:223], v[224:227], v[84:87]
    ds_read_b64_tr_b16 v[246:247], v251 offset:11648
    s_waitcnt lgkmcnt(8)
    v_mfma_f32_16x16x32_bf16 v[88:91], v[216:219], v[228:231], v[88:91]
    ds_read_b128 v[208:211], v248 offset:0
    ds_read_b64_tr_b16 v[224:225], v250 offset:10432
    v_mfma_f32_16x16x32_bf16 v[92:95], v[220:223], v[228:231], v[92:95]
    ds_read_b128 v[212:215], v248 offset:2048
    ds_read_b64_tr_b16 v[226:227], v250 offset:11712
    s_waitcnt lgkmcnt(10)
    v_mfma_f32_16x16x32_bf16 v[96:99], v[216:219], v[232:235], v[96:99]
    ds_read_b64_tr_b16 v[228:229], v251 offset:10432
    v_mfma_f32_16x16x32_bf16 v[100:103], v[220:223], v[232:235], v[100:103]
    ds_read_b64_tr_b16 v[230:231], v251 offset:11712
    s_waitcnt lgkmcnt(10)
    v_mfma_f32_16x16x32_bf16 v[104:107], v[216:219], v[236:239], v[104:107]
    ds_read_b64_tr_b16 v[232:233], v250 offset:10496
    v_mfma_f32_16x16x32_bf16 v[108:111], v[220:223], v[236:239], v[108:111]
    ds_read_b64_tr_b16 v[234:235], v250 offset:11776
    s_waitcnt lgkmcnt(10)
    v_mfma_f32_16x16x32_bf16 v[112:115], v[216:219], v[240:243], v[112:115]
    ds_read_b64_tr_b16 v[236:237], v251 offset:10496
    v_mfma_f32_16x16x32_bf16 v[116:119], v[220:223], v[240:243], v[116:119]
    ds_read_b64_tr_b16 v[238:239], v251 offset:11776
    s_waitcnt lgkmcnt(10)
    v_mfma_f32_16x16x32_bf16 v[120:123], v[216:219], v[244:247], v[120:123]
    ds_read_b64_tr_b16 v[240:241], v250 offset:20480
    v_mfma_f32_16x16x32_bf16 v[124:127], v[220:223], v[244:247], v[124:127]
    ds_read_b64_tr_b16 v[242:243], v250 offset:21760
    s_waitcnt lgkmcnt(8)
    v_mfma_f32_16x16x32_bf16 v[128:131], v[216:219], v[224:227], v[128:131]
    ds_read_b64_tr_b16 v[244:245], v251 offset:20480
    v_mfma_f32_16x16x32_bf16 v[132:135], v[220:223], v[224:227], v[132:135]
    ds_read_b64_tr_b16 v[246:247], v251 offset:21760
    s_waitcnt lgkmcnt(8)
    v_mfma_f32_16x16x32_bf16 v[136:139], v[216:219], v[228:231], v[136:139]
    ds_read_b64_tr_b16 v[224:225], v250 offset:20544
    v_mfma_f32_16x16x32_bf16 v[140:143], v[220:223], v[228:231], v[140:143]
    ds_read_b64_tr_b16 v[226:227], v250 offset:21824
    s_waitcnt lgkmcnt(8)
    v_mfma_f32_16x16x32_bf16 v[144:147], v[216:219], v[232:235], v[144:147]
    ds_read_b64_tr_b16 v[228:229], v251 offset:20544
    v_mfma_f32_16x16x32_bf16 v[148:151], v[220:223], v[232:235], v[148:151]
    ds_read_b64_tr_b16 v[230:231], v251 offset:21824
    s_waitcnt lgkmcnt(8)
    v_mfma_f32_16x16x32_bf16 v[152:155], v[216:219], v[236:239], v[152:155]
    ds_read_b64_tr_b16 v[232:233], v250 offset:20608
    v_mfma_f32_16x16x32_bf16 v[156:159], v[220:223], v[236:239], v[156:159]
    ds_read_b64_tr_b16 v[234:235], v250 offset:21888
    s_waitcnt vmcnt(0)
    v_mfma_f32_16x16x32_bf16 v[0:3], v[160:163], v[200:203], v[0:3]
    v_mfma_f32_16x16x32_bf16 v[4:7], v[160:163], v[204:207], v[4:7]
    v_mfma_f32_16x16x32_bf16 v[8:11], v[164:167], v[200:203], v[8:11]
    v_cvt_pk_bf16_f32 v160, v80, v81
    v_cvt_pk_bf16_f32 v161, v82, v83
    v_mfma_f32_16x16x32_bf16 v[12:15], v[164:167], v[204:207], v[12:15]
    v_cvt_pk_bf16_f32 v162, v84, v85
    v_cvt_pk_bf16_f32 v163, v86, v87
    v_mfma_f32_16x16x32_bf16 v[16:19], v[168:171], v[200:203], v[16:19]
    v_cvt_pk_bf16_f32 v164, v88, v89
    v_cvt_pk_bf16_f32 v165, v90, v91
    v_mfma_f32_16x16x32_bf16 v[20:23], v[168:171], v[204:207], v[20:23]
    v_cvt_pk_bf16_f32 v166, v92, v93
    v_cvt_pk_bf16_f32 v167, v94, v95
    v_mfma_f32_16x16x32_bf16 v[24:27], v[172:175], v[200:203], v[24:27]
    v_cvt_pk_bf16_f32 v168, v96, v97
    v_cvt_pk_bf16_f32 v169, v98, v99
    v_mfma_f32_16x16x32_bf16 v[28:31], v[172:175], v[204:207], v[28:31]
    v_cvt_pk_bf16_f32 v170, v100, v101
    v_cvt_pk_bf16_f32 v171, v102, v103
    v_mfma_f32_16x16x32_bf16 v[32:35], v[176:179], v[200:203], v[32:35]
    v_cvt_pk_bf16_f32 v172, v104, v105
    v_cvt_pk_bf16_f32 v173, v106, v107
    v_mfma_f32_16x16x32_bf16 v[36:39], v[176:179], v[204:207], v[36:39]
    v_cvt_pk_bf16_f32 v174, v108, v109
    v_cvt_pk_bf16_f32 v175, v110, v111
    v_mfma_f32_16x16x32_bf16 v[40:43], v[180:183], v[200:203], v[40:43]
    v_cvt_pk_bf16_f32 v176, v112, v113
    v_cvt_pk_bf16_f32 v177, v114, v115
    v_mfma_f32_16x16x32_bf16 v[44:47], v[180:183], v[204:207], v[44:47]
    v_cvt_pk_bf16_f32 v178, v116, v117
    v_cvt_pk_bf16_f32 v179, v118, v119
    v_mfma_f32_16x16x32_bf16 v[48:51], v[184:187], v[200:203], v[48:51]
    v_cvt_pk_bf16_f32 v180, v120, v121
    v_cvt_pk_bf16_f32 v181, v122, v123
    v_mfma_f32_16x16x32_bf16 v[52:55], v[184:187], v[204:207], v[52:55]
    v_cvt_pk_bf16_f32 v182, v124, v125
    v_cvt_pk_bf16_f32 v183, v126, v127
    v_mfma_f32_16x16x32_bf16 v[56:59], v[188:191], v[200:203], v[56:59]
    v_cvt_pk_bf16_f32 v184, v128, v129
    v_cvt_pk_bf16_f32 v185, v130, v131
    v_mfma_f32_16x16x32_bf16 v[60:63], v[188:191], v[204:207], v[60:63]
    v_cvt_pk_bf16_f32 v186, v132, v133
    v_cvt_pk_bf16_f32 v187, v134, v135
    v_mfma_f32_16x16x32_bf16 v[64:67], v[192:195], v[200:203], v[64:67]
    v_cvt_pk_bf16_f32 v188, v136, v137
    v_cvt_pk_bf16_f32 v189, v138, v139
    v_mfma_f32_16x16x32_bf16 v[68:71], v[192:195], v[204:207], v[68:71]
    v_cvt_pk_bf16_f32 v190, v140, v141
    v_cvt_pk_bf16_f32 v191, v142, v143
    v_mfma_f32_16x16x32_bf16 v[72:75], v[196:199], v[200:203], v[72:75]
    v_cvt_pk_bf16_f32 v192, v144, v145
    v_cvt_pk_bf16_f32 v193, v146, v147
    v_mfma_f32_16x16x32_bf16 v[76:79], v[196:199], v[204:207], v[76:79]
    v_cvt_pk_bf16_f32 v194, v148, v149
    v_cvt_pk_bf16_f32 v195, v150, v151
    s_xor_b32 s14, s18, 3
    s_and_b32 s14, s14, 7
    s_lshl_b32 s14, s14, 11
    s_add_u32 s14, s14, s17
    buffer_load_dwordx4 v[200:203], v252, s[64:67], s14 offen offset:0 sc1
    buffer_load_dwordx4 v[204:207], v252, s[64:67], s14 offen offset:1024 sc1
    s_barrier
    s_waitcnt lgkmcnt(8)
    v_mfma_f32_16x16x32_bf16 v[80:83], v[208:211], v[240:243], 0
    ds_read_b64_tr_b16 v[236:237], v251 offset:20608
    v_mfma_f32_16x16x32_bf16 v[84:87], v[212:215], v[240:243], 0
    ds_read_b64_tr_b16 v[238:239], v251 offset:21888
    v_cvt_pk_bf16_f32 v196, v152, v153
    s_waitcnt lgkmcnt(8)
    v_mfma_f32_16x16x32_bf16 v[88:91], v[208:211], v[244:247], 0
    ds_read_b128 v[216:219], v249 offset:0
    ds_read_b64_tr_b16 v[240:241], v250 offset:20672
    v_mfma_f32_16x16x32_bf16 v[92:95], v[212:215], v[244:247], 0
    ds_read_b128 v[220:223], v249 offset:2048
    ds_read_b64_tr_b16 v[242:243], v250 offset:21952
    s_waitcnt lgkmcnt(10)
    v_mfma_f32_16x16x32_bf16 v[96:99], v[208:211], v[224:227], 0
    ds_read_b64_tr_b16 v[244:245], v251 offset:20672
    v_mfma_f32_16x16x32_bf16 v[100:103], v[212:215], v[224:227], 0
    ds_read_b64_tr_b16 v[246:247], v251 offset:21952
    v_cvt_pk_bf16_f32 v197, v154, v155
    s_waitcnt lgkmcnt(10)
    v_mfma_f32_16x16x32_bf16 v[104:107], v[208:211], v[228:231], 0
    ds_read_b64_tr_b16 v[224:225], v250 offset:20736
    v_mfma_f32_16x16x32_bf16 v[108:111], v[212:215], v[228:231], 0
    ds_read_b64_tr_b16 v[226:227], v250 offset:22016
    v_cvt_pk_bf16_f32 v198, v156, v157
    s_waitcnt lgkmcnt(10)
    v_mfma_f32_16x16x32_bf16 v[112:115], v[208:211], v[232:235], 0
    ds_read_b64_tr_b16 v[228:229], v251 offset:20736
    v_mfma_f32_16x16x32_bf16 v[116:119], v[212:215], v[232:235], 0
    ds_read_b64_tr_b16 v[230:231], v251 offset:22016
    v_cvt_pk_bf16_f32 v199, v158, v159
    s_waitcnt lgkmcnt(10)
    v_mfma_f32_16x16x32_bf16 v[120:123], v[208:211], v[236:239], 0
    ds_read_b64_tr_b16 v[232:233], v250 offset:30720
    v_mfma_f32_16x16x32_bf16 v[124:127], v[212:215], v[236:239], 0
    ds_read_b64_tr_b16 v[234:235], v250 offset:32000
    s_waitcnt lgkmcnt(8)
    v_mfma_f32_16x16x32_bf16 v[128:131], v[208:211], v[240:243], 0
    ds_read_b64_tr_b16 v[236:237], v251 offset:30720
    v_mfma_f32_16x16x32_bf16 v[132:135], v[212:215], v[240:243], 0
    ds_read_b64_tr_b16 v[238:239], v251 offset:32000
    s_waitcnt lgkmcnt(8)
    v_mfma_f32_16x16x32_bf16 v[136:139], v[208:211], v[244:247], 0
    ds_read_b64_tr_b16 v[240:241], v250 offset:30784
    v_mfma_f32_16x16x32_bf16 v[140:143], v[212:215], v[244:247], 0
    ds_read_b64_tr_b16 v[242:243], v250 offset:32064
    s_waitcnt lgkmcnt(8)
    v_mfma_f32_16x16x32_bf16 v[144:147], v[208:211], v[224:227], 0
    ds_read_b64_tr_b16 v[244:245], v251 offset:30784
    v_mfma_f32_16x16x32_bf16 v[148:151], v[212:215], v[224:227], 0
    ds_read_b64_tr_b16 v[246:247], v251 offset:32064
    s_waitcnt lgkmcnt(8)
    v_mfma_f32_16x16x32_bf16 v[152:155], v[208:211], v[228:231], 0
    ds_read_b64_tr_b16 v[224:225], v250 offset:30848
    v_mfma_f32_16x16x32_bf16 v[156:159], v[212:215], v[228:231], 0
    ds_read_b64_tr_b16 v[226:227], v250 offset:32128
    s_waitcnt lgkmcnt(8)
    v_mfma_f32_16x16x32_bf16 v[80:83], v[216:219], v[232:235], v[80:83]
    ds_read_b64_tr_b16 v[228:229], v251 offset:30848
    v_mfma_f32_16x16x32_bf16 v[84:87], v[220:223], v[232:235], v[84:87]
    ds_read_b64_tr_b16 v[230:231], v251 offset:32128
    s_waitcnt lgkmcnt(8)
    v_mfma_f32_16x16x32_bf16 v[88:91], v[216:219], v[236:239], v[88:91]
    ds_read_b128 v[208:211], v248 offset:16384
    ds_read_b64_tr_b16 v[232:233], v250 offset:30912
    v_mfma_f32_16x16x32_bf16 v[92:95], v[220:223], v[236:239], v[92:95]
    ds_read_b128 v[212:215], v248 offset:18432
    ds_read_b64_tr_b16 v[234:235], v250 offset:32192
    s_waitcnt lgkmcnt(10)
    v_mfma_f32_16x16x32_bf16 v[96:99], v[216:219], v[240:243], v[96:99]
    ds_read_b64_tr_b16 v[236:237], v251 offset:30912
    v_mfma_f32_16x16x32_bf16 v[100:103], v[220:223], v[240:243], v[100:103]
    ds_read_b64_tr_b16 v[238:239], v251 offset:32192
    s_waitcnt lgkmcnt(10)
    v_mfma_f32_16x16x32_bf16 v[104:107], v[216:219], v[244:247], v[104:107]
    ds_read_b64_tr_b16 v[240:241], v250 offset:30976
    v_mfma_f32_16x16x32_bf16 v[108:111], v[220:223], v[244:247], v[108:111]
    ds_read_b64_tr_b16 v[242:243], v250 offset:32256
    s_waitcnt lgkmcnt(10)
    v_mfma_f32_16x16x32_bf16 v[112:115], v[216:219], v[224:227], v[112:115]
    ds_read_b64_tr_b16 v[244:245], v251 offset:30976
    v_mfma_f32_16x16x32_bf16 v[116:119], v[220:223], v[224:227], v[116:119]
    ds_read_b64_tr_b16 v[246:247], v251 offset:32256
    s_waitcnt lgkmcnt(10)
    v_mfma_f32_16x16x32_bf16 v[120:123], v[216:219], v[228:231], v[120:123]
    ds_read_b64_tr_b16 v[224:225], v250 offset:40960
    v_mfma_f32_16x16x32_bf16 v[124:127], v[220:223], v[228:231], v[124:127]
    ds_read_b64_tr_b16 v[226:227], v250 offset:42240
    s_waitcnt lgkmcnt(8)
    v_mfma_f32_16x16x32_bf16 v[128:131], v[216:219], v[232:235], v[128:131]
    ds_read_b64_tr_b16 v[228:229], v251 offset:40960
    v_mfma_f32_16x16x32_bf16 v[132:135], v[220:223], v[232:235], v[132:135]
    ds_read_b64_tr_b16 v[230:231], v251 offset:42240
    s_waitcnt lgkmcnt(8)
    v_mfma_f32_16x16x32_bf16 v[136:139], v[216:219], v[236:239], v[136:139]
    ds_read_b64_tr_b16 v[232:233], v250 offset:41024
    v_mfma_f32_16x16x32_bf16 v[140:143], v[220:223], v[236:239], v[140:143]
    ds_read_b64_tr_b16 v[234:235], v250 offset:42304
    s_waitcnt lgkmcnt(8)
    v_mfma_f32_16x16x32_bf16 v[144:147], v[216:219], v[240:243], v[144:147]
    ds_read_b64_tr_b16 v[236:237], v251 offset:41024
    v_mfma_f32_16x16x32_bf16 v[148:151], v[220:223], v[240:243], v[148:151]
    ds_read_b64_tr_b16 v[238:239], v251 offset:42304
    s_waitcnt lgkmcnt(8)
    v_mfma_f32_16x16x32_bf16 v[152:155], v[216:219], v[244:247], v[152:155]
    ds_read_b64_tr_b16 v[240:241], v250 offset:41088
    v_mfma_f32_16x16x32_bf16 v[156:159], v[220:223], v[244:247], v[156:159]
    ds_read_b64_tr_b16 v[242:243], v250 offset:42368
    s_barrier
    s_waitcnt lgkmcnt(8)
    v_mfma_f32_16x16x32_bf16 v[80:83], v[208:211], v[224:227], v[80:83]
    ds_read_b64_tr_b16 v[244:245], v251 offset:41088
    v_mfma_f32_16x16x32_bf16 v[84:87], v[212:215], v[224:227], v[84:87]
    ds_read_b64_tr_b16 v[246:247], v251 offset:42368
    s_waitcnt lgkmcnt(8)
    v_mfma_f32_16x16x32_bf16 v[88:91], v[208:211], v[228:231], v[88:91]
    ds_read_b128 v[216:219], v249 offset:16384
    ds_read_b64_tr_b16 v[224:225], v250 offset:41152
    v_mfma_f32_16x16x32_bf16 v[92:95], v[212:215], v[228:231], v[92:95]
    ds_read_b128 v[220:223], v249 offset:18432
    ds_read_b64_tr_b16 v[226:227], v250 offset:42432
    s_waitcnt lgkmcnt(10)
    v_mfma_f32_16x16x32_bf16 v[96:99], v[208:211], v[232:235], v[96:99]
    ds_read_b64_tr_b16 v[228:229], v251 offset:41152
    v_mfma_f32_16x16x32_bf16 v[100:103], v[212:215], v[232:235], v[100:103]
    ds_read_b64_tr_b16 v[230:231], v251 offset:42432
    s_waitcnt lgkmcnt(10)
    v_mfma_f32_16x16x32_bf16 v[104:107], v[208:211], v[236:239], v[104:107]
    ds_read_b64_tr_b16 v[232:233], v250 offset:41216
    v_mfma_f32_16x16x32_bf16 v[108:111], v[212:215], v[236:239], v[108:111]
    ds_read_b64_tr_b16 v[234:235], v250 offset:42496
    s_waitcnt lgkmcnt(10)
    v_mfma_f32_16x16x32_bf16 v[112:115], v[208:211], v[240:243], v[112:115]
    ds_read_b64_tr_b16 v[236:237], v251 offset:41216
    v_mfma_f32_16x16x32_bf16 v[116:119], v[212:215], v[240:243], v[116:119]
    ds_read_b64_tr_b16 v[238:239], v251 offset:42496
    s_waitcnt lgkmcnt(10)
    v_mfma_f32_16x16x32_bf16 v[120:123], v[208:211], v[244:247], v[120:123]
    ds_read_b64_tr_b16 v[240:241], v250 offset:51200
    v_mfma_f32_16x16x32_bf16 v[124:127], v[212:215], v[244:247], v[124:127]
    ds_read_b64_tr_b16 v[242:243], v250 offset:52480
    s_waitcnt lgkmcnt(8)
    v_mfma_f32_16x16x32_bf16 v[128:131], v[208:211], v[224:227], v[128:131]
    ds_read_b64_tr_b16 v[244:245], v251 offset:51200
    v_mfma_f32_16x16x32_bf16 v[132:135], v[212:215], v[224:227], v[132:135]
    ds_read_b64_tr_b16 v[246:247], v251 offset:52480
    s_waitcnt lgkmcnt(8)
    v_mfma_f32_16x16x32_bf16 v[136:139], v[208:211], v[228:231], v[136:139]
    ds_read_b64_tr_b16 v[224:225], v250 offset:51264
    v_mfma_f32_16x16x32_bf16 v[140:143], v[212:215], v[228:231], v[140:143]
    ds_read_b64_tr_b16 v[226:227], v250 offset:52544
    s_waitcnt lgkmcnt(8)
    v_mfma_f32_16x16x32_bf16 v[144:147], v[208:211], v[232:235], v[144:147]
    ds_read_b64_tr_b16 v[228:229], v251 offset:51264
    v_mfma_f32_16x16x32_bf16 v[148:151], v[212:215], v[232:235], v[148:151]
    ds_read_b64_tr_b16 v[230:231], v251 offset:52544
    s_waitcnt lgkmcnt(8)
    v_mfma_f32_16x16x32_bf16 v[152:155], v[208:211], v[236:239], v[152:155]
    ds_read_b64_tr_b16 v[232:233], v250 offset:51328
    v_mfma_f32_16x16x32_bf16 v[156:159], v[212:215], v[236:239], v[156:159]
    ds_read_b64_tr_b16 v[234:235], v250 offset:52608
    s_waitcnt lgkmcnt(8)
    v_mfma_f32_16x16x32_bf16 v[80:83], v[216:219], v[240:243], v[80:83]
    ds_read_b64_tr_b16 v[236:237], v251 offset:51328
    v_mfma_f32_16x16x32_bf16 v[84:87], v[220:223], v[240:243], v[84:87]
    ds_read_b64_tr_b16 v[238:239], v251 offset:52608
    s_waitcnt lgkmcnt(8)
    v_mfma_f32_16x16x32_bf16 v[88:91], v[216:219], v[244:247], v[88:91]
    ds_read_b128 v[208:211], v248 offset:32768
    ds_read_b64_tr_b16 v[240:241], v250 offset:51392
    v_mfma_f32_16x16x32_bf16 v[92:95], v[220:223], v[244:247], v[92:95]
    ds_read_b128 v[212:215], v248 offset:34816
    ds_read_b64_tr_b16 v[242:243], v250 offset:52672
    s_waitcnt lgkmcnt(10)
    v_mfma_f32_16x16x32_bf16 v[96:99], v[216:219], v[224:227], v[96:99]
    ds_read_b64_tr_b16 v[244:245], v251 offset:51392
    v_mfma_f32_16x16x32_bf16 v[100:103], v[220:223], v[224:227], v[100:103]
    ds_read_b64_tr_b16 v[246:247], v251 offset:52672
    s_waitcnt lgkmcnt(10)
    v_mfma_f32_16x16x32_bf16 v[104:107], v[216:219], v[228:231], v[104:107]
    ds_read_b64_tr_b16 v[224:225], v250 offset:51456
    v_mfma_f32_16x16x32_bf16 v[108:111], v[220:223], v[228:231], v[108:111]
    ds_read_b64_tr_b16 v[226:227], v250 offset:52736
    s_waitcnt lgkmcnt(10)
    v_mfma_f32_16x16x32_bf16 v[112:115], v[216:219], v[232:235], v[112:115]
    ds_read_b64_tr_b16 v[228:229], v251 offset:51456
    v_mfma_f32_16x16x32_bf16 v[116:119], v[220:223], v[232:235], v[116:119]
    ds_read_b64_tr_b16 v[230:231], v251 offset:52736
    s_waitcnt lgkmcnt(10)
    v_mfma_f32_16x16x32_bf16 v[120:123], v[216:219], v[236:239], v[120:123]
    ds_read_b64_tr_b16 v[232:233], v250 offset:61440
    v_mfma_f32_16x16x32_bf16 v[124:127], v[220:223], v[236:239], v[124:127]
    ds_read_b64_tr_b16 v[234:235], v250 offset:62720
    s_waitcnt lgkmcnt(8)
    v_mfma_f32_16x16x32_bf16 v[128:131], v[216:219], v[240:243], v[128:131]
    ds_read_b64_tr_b16 v[236:237], v251 offset:61440
    v_mfma_f32_16x16x32_bf16 v[132:135], v[220:223], v[240:243], v[132:135]
    ds_read_b64_tr_b16 v[238:239], v251 offset:62720
    s_waitcnt lgkmcnt(8)
    v_mfma_f32_16x16x32_bf16 v[136:139], v[216:219], v[244:247], v[136:139]
    ds_read_b64_tr_b16 v[240:241], v250 offset:61504
    v_mfma_f32_16x16x32_bf16 v[140:143], v[220:223], v[244:247], v[140:143]
    ds_read_b64_tr_b16 v[242:243], v250 offset:62784
    s_waitcnt lgkmcnt(8)
    v_mfma_f32_16x16x32_bf16 v[144:147], v[216:219], v[224:227], v[144:147]
    ds_read_b64_tr_b16 v[244:245], v251 offset:61504
    v_mfma_f32_16x16x32_bf16 v[148:151], v[220:223], v[224:227], v[148:151]
    ds_read_b64_tr_b16 v[246:247], v251 offset:62784
    s_waitcnt lgkmcnt(8)
    v_mfma_f32_16x16x32_bf16 v[152:155], v[216:219], v[228:231], v[152:155]
    ds_read_b64_tr_b16 v[224:225], v250 offset:61568
    v_mfma_f32_16x16x32_bf16 v[156:159], v[220:223], v[228:231], v[156:159]
    ds_read_b64_tr_b16 v[226:227], v250 offset:62848
    s_waitcnt vmcnt(0)
    v_mfma_f32_16x16x32_bf16 v[0:3], v[160:163], v[200:203], v[0:3]
    v_mfma_f32_16x16x32_bf16 v[4:7], v[160:163], v[204:207], v[4:7]
    v_mfma_f32_16x16x32_bf16 v[8:11], v[164:167], v[200:203], v[8:11]
    v_cvt_pk_bf16_f32 v160, v80, v81
    v_cvt_pk_bf16_f32 v161, v82, v83
    v_mfma_f32_16x16x32_bf16 v[12:15], v[164:167], v[204:207], v[12:15]
    v_cvt_pk_bf16_f32 v162, v84, v85
    v_cvt_pk_bf16_f32 v163, v86, v87
    v_mfma_f32_16x16x32_bf16 v[16:19], v[168:171], v[200:203], v[16:19]
    v_cvt_pk_bf16_f32 v164, v88, v89
    v_cvt_pk_bf16_f32 v165, v90, v91
    v_mfma_f32_16x16x32_bf16 v[20:23], v[168:171], v[204:207], v[20:23]
    v_cvt_pk_bf16_f32 v166, v92, v93
    v_cvt_pk_bf16_f32 v167, v94, v95
    v_mfma_f32_16x16x32_bf16 v[24:27], v[172:175], v[200:203], v[24:27]
    v_cvt_pk_bf16_f32 v168, v96, v97
    v_cvt_pk_bf16_f32 v169, v98, v99
    v_mfma_f32_16x16x32_bf16 v[28:31], v[172:175], v[204:207], v[28:31]
    v_cvt_pk_bf16_f32 v170, v100, v101
    v_cvt_pk_bf16_f32 v171, v102, v103
    v_mfma_f32_16x16x32_bf16 v[32:35], v[176:179], v[200:203], v[32:35]
    v_cvt_pk_bf16_f32 v172, v104, v105
    v_cvt_pk_bf16_f32 v173, v106, v107
    v_mfma_f32_16x16x32_bf16 v[36:39], v[176:179], v[204:207], v[36:39]
    v_cvt_pk_bf16_f32 v174, v108, v109
    v_cvt_pk_bf16_f32 v175, v110, v111
    v_mfma_f32_16x16x32_bf16 v[40:43], v[180:183], v[200:203], v[40:43]
    v_cvt_pk_bf16_f32 v176, v112, v113
    v_cvt_pk_bf16_f32 v177, v114, v115
    v_mfma_f32_16x16x32_bf16 v[44:47], v[180:183], v[204:207], v[44:47]
    v_cvt_pk_bf16_f32 v178, v116, v117
    v_cvt_pk_bf16_f32 v179, v118, v119
    v_mfma_f32_16x16x32_bf16 v[48:51], v[184:187], v[200:203], v[48:51]
    v_cvt_pk_bf16_f32 v180, v120, v121
    v_cvt_pk_bf16_f32 v181, v122, v123
    v_mfma_f32_16x16x32_bf16 v[52:55], v[184:187], v[204:207], v[52:55]
    v_cvt_pk_bf16_f32 v182, v124, v125
    v_cvt_pk_bf16_f32 v183, v126, v127
    v_mfma_f32_16x16x32_bf16 v[56:59], v[188:191], v[200:203], v[56:59]
    v_cvt_pk_bf16_f32 v184, v128, v129
    v_cvt_pk_bf16_f32 v185, v130, v131
    v_mfma_f32_16x16x32_bf16 v[60:63], v[188:191], v[204:207], v[60:63]
    v_cvt_pk_bf16_f32 v186, v132, v133
    v_cvt_pk_bf16_f32 v187, v134, v135
    v_mfma_f32_16x16x32_bf16 v[64:67], v[192:195], v[200:203], v[64:67]
    v_cvt_pk_bf16_f32 v188, v136, v137
    v_cvt_pk_bf16_f32 v189, v138, v139
    v_mfma_f32_16x16x32_bf16 v[68:71], v[192:195], v[204:207], v[68:71]
    v_cvt_pk_bf16_f32 v190, v140, v141
    v_cvt_pk_bf16_f32 v191, v142, v143
    v_mfma_f32_16x16x32_bf16 v[72:75], v[196:199], v[200:203], v[72:75]
    v_cvt_pk_bf16_f32 v192, v144, v145
    v_cvt_pk_bf16_f32 v193, v146, v147
    v_mfma_f32_16x16x32_bf16 v[76:79], v[196:199], v[204:207], v[76:79]
    v_cvt_pk_bf16_f32 v194, v148, v149
    v_cvt_pk_bf16_f32 v195, v150, v151
    s_xor_b32 s14, s18, 4
    s_and_b32 s14, s14, 7
    s_lshl_b32 s14, s14, 11
    s_add_u32 s14, s14, s17
    buffer_load_dwordx4 v[200:203], v252, s[64:67], s14 offen offset:0 sc1
    buffer_load_dwordx4 v[204:207], v252, s[64:67], s14 offen offset:1024 sc1
L_at_C10:
    s_barrier
    s_waitcnt lgkmcnt(8)
    v_mfma_f32_16x16x32_bf16 v[80:83], v[208:211], v[232:235], 0
    ds_read_b64_tr_b16 v[228:229], v251 offset:61568
    v_mfma_f32_16x16x32_bf16 v[84:87], v[212:215], v[232:235], 0
    ds_read_b64_tr_b16 v[230:231], v251 offset:62848
    v_cvt_pk_bf16_f32 v196, v152, v153
    s_waitcnt lgkmcnt(8)
    v_mfma_f32_16x16x32_bf16 v[88:91], v[208:211], v[236:239], 0
    ds_read_b128 v[216:219], v249 offset:32768
    ds_read_b64_tr_b16 v[232:233], v250 offset:61632
    v_mfma_f32_16x16x32_bf16 v[92:95], v[212:215], v[236:239], 0
    ds_read_b128 v[220:223], v249 offset:34816
    ds_read_b64_tr_b16 v[234:235], v250 offset:62912
    s_waitcnt lgkmcnt(10)
    v_mfma_f32_16x16x32_bf16 v[96:99], v[208:211], v[240:243], 0
    ds_read_b64_tr_b16 v[236:237], v251 offset:61632
    v_mfma_f32_16x16x32_bf16 v[100:103], v[212:215], v[240:243], 0
    ds_read_b64_tr_b16 v[238:239], v251 offset:62912
    v_cvt_pk_bf16_f32 v197, v154, v155
    s_waitcnt lgkmcnt(10)
    v_mfma_f32_16x16x32_bf16 v[104:107], v[208:211], v[244:247], 0
    ds_read_b64_tr_b16 v[240:241], v250 offset:61696
    v_mfma_f32_16x16x32_bf16 v[108:111], v[212:215], v[244:247], 0
    ds_read_b64_tr_b16 v[242:243], v250 offset:62976
    v_cvt_pk_bf16_f32 v198, v156, v157
    s_waitcnt lgkmcnt(10)
    v_mfma_f32_16x16x32_bf16 v[112:115], v[208:211], v[224:227], 0
    ds_read_b64_tr_b16 v[244:245], v251 offset:61696
    v_mfma_f32_16x16x32_bf16 v[116:119], v[212:215], v[224:227], 0
    ds_read_b64_tr_b16 v[246:247], v251 offset:62976
    v_cvt_pk_bf16_f32 v199, v158, v159
    s_waitcnt lgkmcnt(10)
    v_mfma_f32_16x16x32_bf16 v[120:123], v[208:211], v[228:231], 0
    v_add_u32 v250, 20480, v250
    v_add_u32 v251, 20480, v251
    ds_read_b64_tr_b16 v[224:225], v250 offset:51200
    v_mfma_f32_16x16x32_bf16 v[124:127], v[212:215], v[228:231], 0
    ds_read_b64_tr_b16 v[226:227], v250 offset:52480
    s_waitcnt lgkmcnt(8)
    v_mfma_f32_16x16x32_bf16 v[128:131], v[208:211], v[232:235], 0
    ds_read_b64_tr_b16 v[228:229], v251 offset:51200
    v_mfma_f32_16x16x32_bf16 v[132:135], v[212:215], v[232:235], 0
    ds_read_b64_tr_b16 v[230:231], v251 offset:52480
    s_waitcnt lgkmcnt(8)
    v_mfma_f32_16x16x32_bf16 v[136:139], v[208:211], v[236:239], 0
    ds_read_b64_tr_b16 v[232:233], v250 offset:51264
    v_mfma_f32_16x16x32_bf16 v[140:143], v[212:215], v[236:239], 0
    ds_read_b64_tr_b16 v[234:235], v250 offset:52544
    s_waitcnt lgkmcnt(8)
    v_mfma_f32_16x16x32_bf16 v[144:147], v[208:211], v[240:243], 0
    ds_read_b64_tr_b16 v[236:237], v251 offset:51264
    v_mfma_f32_16x16x32_bf16 v[148:151], v[212:215], v[240:243], 0
    ds_read_b64_tr_b16 v[238:239], v251 offset:52544
    s_waitcnt lgkmcnt(8)
    v_mfma_f32_16x16x32_bf16 v[152:155], v[208:211], v[244:247], 0
    ds_read_b64_tr_b16 v[240:241], v250 offset:51328
    v_mfma_f32_16x16x32_bf16 v[156:159], v[212:215], v[244:247], 0
    ds_read_b64_tr_b16 v[242:243], v250 offset:52608
    s_waitcnt lgkmcnt(8)
    v_mfma_f32_16x16x32_bf16 v[80:83], v[216:219], v[224:227], v[80:83]
    ds_read_b64_tr_b16 v[244:245], v251 offset:51328
    v_mfma_f32_16x16x32_bf16 v[84:87], v[220:223], v[224:227], v[84:87]
    ds_read_b64_tr_b16 v[246:247], v251 offset:52608
    s_waitcnt lgkmcnt(8)
    v_mfma_f32_16x16x32_bf16 v[88:91], v[216:219], v[228:231], v[88:91]
    ds_read_b128 v[208:211], v248 offset:49152
    ds_read_b64_tr_b16 v[224:225], v250 offset:51392
    v_mfma_f32_16x16x32_bf16 v[92:95], v[220:223], v[228:231], v[92:95]
    ds_read_b128 v[212:215], v248 offset:51200
    ds_read_b64_tr_b16 v[226:227], v250 offset:52672
    s_waitcnt lgkmcnt(10)
    v_mfma_f32_16x16x32_bf16 v[96:99], v[216:219], v[232:235], v[96:99]
    ds_read_b64_tr_b16 v[228:229], v251 offset:51392
    v_mfma_f32_16x16x32_bf16 v[100:103], v[220:223], v[232:235], v[100:103]
    ds_read_b64_tr_b16 v[230:231], v251 offset:52672
    s_waitcnt lgkmcnt(10)
    v_mfma_f32_16x16x32_bf16 v[104:107], v[216:219], v[236:239], v[104:107]
    ds_read_b64_tr_b16 v[232:233], v250 offset:51456
    v_mfma_f32_16x16x32_bf16 v[108:111], v[220:223], v[236:239], v[108:111]
    ds_read_b64_tr_b16 v[234:235], v250 offset:52736
    s_waitcnt lgkmcnt(10)
    v_mfma_f32_16x16x32_bf16 v[112:115], v[216:219], v[240:243], v[112:115]
    ds_read_b64_tr_b16 v[236:237], v251 offset:51456
    v_mfma_f32_16x16x32_bf16 v[116:119], v[220:223], v[240:243], v[116:119]
    ds_read_b64_tr_b16 v[238:239], v251 offset:52736
    s_waitcnt lgkmcnt(10)
    v_mfma_f32_16x16x32_bf16 v[120:123], v[216:219], v[244:247], v[120:123]
    v_add_u32 v250, 4294946816, v250
    v_add_u32 v251, 4294946816, v251
    ds_read_b64_tr_b16 v[240:241], v250 offset:0
    v_mfma_f32_16x16x32_bf16 v[124:127], v[220:223], v[244:247], v[124:127]
    ds_read_b64_tr_b16 v[242:243], v250 offset:1280
    s_waitcnt lgkmcnt(8)
    v_mfma_f32_16x16x32_bf16 v[128:131], v[216:219], v[224:227], v[128:131]
    ds_read_b64_tr_b16 v[244:245], v251 offset:0
    v_mfma_f32_16x16x32_bf16 v[132:135], v[220:223], v[224:227], v[132:135]
    ds_read_b64_tr_b16 v[246:247], v251 offset:1280
    s_waitcnt lgkmcnt(8)
    v_mfma_f32_16x16x32_bf16 v[136:139], v[216:219], v[228:231], v[136:139]
    ds_read_b64_tr_b16 v[224:225], v250 offset:64
    v_mfma_f32_16x16x32_bf16 v[140:143], v[220:223], v[228:231], v[140:143]
    ds_read_b64_tr_b16 v[226:227], v250 offset:1344
    s_waitcnt lgkmcnt(8)
    v_mfma_f32_16x16x32_bf16 v[144:147], v[216:219], v[232:235], v[144:147]
    ds_read_b64_tr_b16 v[228:229], v251 offset:64
    v_mfma_f32_16x16x32_bf16 v[148:151], v[220:223], v[232:235], v[148:151]
    ds_read_b64_tr_b16 v[230:231], v251 offset:1344
    s_waitcnt lgkmcnt(8)
    v_mfma_f32_16x16x32_bf16 v[152:155], v[216:219], v[236:239], v[152:155]
    ds_read_b64_tr_b16 v[232:233], v250 offset:128
    v_mfma_f32_16x16x32_bf16 v[156:159], v[220:223], v[236:239], v[156:159]
    ds_read_b64_tr_b16 v[234:235], v250 offset:1408
    s_barrier
    s_waitcnt lgkmcnt(8)
    v_mfma_f32_16x16x32_bf16 v[80:83], v[208:211], v[240:243], v[80:83]
    ds_read_b64_tr_b16 v[236:237], v251 offset:128
    v_mfma_f32_16x16x32_bf16 v[84:87], v[212:215], v[240:243], v[84:87]
    ds_read_b64_tr_b16 v[238:239], v251 offset:1408
    s_waitcnt lgkmcnt(8)
    v_mfma_f32_16x16x32_bf16 v[88:91], v[208:211], v[244:247], v[88:91]
    ds_read_b128 v[216:219], v249 offset:49152
    ds_read_b64_tr_b16 v[240:241], v250 offset:192
    v_mfma_f32_16x16x32_bf16 v[92:95], v[212:215], v[244:247], v[92:95]
    ds_read_b128 v[220:223], v249 offset:51200
    ds_read_b64_tr_b16 v[242:243], v250 offset:1472
    s_waitcnt lgkmcnt(10)
    v_mfma_f32_16x16x32_bf16 v[96:99], v[208:211], v[224:227], v[96:99]
    ds_read_b64_tr_b16 v[244:245], v251 offset:192
    v_mfma_f32_16x16x32_bf16 v[100:103], v[212:215], v[224:227], v[100:103]
    ds_read_b64_tr_b16 v[246:247], v251 offset:1472
    s_waitcnt lgkmcnt(10)
    v_mfma_f32_16x16x32_bf16 v[104:107], v[208:211], v[228:231], v[104:107]
    ds_read_b64_tr_b16 v[224:225], v250 offset:256
    v_mfma_f32_16x16x32_bf16 v[108:111], v[212:215], v[228:231], v[108:111]
    ds_read_b64_tr_b16 v[226:227], v250 offset:1536
    s_waitcnt lgkmcnt(10)
    v_mfma_f32_16x16x32_bf16 v[112:115], v[208:211], v[232:235], v[112:115]
    ds_read_b64_tr_b16 v[228:229], v251 offset:256
    v_mfma_f32_16x16x32_bf16 v[116:119], v[212:215], v[232:235], v[116:119]
    ds_read_b64_tr_b16 v[230:231], v251 offset:1536
    s_waitcnt lgkmcnt(10)
    v_mfma_f32_16x16x32_bf16 v[120:123], v[208:211], v[236:239], v[120:123]
    ds_read_b64_tr_b16 v[232:233], v250 offset:10240
    v_mfma_f32_16x16x32_bf16 v[124:127], v[212:215], v[236:239], v[124:127]
    ds_read_b64_tr_b16 v[234:235], v250 offset:11520
    s_waitcnt lgkmcnt(8)
    v_mfma_f32_16x16x32_bf16 v[128:131], v[208:211], v[240:243], v[128:131]
    ds_read_b64_tr_b16 v[236:237], v251 offset:10240
    v_mfma_f32_16x16x32_bf16 v[132:135], v[212:215], v[240:243], v[132:135]
    ds_read_b64_tr_b16 v[238:239], v251 offset:11520
    s_waitcnt lgkmcnt(8)
    v_mfma_f32_16x16x32_bf16 v[136:139], v[208:211], v[244:247], v[136:139]
    ds_read_b64_tr_b16 v[240:241], v250 offset:10304
    v_mfma_f32_16x16x32_bf16 v[140:143], v[212:215], v[244:247], v[140:143]
    ds_read_b64_tr_b16 v[242:243], v250 offset:11584
    s_waitcnt lgkmcnt(8)
    v_mfma_f32_16x16x32_bf16 v[144:147], v[208:211], v[224:227], v[144:147]
    ds_read_b64_tr_b16 v[244:245], v251 offset:10304
    v_mfma_f32_16x16x32_bf16 v[148:151], v[212:215], v[224:227], v[148:151]
    ds_read_b64_tr_b16 v[246:247], v251 offset:11584
    s_waitcnt lgkmcnt(8)
    v_mfma_f32_16x16x32_bf16 v[152:155], v[208:211], v[228:231], v[152:155]
    ds_read_b64_tr_b16 v[224:225], v250 offset:10368
    v_mfma_f32_16x16x32_bf16 v[156:159], v[212:215], v[228:231], v[156:159]
    ds_read_b64_tr_b16 v[226:227], v250 offset:11648
    s_waitcnt lgkmcnt(8)
    v_mfma_f32_16x16x32_bf16 v[80:83], v[216:219], v[232:235], v[80:83]
    ds_read_b64_tr_b16 v[228:229], v251 offset:10368
    v_mfma_f32_16x16x32_bf16 v[84:87], v[220:223], v[232:235], v[84:87]
    ds_read_b64_tr_b16 v[230:231], v251 offset:11648
    s_waitcnt lgkmcnt(8)
    v_mfma_f32_16x16x32_bf16 v[88:91], v[216:219], v[236:239], v[88:91]
    ds_read_b128 v[208:211], v248 offset:0
    ds_read_b64_tr_b16 v[232:233], v250 offset:10432
    v_mfma_f32_16x16x32_bf16 v[92:95], v[220:223], v[236:239], v[92:95]
    ds_read_b128 v[212:215], v248 offset:2048
    ds_read_b64_tr_b16 v[234:235], v250 offset:11712
    s_waitcnt lgkmcnt(10)
    v_mfma_f32_16x16x32_bf16 v[96:99], v[216:219], v[240:243], v[96:99]
    ds_read_b64_tr_b16 v[236:237], v251 offset:10432
    v_mfma_f32_16x16x32_bf16 v[100:103], v[220:223], v[240:243], v[100:103]
    ds_read_b64_tr_b16 v[238:239], v251 offset:11712
    s_waitcnt lgkmcnt(10)
    v_mfma_f32_16x16x32_bf16 v[104:107], v[216:219], v[244:247], v[104:107]
    ds_read_b64_tr_b16 v[240:241], v250 offset:10496
    v_mfma_f32_16x16x32_bf16 v[108:111], v[220:223], v[244:247], v[108:111]
    ds_read_b64_tr_b16 v[242:243], v250 offset:11776
    s_waitcnt lgkmcnt(10)
    v_mfma_f32_16x16x32_bf16 v[112:115], v[216:219], v[224:227], v[112:115]
    ds_read_b64_tr_b16 v[244:245], v251 offset:10496
    v_mfma_f32_16x16x32_bf16 v[116:119], v[220:223], v[224:227], v[116:119]
    ds_read_b64_tr_b16 v[246:247], v251 offset:11776
    s_waitcnt lgkmcnt(10)
    v_mfma_f32_16x16x32_bf16 v[120:123], v[216:219], v[228:231], v[120:123]
    ds_read_b64_tr_b16 v[224:225], v250 offset:20480
    v_mfma_f32_16x16x32_bf16 v[124:127], v[220:223], v[228:231], v[124:127]
    ds_read_b64_tr_b16 v[226:227], v250 offset:21760
    s_waitcnt lgkmcnt(8)
    v_mfma_f32_16x16x32_bf16 v[128:131], v[216:219], v[232:235], v[128:131]
    ds_read_b64_tr_b16 v[228:229], v251 offset:20480
    v_mfma_f32_16x16x32_bf16 v[132:135], v[220:223], v[232:235], v[132:135]
    ds_read_b64_tr_b16 v[230:231], v251 offset:21760
    s_waitcnt lgkmcnt(8)
    v_mfma_f32_16x16x32_bf16 v[136:139], v[216:219], v[236:239], v[136:139]
    ds_read_b64_tr_b16 v[232:233], v250 offset:20544
    v_mfma_f32_16x16x32_bf16 v[140:143], v[220:223], v[236:239], v[140:143]
    ds_read_b64_tr_b16 v[234:235], v250 offset:21824
    s_waitcnt lgkmcnt(8)
    v_mfma_f32_16x16x32_bf16 v[144:147], v[216:219], v[240:243], v[144:147]
    ds_read_b64_tr_b16 v[236:237], v251 offset:20544
    v_mfma_f32_16x16x32_bf16 v[148:151], v[220:223], v[240:243], v[148:151]
    ds_read_b64_tr_b16 v[238:239], v251 offset:21824
    s_waitcnt lgkmcnt(8)
    v_mfma_f32_16x16x32_bf16 v[152:155], v[216:219], v[244:247], v[152:155]
    ds_read_b64_tr_b16 v[240:241], v250 offset:20608
    v_mfma_f32_16x16x32_bf16 v[156:159], v[220:223], v[244:247], v[156:159]
    ds_read_b64_tr_b16 v[242:243], v250 offset:21888
    s_waitcnt vmcnt(0)
    v_mfma_f32_16x16x32_bf16 v[0:3], v[160:163], v[200:203], v[0:3]
    v_mfma_f32_16x16x32_bf16 v[4:7], v[160:163], v[204:207], v[4:7]
    v_mfma_f32_16x16x32_bf16 v[8:11], v[164:167], v[200:203], v[8:11]
    v_cvt_pk_bf16_f32 v160, v80, v81
    v_cvt_pk_bf16_f32 v161, v82, v83
    v_mfma_f32_16x16x32_bf16 v[12:15], v[164:167], v[204:207], v[12:15]
    v_cvt_pk_bf16_f32 v162, v84, v85
    v_cvt_pk_bf16_f32 v163, v86, v87
    v_mfma_f32_16x16x32_bf16 v[16:19], v[168:171], v[200:203], v[16:19]
    v_cvt_pk_bf16_f32 v164, v88, v89
    v_cvt_pk_bf16_f32 v165, v90, v91
    v_mfma_f32_16x16x32_bf16 v[20:23], v[168:171], v[204:207], v[20:23]
    v_cvt_pk_bf16_f32 v166, v92, v93
    v_cvt_pk_bf16_f32 v167, v94, v95
    v_mfma_f32_16x16x32_bf16 v[24:27], v[172:175], v[200:203], v[24:27]
    v_cvt_pk_bf16_f32 v168, v96, v97
    v_cvt_pk_bf16_f32 v169, v98, v99
    v_mfma_f32_16x16x32_bf16 v[28:31], v[172:175], v[204:207], v[28:31]
    v_cvt_pk_bf16_f32 v170, v100, v101
    v_cvt_pk_bf16_f32 v171, v102, v103
    v_mfma_f32_16x16x32_bf16 v[32:35], v[176:179], v[200:203], v[32:35]
    v_cvt_pk_bf16_f32 v172, v104, v105
    v_cvt_pk_bf16_f32 v173, v106, v107
    v_mfma_f32_16x16x32_bf16 v[36:39], v[176:179], v[204:207], v[36:39]
    v_cvt_pk_bf16_f32 v174, v108, v109
    v_cvt_pk_bf16_f32 v175, v110, v111
    v_mfma_f32_16x16x32_bf16 v[40:43], v[180:183], v[200:203], v[40:43]
    v_cvt_pk_bf16_f32 v176, v112, v113
    v_cvt_pk_bf16_f32 v177, v114, v115
    v_mfma_f32_16x16x32_bf16 v[44:47], v[180:183], v[204:207], v[44:47]
    v_cvt_pk_bf16_f32 v178, v116, v117
    v_cvt_pk_bf16_f32 v179, v118, v119
    v_mfma_f32_16x16x32_bf16 v[48:51], v[184:187], v[200:203], v[48:51]
    v_cvt_pk_bf16_f32 v180, v120, v121
    v_cvt_pk_bf16_f32 v181, v122, v123
    v_mfma_f32_16x16x32_bf16 v[52:55], v[184:187], v[204:207], v[52:55]
    v_cvt_pk_bf16_f32 v182, v124, v125
    v_cvt_pk_bf16_f32 v183, v126, v127
    v_mfma_f32_16x16x32_bf16 v[56:59], v[188:191], v[200:203], v[56:59]
    v_cvt_pk_bf16_f32 v184, v128, v129
    v_cvt_pk_bf16_f32 v185, v130, v131
    v_mfma_f32_16x16x32_bf16 v[60:63], v[188:191], v[204:207], v[60:63]
    v_cvt_pk_bf16_f32 v186, v132, v133
    v_cvt_pk_bf16_f32 v187, v134, v135
    v_mfma_f32_16x16x32_bf16 v[64:67], v[192:195], v[200:203], v[64:67]
    v_cvt_pk_bf16_f32 v188, v136, v137
    v_cvt_pk_bf16_f32 v189, v138, v139
    v_mfma_f32_16x16x32_bf16 v[68:71], v[192:195], v[204:207], v[68:71]
    v_cvt_pk_bf16_f32 v190, v140, v141
    v_cvt_pk_bf16_f32 v191, v142, v143
    v_mfma_f32_16x16x32_bf16 v[72:75], v[196:199], v[200:203], v[72:75]
    v_cvt_pk_bf16_f32 v192, v144, v145
    v_cvt_pk_bf16_f32 v193, v146, v147
    v_mfma_f32_16x16x32_bf16 v[76:79], v[196:199], v[204:207], v[76:79]
    v_cvt_pk_bf16_f32 v194, v148, v149
    v_cvt_pk_bf16_f32 v195, v150, v151
    s_xor_b32 s14, s18, 5
    s_and_b32 s14, s14, 7
    s_lshl_b32 s14, s14, 11
    s_add_u32 s14, s14, s17
    buffer_load_dwordx4 v[200:203], v252, s[64:67], s14 offen offset:0 sc1
    buffer_load_dwordx4 v[204:207], v252, s[64:67], s14 offen offset:1024 sc1
    s_barrier
    s_lshl_b32 s19, s3, 11
    s_add_u32 s20, s19, 155648
    s_add_u32 s19, s19, 65536
    s_cmp_lt_u32 s3, 2
    s_cbranch_scc0 L_plb_compute
    s_add_u32 s20, s19, 8192
L_plb_compute:
    v_add_u32 v254, s19, v252
    v_add_u32 v255, s20, v252
    s_waitcnt lgkmcnt(8)
    v_mfma_f32_16x16x32_bf16 v[80:83], v[208:211], v[224:227], 0
    ds_read_b64_tr_b16 v[244:245], v251 offset:20608
    v_mfma_f32_16x16x32_bf16 v[84:87], v[212:215], v[224:227], 0
    ds_read_b64_tr_b16 v[246:247], v251 offset:21888
    v_cvt_pk_bf16_f32 v196, v152, v153
    s_waitcnt lgkmcnt(8)
    v_mfma_f32_16x16x32_bf16 v[88:91], v[208:211], v[228:231], 0
    ds_read_b128 v[216:219], v249 offset:0
    ds_read_b64_tr_b16 v[224:225], v250 offset:20672
    v_mfma_f32_16x16x32_bf16 v[92:95], v[212:215], v[228:231], 0
    ds_read_b128 v[220:223], v249 offset:2048
    ds_read_b64_tr_b16 v[226:227], v250 offset:21952
    s_waitcnt lgkmcnt(10)
    v_mfma_f32_16x16x32_bf16 v[96:99], v[208:211], v[232:235], 0
    ds_read_b64_tr_b16 v[228:229], v251 offset:20672
    v_mfma_f32_16x16x32_bf16 v[100:103], v[212:215], v[232:235], 0
    ds_read_b64_tr_b16 v[230:231], v251 offset:21952
    v_cvt_pk_bf16_f32 v197, v154, v155
    s_waitcnt lgkmcnt(10)
    v_mfma_f32_16x16x32_bf16 v[104:107], v[208:211], v[236:239], 0
    ds_read_b64_tr_b16 v[232:233], v250 offset:20736
    v_mfma_f32_16x16x32_bf16 v[108:111], v[212:215], v[236:239], 0
    ds_read_b64_tr_b16 v[234:235], v250 offset:22016
    v_cvt_pk_bf16_f32 v198, v156, v157
    s_waitcnt lgkmcnt(10)
    v_mfma_f32_16x16x32_bf16 v[112:115], v[208:211], v[240:243], 0
    ds_read_b64_tr_b16 v[236:237], v251 offset:20736
    v_mfma_f32_16x16x32_bf16 v[116:119], v[212:215], v[240:243], 0
    ds_read_b64_tr_b16 v[238:239], v251 offset:22016
    v_cvt_pk_bf16_f32 v199, v158, v159
    s_waitcnt lgkmcnt(10)
    v_mfma_f32_16x16x32_bf16 v[120:123], v[208:211], v[244:247], 0
    ds_read_b64_tr_b16 v[240:241], v250 offset:30720
    v_mfma_f32_16x16x32_bf16 v[124:127], v[212:215], v[244:247], 0
    ds_read_b64_tr_b16 v[242:243], v250 offset:32000
    s_waitcnt lgkmcnt(8)
    v_mfma_f32_16x16x32_bf16 v[128:131], v[208:211], v[224:227], 0
    ds_read_b64_tr_b16 v[244:245], v251 offset:30720
    v_mfma_f32_16x16x32_bf16 v[132:135], v[212:215], v[224:227], 0
    ds_read_b64_tr_b16 v[246:247], v251 offset:32000
    s_waitcnt lgkmcnt(8)
    v_mfma_f32_16x16x32_bf16 v[136:139], v[208:211], v[228:231], 0
    ds_read_b64_tr_b16 v[224:225], v250 offset:30784
    v_mfma_f32_16x16x32_bf16 v[140:143], v[212:215], v[228:231], 0
    ds_read_b64_tr_b16 v[226:227], v250 offset:32064
    s_waitcnt lgkmcnt(8)
    v_mfma_f32_16x16x32_bf16 v[144:147], v[208:211], v[232:235], 0
    ds_read_b64_tr_b16 v[228:229], v251 offset:30784
    v_mfma_f32_16x16x32_bf16 v[148:151], v[212:215], v[232:235], 0
    ds_read_b64_tr_b16 v[230:231], v251 offset:32064
    s_waitcnt lgkmcnt(8)
    v_mfma_f32_16x16x32_bf16 v[152:155], v[208:211], v[236:239], 0
    ds_read_b64_tr_b16 v[232:233], v250 offset:30848
    v_mfma_f32_16x16x32_bf16 v[156:159], v[212:215], v[236:239], 0
    ds_read_b64_tr_b16 v[234:235], v250 offset:32128
    s_waitcnt lgkmcnt(8)
    v_mfma_f32_16x16x32_bf16 v[80:83], v[216:219], v[240:243], v[80:83]
    ds_read_b64_tr_b16 v[236:237], v251 offset:30848
    v_mfma_f32_16x16x32_bf16 v[84:87], v[220:223], v[240:243], v[84:87]
    ds_read_b64_tr_b16 v[238:239], v251 offset:32128
    s_waitcnt lgkmcnt(8)
    v_mfma_f32_16x16x32_bf16 v[88:91], v[216:219], v[244:247], v[88:91]
    ds_read_b128 v[208:211], v248 offset:16384
    ds_read_b64_tr_b16 v[240:241], v250 offset:30912
    v_mfma_f32_16x16x32_bf16 v[92:95], v[220:223], v[244:247], v[92:95]
    ds_read_b128 v[212:215], v248 offset:18432
    ds_read_b64_tr_b16 v[242:243], v250 offset:32192
    s_waitcnt lgkmcnt(10)
    v_mfma_f32_16x16x32_bf16 v[96:99], v[216:219], v[224:227], v[96:99]
    ds_read_b64_tr_b16 v[244:245], v251 offset:30912
    v_mfma_f32_16x16x32_bf16 v[100:103], v[220:223], v[224:227], v[100:103]
    ds_read_b64_tr_b16 v[246:247], v251 offset:32192
    s_waitcnt lgkmcnt(10)
    v_mfma_f32_16x16x32_bf16 v[104:107], v[216:219], v[228:231], v[104:107]
    ds_read_b64_tr_b16 v[224:225], v250 offset:30976
    v_mfma_f32_16x16x32_bf16 v[108:111], v[220:223], v[228:231], v[108:111]
    ds_read_b64_tr_b16 v[226:227], v250 offset:32256
    s_waitcnt lgkmcnt(10)
    v_mfma_f32_16x16x32_bf16 v[112:115], v[216:219], v[232:235], v[112:115]
    ds_read_b64_tr_b16 v[228:229], v251 offset:30976
    v_mfma_f32_16x16x32_bf16 v[116:119], v[220:223], v[232:235], v[116:119]
    ds_read_b64_tr_b16 v[230:231], v251 offset:32256
    s_waitcnt lgkmcnt(10)
    v_mfma_f32_16x16x32_bf16 v[120:123], v[216:219], v[236:239], v[120:123]
    ds_read_b64_tr_b16 v[232:233], v250 offset:40960
    v_mfma_f32_16x16x32_bf16 v[124:127], v[220:223], v[236:239], v[124:127]
    ds_read_b64_tr_b16 v[234:235], v250 offset:42240
    s_waitcnt lgkmcnt(8)
    v_mfma_f32_16x16x32_bf16 v[128:131], v[216:219], v[240:243], v[128:131]
    ds_read_b64_tr_b16 v[236:237], v251 offset:40960
    v_mfma_f32_16x16x32_bf16 v[132:135], v[220:223], v[240:243], v[132:135]
    ds_read_b64_tr_b16 v[238:239], v251 offset:42240
    s_waitcnt lgkmcnt(8)
    v_mfma_f32_16x16x32_bf16 v[136:139], v[216:219], v[244:247], v[136:139]
    ds_read_b64_tr_b16 v[240:241], v250 offset:41024
    v_mfma_f32_16x16x32_bf16 v[140:143], v[220:223], v[244:247], v[140:143]
    ds_read_b64_tr_b16 v[242:243], v250 offset:42304
    s_waitcnt lgkmcnt(8)
    v_mfma_f32_16x16x32_bf16 v[144:147], v[216:219], v[224:227], v[144:147]
    ds_read_b64_tr_b16 v[244:245], v251 offset:41024
    v_mfma_f32_16x16x32_bf16 v[148:151], v[220:223], v[224:227], v[148:151]
    ds_read_b64_tr_b16 v[246:247], v251 offset:42304
    s_waitcnt lgkmcnt(8)
    v_mfma_f32_16x16x32_bf16 v[152:155], v[216:219], v[228:231], v[152:155]
    ds_read_b64_tr_b16 v[224:225], v250 offset:41088
    v_mfma_f32_16x16x32_bf16 v[156:159], v[220:223], v[228:231], v[156:159]
    ds_read_b64_tr_b16 v[226:227], v250 offset:42368
    s_waitcnt lgkmcnt(8)
    v_mfma_f32_16x16x32_bf16 v[80:83], v[208:211], v[232:235], v[80:83]
    ds_read_b64_tr_b16 v[228:229], v251 offset:41088
    v_mfma_f32_16x16x32_bf16 v[84:87], v[212:215], v[232:235], v[84:87]
    ds_read_b64_tr_b16 v[230:231], v251 offset:42368
    s_waitcnt lgkmcnt(8)
    v_mfma_f32_16x16x32_bf16 v[88:91], v[208:211], v[236:239], v[88:91]
    ds_read_b128 v[216:219], v249 offset:16384
    ds_read_b64_tr_b16 v[232:233], v250 offset:41152
    v_mfma_f32_16x16x32_bf16 v[92:95], v[212:215], v[236:239], v[92:95]
    ds_read_b128 v[220:223], v249 offset:18432
    ds_read_b64_tr_b16 v[234:235], v250 offset:42432
    s_waitcnt lgkmcnt(10)
    v_mfma_f32_16x16x32_bf16 v[96:99], v[208:211], v[240:243], v[96:99]
    ds_read_b64_tr_b16 v[236:237], v251 offset:41152
    v_mfma_f32_16x16x32_bf16 v[100:103], v[212:215], v[240:243], v[100:103]
    ds_read_b64_tr_b16 v[238:239], v251 offset:42432
    s_waitcnt lgkmcnt(10)
    v_mfma_f32_16x16x32_bf16 v[104:107], v[208:211], v[244:247], v[104:107]
    ds_read_b64_tr_b16 v[240:241], v250 offset:41216
    v_mfma_f32_16x16x32_bf16 v[108:111], v[212:215], v[244:247], v[108:111]
    ds_read_b64_tr_b16 v[242:243], v250 offset:42496
    s_waitcnt lgkmcnt(10)
    v_mfma_f32_16x16x32_bf16 v[112:115], v[208:211], v[224:227], v[112:115]
    ds_read_b64_tr_b16 v[244:245], v251 offset:41216
    v_mfma_f32_16x16x32_bf16 v[116:119], v[212:215], v[224:227], v[116:119]
    ds_read_b64_tr_b16 v[246:247], v251 offset:42496
    s_waitcnt lgkmcnt(10)
    v_mfma_f32_16x16x32_bf16 v[120:123], v[208:211], v[228:231], v[120:123]
    ds_read_b64_tr_b16 v[224:225], v250 offset:51200
    v_mfma_f32_16x16x32_bf16 v[124:127], v[212:215], v[228:231], v[124:127]
    ds_read_b64_tr_b16 v[226:227], v250 offset:52480
    s_waitcnt lgkmcnt(8)
    v_mfma_f32_16x16x32_bf16 v[128:131], v[208:211], v[232:235], v[128:131]
    ds_read_b64_tr_b16 v[228:229], v251 offset:51200
    v_mfma_f32_16x16x32_bf16 v[132:135], v[212:215], v[232:235], v[132:135]
    ds_read_b64_tr_b16 v[230:231], v251 offset:52480
    s_waitcnt lgkmcnt(8)
    v_mfma_f32_16x16x32_bf16 v[136:139], v[208:211], v[236:239], v[136:139]
    ds_read_b64_tr_b16 v[232:233], v250 offset:51264
    v_mfma_f32_16x16x32_bf16 v[140:143], v[212:215], v[236:239], v[140:143]
    ds_read_b64_tr_b16 v[234:235], v250 offset:52544
    s_waitcnt lgkmcnt(8)
    v_mfma_f32_16x16x32_bf16 v[144:147], v[208:211], v[240:243], v[144:147]
    ds_read_b64_tr_b16 v[236:237], v251 offset:51264
    v_mfma_f32_16x16x32_bf16 v[148:151], v[212:215], v[240:243], v[148:151]
    ds_read_b64_tr_b16 v[238:239], v251 offset:52544
    s_waitcnt lgkmcnt(8)
    v_mfma_f32_16x16x32_bf16 v[152:155], v[208:211], v[244:247], v[152:155]
    ds_read_b64_tr_b16 v[240:241], v250 offset:51328
    v_mfma_f32_16x16x32_bf16 v[156:159], v[212:215], v[244:247], v[156:159]
    ds_read_b64_tr_b16 v[242:243], v250 offset:52608
    s_waitcnt lgkmcnt(8)
    v_mfma_f32_16x16x32_bf16 v[80:83], v[216:219], v[224:227], v[80:83]
    ds_read_b64_tr_b16 v[244:245], v251 offset:51328
    v_mfma_f32_16x16x32_bf16 v[84:87], v[220:223], v[224:227], v[84:87]
    ds_read_b64_tr_b16 v[246:247], v251 offset:52608
    s_waitcnt lgkmcnt(8)
    v_mfma_f32_16x16x32_bf16 v[88:91], v[216:219], v[228:231], v[88:91]
    ds_read_b64_tr_b16 v[224:225], v250 offset:51392
    v_mfma_f32_16x16x32_bf16 v[92:95], v[220:223], v[228:231], v[92:95]
    ds_read_b64_tr_b16 v[226:227], v250 offset:52672
    s_waitcnt lgkmcnt(8)
    v_mfma_f32_16x16x32_bf16 v[96:99], v[216:219], v[232:235], v[96:99]
    ds_read_b64_tr_b16 v[228:229], v251 offset:51392
    v_mfma_f32_16x16x32_bf16 v[100:103], v[220:223], v[232:235], v[100:103]
    ds_read_b64_tr_b16 v[230:231], v251 offset:52672
    s_waitcnt lgkmcnt(8)
    v_mfma_f32_16x16x32_bf16 v[104:107], v[216:219], v[236:239], v[104:107]
    ds_read_b64_tr_b16 v[232:233], v250 offset:51456
    v_mfma_f32_16x16x32_bf16 v[108:111], v[220:223], v[236:239], v[108:111]
    ds_read_b64_tr_b16 v[234:235], v250 offset:52736
    s_waitcnt lgkmcnt(8)
    v_mfma_f32_16x16x32_bf16 v[112:115], v[216:219], v[240:243], v[112:115]
    ds_read_b64_tr_b16 v[236:237], v251 offset:51456
    v_mfma_f32_16x16x32_bf16 v[116:119], v[220:223], v[240:243], v[116:119]
    ds_read_b64_tr_b16 v[238:239], v251 offset:52736
    s_waitcnt lgkmcnt(8)
    v_mfma_f32_16x16x32_bf16 v[120:123], v[216:219], v[244:247], v[120:123]
    ds_read_b64_tr_b16 v[240:241], v250 offset:61440
    v_mfma_f32_16x16x32_bf16 v[124:127], v[220:223], v[244:247], v[124:127]
    ds_read_b64_tr_b16 v[242:243], v250 offset:62720
    s_waitcnt lgkmcnt(8)
    v_mfma_f32_16x16x32_bf16 v[128:131], v[216:219], v[224:227], v[128:131]
    ds_read_b64_tr_b16 v[244:245], v251 offset:61440
    v_mfma_f32_16x16x32_bf16 v[132:135], v[220:223], v[224:227], v[132:135]
    ds_read_b64_tr_b16 v[246:247], v251 offset:62720
    s_waitcnt lgkmcnt(8)
    v_mfma_f32_16x16x32_bf16 v[136:139], v[216:219], v[228:231], v[136:139]
    v_add_u32 v250, 20480, v250
    v_add_u32 v251, 20480, v251
    ds_read_b64_tr_b16 v[224:225], v250 offset:51200
    v_mfma_f32_16x16x32_bf16 v[140:143], v[220:223], v[228:231], v[140:143]
    ds_read_b64_tr_b16 v[226:227], v250 offset:52480
    s_waitcnt lgkmcnt(8)
    v_mfma_f32_16x16x32_bf16 v[144:147], v[216:219], v[232:235], v[144:147]
    ds_read_b64_tr_b16 v[228:229], v251 offset:51200
    v_mfma_f32_16x16x32_bf16 v[148:151], v[220:223], v[232:235], v[148:151]
    ds_read_b64_tr_b16 v[230:231], v251 offset:52480
    s_waitcnt lgkmcnt(8)
    v_mfma_f32_16x16x32_bf16 v[152:155], v[216:219], v[236:239], v[152:155]
    v_mfma_f32_16x16x32_bf16 v[156:159], v[220:223], v[236:239], v[156:159]
    s_barrier
    v_add_u32 v250, 4294946816, v250
    v_add_u32 v251, 4294946816, v251
    ds_read_b64_tr_b16 v[232:233], v250 offset:0
    ds_read_b64_tr_b16 v[234:235], v250 offset:1280
    s_waitcnt vmcnt(0)
    v_mfma_f32_16x16x32_bf16 v[0:3], v[160:163], v[200:203], v[0:3]
    v_mfma_f32_16x16x32_bf16 v[4:7], v[160:163], v[204:207], v[4:7]
    v_mfma_f32_16x16x32_bf16 v[8:11], v[164:167], v[200:203], v[8:11]
    v_cvt_pk_bf16_f32 v160, v80, v81
    v_cvt_pk_bf16_f32 v161, v82, v83
    v_mfma_f32_16x16x32_bf16 v[12:15], v[164:167], v[204:207], v[12:15]
    v_cvt_pk_bf16_f32 v162, v84, v85
    v_cvt_pk_bf16_f32 v163, v86, v87
    v_mfma_f32_16x16x32_bf16 v[16:19], v[168:171], v[200:203], v[16:19]
    ds_read_b128 v[80:83], v248 offset:32768
    v_cvt_pk_bf16_f32 v164, v88, v89
    v_mfma_f32_16x16x32_bf16 v[20:23], v[168:171], v[204:207], v[20:23]
    ds_read_b128 v[84:87], v248 offset:34816
    v_cvt_pk_bf16_f32 v165, v90, v91
    v_mfma_f32_16x16x32_bf16 v[24:27], v[172:175], v[200:203], v[24:27]
    v_cvt_pk_bf16_f32 v166, v92, v93
    v_cvt_pk_bf16_f32 v167, v94, v95
    ds_read_b128 v[88:91], v249 offset:32768
    v_mfma_f32_16x16x32_bf16 v[28:31], v[172:175], v[204:207], v[28:31]
    ds_read_b128 v[92:95], v249 offset:34816
    v_cvt_pk_bf16_f32 v168, v96, v97
    v_mfma_f32_16x16x32_bf16 v[32:35], v[176:179], v[200:203], v[32:35]
    v_cvt_pk_bf16_f32 v169, v98, v99
    v_cvt_pk_bf16_f32 v170, v100, v101
    v_cvt_pk_bf16_f32 v171, v102, v103
    ds_read_b128 v[96:99], v248 offset:49152
    v_mfma_f32_16x16x32_bf16 v[36:39], v[176:179], v[204:207], v[36:39]
    s_waitcnt lgkmcnt(14)
    ds_read_b128 v[100:103], v248 offset:51200
    v_mfma_f32_16x16x32_bf16 v[40:43], v[180:183], v[200:203], v[40:43]
    v_cvt_pk_bf16_f32 v172, v104, v105
    v_cvt_pk_bf16_f32 v173, v106, v107
    v_cvt_pk_bf16_f32 v174, v108, v109
    v_cvt_pk_bf16_f32 v175, v110, v111
    s_waitcnt lgkmcnt(14)
    ds_read_b128 v[104:107], v249 offset:49152
    v_mfma_f32_16x16x32_bf16 v[44:47], v[180:183], v[204:207], v[44:47]
    s_waitcnt lgkmcnt(14)
    ds_read_b128 v[108:111], v249 offset:51200
    v_mfma_f32_16x16x32_bf16 v[48:51], v[184:187], v[200:203], v[48:51]
    v_cvt_pk_bf16_f32 v176, v112, v113
    v_cvt_pk_bf16_f32 v177, v114, v115
    v_mfma_f32_16x16x32_bf16 v[52:55], v[184:187], v[204:207], v[52:55]
    v_cvt_pk_bf16_f32 v178, v116, v117
    v_cvt_pk_bf16_f32 v179, v118, v119
    s_waitcnt lgkmcnt(14)
    ds_read_b128 v[112:115], v255 offset:0
    s_waitcnt lgkmcnt(14)
    ds_read_b128 v[116:119], v255 offset:1024
    v_mfma_f32_16x16x32_bf16 v[56:59], v[188:191], v[200:203], v[56:59]
    v_cvt_pk_bf16_f32 v180, v120, v121
    v_cvt_pk_bf16_f32 v181, v122, v123
    v_mfma_f32_16x16x32_bf16 v[60:63], v[188:191], v[204:207], v[60:63]
    v_cvt_pk_bf16_f32 v182, v124, v125
    v_cvt_pk_bf16_f32 v183, v126, v127
    v_mfma_f32_16x16x32_bf16 v[64:67], v[192:195], v[200:203], v[64:67]
    v_cvt_pk_bf16_f32 v184, v128, v129
    v_cvt_pk_bf16_f32 v185, v130, v131
    v_mfma_f32_16x16x32_bf16 v[68:71], v[192:195], v[204:207], v[68:71]
    v_cvt_pk_bf16_f32 v186, v132, v133
    v_cvt_pk_bf16_f32 v187, v134, v135
    v_mfma_f32_16x16x32_bf16 v[72:75], v[196:199], v[200:203], v[72:75]
    v_cvt_pk_bf16_f32 v188, v136, v137
    v_cvt_pk_bf16_f32 v189, v138, v139
    v_mfma_f32_16x16x32_bf16 v[76:79], v[196:199], v[204:207], v[76:79]
    v_cvt_pk_bf16_f32 v190, v140, v141
    v_cvt_pk_bf16_f32 v191, v142, v143
    s_waitcnt lgkmcnt(14)
    ds_read_b128 v[200:203], v254 offset:0
    s_waitcnt lgkmcnt(14)
    ds_read_b128 v[204:207], v254 offset:1024
    v_mov_b32 v253, 0
    v_cvt_pk_bf16_f32 v192, v144, v145
    v_cvt_pk_bf16_f32 v193, v146, v147
    v_cvt_pk_bf16_f32 v194, v148, v149
    v_cvt_pk_bf16_f32 v195, v150, v151
    v_cvt_pk_bf16_f32 v196, v152, v153
    v_cvt_pk_bf16_f32 v197, v154, v155
    v_cvt_pk_bf16_f32 v198, v156, v157
    v_cvt_pk_bf16_f32 v199, v158, v159
    s_waitcnt lgkmcnt(10)
    v_mfma_f32_16x16x32_bf16 v[128:131], v[80:83], v[240:243], 0
    ds_read_b64_tr_b16 v[236:237], v251 offset:0
    v_mfma_f32_16x16x32_bf16 v[132:135], v[84:87], v[240:243], 0
    ds_read_b64_tr_b16 v[238:239], v251 offset:1280
    v_mfma_f32_16x16x32_bf16 v[136:139], v[80:83], v[244:247], 0
    ds_read_b64_tr_b16 v[240:241], v250 offset:10240
    v_mfma_f32_16x16x32_bf16 v[140:143], v[84:87], v[244:247], 0
    ds_read_b64_tr_b16 v[242:243], v250 offset:11520
    s_waitcnt lgkmcnt(12)
    v_mfma_f32_16x16x32_bf16 v[128:131], v[88:91], v[224:227], v[128:131]
    ds_read_b64_tr_b16 v[244:245], v251 offset:10240
    v_mfma_f32_16x16x32_bf16 v[132:135], v[92:95], v[224:227], v[132:135]
    ds_read_b64_tr_b16 v[246:247], v251 offset:11520
    v_mfma_f32_16x16x32_bf16 v[136:139], v[88:91], v[228:231], v[136:139]
    ds_read_b64_tr_b16 v[224:225], v250 offset:61504
    v_mfma_f32_16x16x32_bf16 v[140:143], v[92:95], v[228:231], v[140:143]
    s_waitcnt lgkmcnt(14)
    ds_read_b64_tr_b16 v[226:227], v250 offset:62784
    s_waitcnt lgkmcnt(14)
    v_mfma_f32_16x16x32_bf16 v[128:131], v[96:99], v[232:235], v[128:131]
    ds_read_b64_tr_b16 v[228:229], v251 offset:61504
    v_mfma_f32_16x16x32_bf16 v[132:135], v[100:103], v[232:235], v[132:135]
    s_waitcnt lgkmcnt(14)
    ds_read_b64_tr_b16 v[230:231], v251 offset:62784
    s_waitcnt lgkmcnt(8)
    v_mfma_f32_16x16x32_bf16 v[136:139], v[96:99], v[236:239], v[136:139]
    v_add_u32 v250, 20480, v250
    v_add_u32 v251, 20480, v251
    ds_read_b64_tr_b16 v[232:233], v250 offset:51264
    v_mfma_f32_16x16x32_bf16 v[140:143], v[100:103], v[236:239], v[140:143]
    ds_read_b64_tr_b16 v[234:235], v250 offset:52544
    v_add_u32 v255, 98304, v252
    s_waitcnt lgkmcnt(8)
    v_mfma_f32_16x16x32_bf16 v[128:131], v[104:107], v[240:243], v[128:131]
    ds_read_b64_tr_b16 v[236:237], v251 offset:51264
    v_mfma_f32_16x16x32_bf16 v[132:135], v[108:111], v[240:243], v[132:135]
    ds_read_b64_tr_b16 v[238:239], v251 offset:52544
    s_waitcnt lgkmcnt(8)
    v_mfma_f32_16x16x32_bf16 v[136:139], v[104:107], v[244:247], v[136:139]
    v_add_u32 v250, 4294946816, v250
    v_add_u32 v251, 4294946816, v251
    ds_read_b64_tr_b16 v[240:241], v250 offset:64
    v_mfma_f32_16x16x32_bf16 v[140:143], v[108:111], v[244:247], v[140:143]
    ds_read_b64_tr_b16 v[242:243], v250 offset:1344
    v_mfma_f32_16x16x32_bf16 v[0:3], v[160:163], v[200:203], v[0:3]
    v_mfma_f32_16x16x32_bf16 v[4:7], v[160:163], v[204:207], v[4:7]
    v_mfma_f32_16x16x32_bf16 v[8:11], v[164:167], v[200:203], v[8:11]
    v_cvt_pk_bf16_f32 v160, v128, v129
    v_cvt_pk_bf16_f32 v161, v130, v131
    v_cvt_pk_bf16_f32 v162, v132, v133
    v_mfma_f32_16x16x32_bf16 v[12:15], v[164:167], v[204:207], v[12:15]
    v_cvt_pk_bf16_f32 v163, v134, v135
    s_waitcnt lgkmcnt(8)
    v_mfma_f32_16x16x32_bf16 v[144:147], v[80:83], v[224:227], 0
    ds_read_b64_tr_b16 v[244:245], v251 offset:64
    v_cvt_pk_bf16_f32 v164, v136, v137
    v_cvt_pk_bf16_f32 v165, v138, v139
    v_mfma_f32_16x16x32_bf16 v[148:151], v[84:87], v[224:227], 0
    ds_read_b64_tr_b16 v[246:247], v251 offset:1344
    v_cvt_pk_bf16_f32 v166, v140, v141
    v_cvt_pk_bf16_f32 v167, v142, v143
    s_waitcnt lgkmcnt(8)
    v_mfma_f32_16x16x32_bf16 v[152:155], v[80:83], v[228:231], 0
    ds_read_b64_tr_b16 v[224:225], v250 offset:10304
    v_mfma_f32_16x16x32_bf16 v[156:159], v[84:87], v[228:231], 0
    ds_read_b64_tr_b16 v[226:227], v250 offset:11584
    v_mfma_f32_16x16x32_bf16 v[0:3], v[160:163], v[112:115], v[0:3]
    v_mfma_f32_16x16x32_bf16 v[4:7], v[160:163], v[116:119], v[4:7]
    v_mfma_f32_16x16x32_bf16 v[8:11], v[164:167], v[112:115], v[8:11]
    v_mfma_f32_16x16x32_bf16 v[12:15], v[164:167], v[116:119], v[12:15]
    s_barrier
    s_waitcnt lgkmcnt(8)
    v_mfma_f32_16x16x32_bf16 v[144:147], v[88:91], v[232:235], v[144:147]
    ds_read_b64_tr_b16 v[228:229], v251 offset:10304
    v_mfma_f32_16x16x32_bf16 v[148:151], v[92:95], v[232:235], v[148:151]
    ds_read_b64_tr_b16 v[230:231], v251 offset:11584
    s_waitcnt lgkmcnt(8)
    v_mfma_f32_16x16x32_bf16 v[152:155], v[88:91], v[236:239], v[152:155]
    ds_read_b64_tr_b16 v[232:233], v250 offset:61568
    v_cvt_pk_bf16_f32 v160, v0, v1
    v_cvt_pk_bf16_f32 v161, v2, v3
    v_mfma_f32_16x16x32_bf16 v[156:159], v[92:95], v[236:239], v[156:159]
    ds_read_b64_tr_b16 v[234:235], v250 offset:62848
    v_cvt_pk_bf16_f32 v162, v4, v5
    v_cvt_pk_bf16_f32 v163, v6, v7
    s_waitcnt lgkmcnt(8)
    v_mfma_f32_16x16x32_bf16 v[144:147], v[96:99], v[240:243], v[144:147]
    ds_read_b64_tr_b16 v[236:237], v251 offset:61568
    buffer_store_dwordx4 v[160:163], v252, s[64:67], s12 offen offset:0 sc1
    v_cvt_pk_bf16_f32 v164, v8, v9
    v_mfma_f32_16x16x32_bf16 v[148:151], v[100:103], v[240:243], v[148:151]
    ds_read_b64_tr_b16 v[238:239], v251 offset:62848
    v_cvt_pk_bf16_f32 v165, v10, v11
    v_cvt_pk_bf16_f32 v166, v12, v13
    s_waitcnt lgkmcnt(8)
    v_mfma_f32_16x16x32_bf16 v[152:155], v[96:99], v[244:247], v[152:155]
    v_add_u32 v250, 20480, v250
    v_add_u32 v251, 20480, v251
    ds_read_b64_tr_b16 v[240:241], v250 offset:51328
    v_mfma_f32_16x16x32_bf16 v[156:159], v[100:103], v[244:247], v[156:159]
    ds_read_b64_tr_b16 v[242:243], v250 offset:52608
    v_cvt_pk_bf16_f32 v167, v14, v15
    buffer_store_dwordx4 v[164:167], v252, s[64:67], s12 offen offset:1024 sc1
    s_waitcnt lgkmcnt(8)
    v_mfma_f32_16x16x32_bf16 v[144:147], v[104:107], v[224:227], v[144:147]
    ds_read_b64_tr_b16 v[244:245], v251 offset:51328
    s_cmp_eq_u32 s13, 1
    s_cbranch_scc0 L_own0
    s_waitcnt lgkmcnt(8)
    ds_write_b128 v255, v[0:3] offset:0
    ds_write_b128 v255, v[4:7] offset:1024
    ds_write_b128 v255, v[8:11] offset:2048
    ds_write_b128 v255, v[12:15] offset:3072
    v_mov_b32 v254, 1
    ds_write_b32 v253, v254
L_own0:
    v_mfma_f32_16x16x32_bf16 v[148:151], v[108:111], v[224:227], v[148:151]
    ds_read_b64_tr_b16 v[246:247], v251 offset:52608
    s_waitcnt lgkmcnt(8)
    v_mfma_f32_16x16x32_bf16 v[152:155], v[104:107], v[228:231], v[152:155]
    v_add_u32 v250, 4294946816, v250
    v_add_u32 v251, 4294946816, v251
    ds_read_b64_tr_b16 v[224:225], v250 offset:128
    v_mfma_f32_16x16x32_bf16 v[156:159], v[108:111], v[228:231], v[156:159]
    ds_read_b64_tr_b16 v[226:227], v250 offset:1408
    v_mfma_f32_16x16x32_bf16 v[16:19], v[168:171], v[200:203], v[16:19]
    v_mfma_f32_16x16x32_bf16 v[20:23], v[168:171], v[204:207], v[20:23]
    v_mfma_f32_16x16x32_bf16 v[24:27], v[172:175], v[200:203], v[24:27]
    v_cvt_pk_bf16_f32 v168, v144, v145
    v_cvt_pk_bf16_f32 v169, v146, v147
    v_cvt_pk_bf16_f32 v170, v148, v149
    v_mfma_f32_16x16x32_bf16 v[28:31], v[172:175], v[204:207], v[28:31]
    v_cvt_pk_bf16_f32 v171, v150, v151
    s_waitcnt lgkmcnt(8)
    v_mfma_f32_16x16x32_bf16 v[128:131], v[80:83], v[232:235], 0
    ds_read_b64_tr_b16 v[228:229], v251 offset:128
    v_cvt_pk_bf16_f32 v172, v152, v153
    v_cvt_pk_bf16_f32 v173, v154, v155
    v_mfma_f32_16x16x32_bf16 v[132:135], v[84:87], v[232:235], 0
    ds_read_b64_tr_b16 v[230:231], v251 offset:1408
    v_cvt_pk_bf16_f32 v174, v156, v157
    v_cvt_pk_bf16_f32 v175, v158, v159
    s_waitcnt lgkmcnt(8)
    v_mfma_f32_16x16x32_bf16 v[136:139], v[80:83], v[236:239], 0
    ds_read_b64_tr_b16 v[232:233], v250 offset:10368
    v_mfma_f32_16x16x32_bf16 v[140:143], v[84:87], v[236:239], 0
    ds_read_b64_tr_b16 v[234:235], v250 offset:11648
    v_mfma_f32_16x16x32_bf16 v[16:19], v[168:171], v[112:115], v[16:19]
    v_mfma_f32_16x16x32_bf16 v[20:23], v[168:171], v[116:119], v[20:23]
    v_mfma_f32_16x16x32_bf16 v[24:27], v[172:175], v[112:115], v[24:27]
    v_mfma_f32_16x16x32_bf16 v[28:31], v[172:175], v[116:119], v[28:31]
    s_waitcnt lgkmcnt(8)
    v_mfma_f32_16x16x32_bf16 v[128:131], v[88:91], v[240:243], v[128:131]
    ds_read_b64_tr_b16 v[236:237], v251 offset:10368
    v_mfma_f32_16x16x32_bf16 v[132:135], v[92:95], v[240:243], v[132:135]
    ds_read_b64_tr_b16 v[238:239], v251 offset:11648
    s_waitcnt lgkmcnt(8)
    v_mfma_f32_16x16x32_bf16 v[136:139], v[88:91], v[244:247], v[136:139]
    ds_read_b64_tr_b16 v[240:241], v250 offset:61632
    v_cvt_pk_bf16_f32 v168, v16, v17
    v_cvt_pk_bf16_f32 v169, v18, v19
    v_mfma_f32_16x16x32_bf16 v[140:143], v[92:95], v[244:247], v[140:143]
    ds_read_b64_tr_b16 v[242:243], v250 offset:62912
    v_cvt_pk_bf16_f32 v170, v20, v21
    v_cvt_pk_bf16_f32 v171, v22, v23
    s_waitcnt lgkmcnt(8)
    v_mfma_f32_16x16x32_bf16 v[128:131], v[96:99], v[224:227], v[128:131]
    ds_read_b64_tr_b16 v[244:245], v251 offset:61632
    buffer_store_dwordx4 v[168:171], v252, s[64:67], s12 offen offset:2048 sc1
    v_cvt_pk_bf16_f32 v172, v24, v25
    v_mfma_f32_16x16x32_bf16 v[132:135], v[100:103], v[224:227], v[132:135]
    ds_read_b64_tr_b16 v[246:247], v251 offset:62912
    v_cvt_pk_bf16_f32 v173, v26, v27
    v_cvt_pk_bf16_f32 v174, v28, v29
    s_waitcnt lgkmcnt(8)
    v_mfma_f32_16x16x32_bf16 v[136:139], v[96:99], v[228:231], v[136:139]
    v_add_u32 v250, 20480, v250
    v_add_u32 v251, 20480, v251
    ds_read_b64_tr_b16 v[224:225], v250 offset:51392
    v_mfma_f32_16x16x32_bf16 v[140:143], v[100:103], v[228:231], v[140:143]
    ds_read_b64_tr_b16 v[226:227], v250 offset:52672
    v_cvt_pk_bf16_f32 v175, v30, v31
    buffer_store_dwordx4 v[172:175], v252, s[64:67], s12 offen offset:3072 sc1
    s_waitcnt lgkmcnt(8)
    v_mfma_f32_16x16x32_bf16 v[128:131], v[104:107], v[232:235], v[128:131]
    ds_read_b64_tr_b16 v[228:229], v251 offset:51392
    s_add_u32 s12, s12, 4096
    s_cmp_eq_u32 s13, 1
    s_cbranch_scc0 L_own1
    s_waitcnt lgkmcnt(8)
    ds_write_b128 v255, v[16:19] offset:4096
    ds_write_b128 v255, v[20:23] offset:5120
    ds_write_b128 v255, v[24:27] offset:6144
    ds_write_b128 v255, v[28:31] offset:7168
    v_mov_b32 v254, 2
    ds_write_b32 v253, v254
L_own1:
    v_mfma_f32_16x16x32_bf16 v[132:135], v[108:111], v[232:235], v[132:135]
    ds_read_b64_tr_b16 v[230:231], v251 offset:52672
    s_waitcnt lgkmcnt(8)
    v_mfma_f32_16x16x32_bf16 v[136:139], v[104:107], v[236:239], v[136:139]
    v_add_u32 v250, 4294946816, v250
    v_add_u32 v251, 4294946816, v251
    ds_read_b64_tr_b16 v[232:233], v250 offset:192
    v_mfma_f32_16x16x32_bf16 v[140:143], v[108:111], v[236:239], v[140:143]
    ds_read_b64_tr_b16 v[234:235], v250 offset:1472
    v_mfma_f32_16x16x32_bf16 v[32:35], v[176:179], v[200:203], v[32:35]
    v_mfma_f32_16x16x32_bf16 v[36:39], v[176:179], v[204:207], v[36:39]
    v_mfma_f32_16x16x32_bf16 v[40:43], v[180:183], v[200:203], v[40:43]
    v_cvt_pk_bf16_f32 v176, v128, v129
    v_cvt_pk_bf16_f32 v177, v130, v131
    v_cvt_pk_bf16_f32 v178, v132, v133
    v_mfma_f32_16x16x32_bf16 v[44:47], v[180:183], v[204:207], v[44:47]
    v_cvt_pk_bf16_f32 v179, v134, v135
    s_waitcnt lgkmcnt(8)
    v_mfma_f32_16x16x32_bf16 v[144:147], v[80:83], v[240:243], 0
    ds_read_b64_tr_b16 v[236:237], v251 offset:192
    v_cvt_pk_bf16_f32 v180, v136, v137
    v_cvt_pk_bf16_f32 v181, v138, v139
    v_mfma_f32_16x16x32_bf16 v[148:151], v[84:87], v[240:243], 0
    ds_read_b64_tr_b16 v[238:239], v251 offset:1472
    v_cvt_pk_bf16_f32 v182, v140, v141
    v_cvt_pk_bf16_f32 v183, v142, v143
    s_waitcnt lgkmcnt(8)
    v_mfma_f32_16x16x32_bf16 v[152:155], v[80:83], v[244:247], 0
    ds_read_b64_tr_b16 v[240:241], v250 offset:10432
    v_mfma_f32_16x16x32_bf16 v[156:159], v[84:87], v[244:247], 0
    ds_read_b64_tr_b16 v[242:243], v250 offset:11712
    v_mfma_f32_16x16x32_bf16 v[32:35], v[176:179], v[112:115], v[32:35]
    v_mfma_f32_16x16x32_bf16 v[36:39], v[176:179], v[116:119], v[36:39]
    v_mfma_f32_16x16x32_bf16 v[40:43], v[180:183], v[112:115], v[40:43]
    v_mfma_f32_16x16x32_bf16 v[44:47], v[180:183], v[116:119], v[44:47]
    s_waitcnt lgkmcnt(8)
    v_mfma_f32_16x16x32_bf16 v[144:147], v[88:91], v[224:227], v[144:147]
    ds_read_b64_tr_b16 v[244:245], v251 offset:10432
    v_mfma_f32_16x16x32_bf16 v[148:151], v[92:95], v[224:227], v[148:151]
    ds_read_b64_tr_b16 v[246:247], v251 offset:11712
    s_waitcnt lgkmcnt(8)
    v_mfma_f32_16x16x32_bf16 v[152:155], v[88:91], v[228:231], v[152:155]
    ds_read_b64_tr_b16 v[224:225], v250 offset:61696
    v_cvt_pk_bf16_f32 v176, v32, v33
    v_cvt_pk_bf16_f32 v177, v34, v35
    v_mfma_f32_16x16x32_bf16 v[156:159], v[92:95], v[228:231], v[156:159]
    ds_read_b64_tr_b16 v[226:227], v250 offset:62976
    v_cvt_pk_bf16_f32 v178, v36, v37
    v_cvt_pk_bf16_f32 v179, v38, v39
    s_waitcnt lgkmcnt(8)
    v_mfma_f32_16x16x32_bf16 v[144:147], v[96:99], v[232:235], v[144:147]
    ds_read_b64_tr_b16 v[228:229], v251 offset:61696
    buffer_store_dwordx4 v[176:179], v252, s[64:67], s12 offen offset:0 sc1
    v_cvt_pk_bf16_f32 v180, v40, v41
    v_mfma_f32_16x16x32_bf16 v[148:151], v[100:103], v[232:235], v[148:151]
    ds_read_b64_tr_b16 v[230:231], v251 offset:62976
    v_cvt_pk_bf16_f32 v181, v42, v43
    v_cvt_pk_bf16_f32 v182, v44, v45
    s_waitcnt lgkmcnt(8)
    v_mfma_f32_16x16x32_bf16 v[152:155], v[96:99], v[236:239], v[152:155]
    v_add_u32 v250, 20480, v250
    v_add_u32 v251, 20480, v251
    ds_read_b64_tr_b16 v[232:233], v250 offset:51456
    v_mfma_f32_16x16x32_bf16 v[156:159], v[100:103], v[236:239], v[156:159]
    ds_read_b64_tr_b16 v[234:235], v250 offset:52736
    v_cvt_pk_bf16_f32 v183, v46, v47
    buffer_store_dwordx4 v[180:183], v252, s[64:67], s12 offen offset:1024 sc1
    s_waitcnt lgkmcnt(8)
    v_mfma_f32_16x16x32_bf16 v[144:147], v[104:107], v[240:243], v[144:147]
    ds_read_b64_tr_b16 v[236:237], v251 offset:51456
    s_cmp_eq_u32 s13, 1
    s_cbranch_scc0 L_own2
    s_waitcnt lgkmcnt(8)
    ds_write_b128 v255, v[32:35] offset:8192
    ds_write_b128 v255, v[36:39] offset:9216
    ds_write_b128 v255, v[40:43] offset:10240
    ds_write_b128 v255, v[44:47] offset:11264
    v_mov_b32 v254, 3
    ds_write_b32 v253, v254
L_own2:
    v_mfma_f32_16x16x32_bf16 v[148:151], v[108:111], v[240:243], v[148:151]
    ds_read_b64_tr_b16 v[238:239], v251 offset:52736
    s_waitcnt lgkmcnt(8)
    v_mfma_f32_16x16x32_bf16 v[152:155], v[104:107], v[244:247], v[152:155]
    v_add_u32 v250, 4294946816, v250
    v_add_u32 v251, 4294946816, v251
    ds_read_b64_tr_b16 v[240:241], v250 offset:256
    v_mfma_f32_16x16x32_bf16 v[156:159], v[108:111], v[244:247], v[156:159]
    ds_read_b64_tr_b16 v[242:243], v250 offset:1536
    v_mfma_f32_16x16x32_bf16 v[48:51], v[184:187], v[200:203], v[48:51]
    v_mfma_f32_16x16x32_bf16 v[52:55], v[184:187], v[204:207], v[52:55]
    v_mfma_f32_16x16x32_bf16 v[56:59], v[188:191], v[200:203], v[56:59]
    v_cvt_pk_bf16_f32 v184, v144, v145
    v_cvt_pk_bf16_f32 v185, v146, v147
    v_cvt_pk_bf16_f32 v186, v148, v149
    v_mfma_f32_16x16x32_bf16 v[60:63], v[188:191], v[204:207], v[60:63]
    v_cvt_pk_bf16_f32 v187, v150, v151
    s_waitcnt lgkmcnt(8)
    v_mfma_f32_16x16x32_bf16 v[128:131], v[80:83], v[224:227], 0
    ds_read_b64_tr_b16 v[244:245], v251 offset:256
    v_cvt_pk_bf16_f32 v188, v152, v153
    v_cvt_pk_bf16_f32 v189, v154, v155
    v_mfma_f32_16x16x32_bf16 v[132:135], v[84:87], v[224:227], 0
    ds_read_b64_tr_b16 v[246:247], v251 offset:1536
    v_cvt_pk_bf16_f32 v190, v156, v157
    v_cvt_pk_bf16_f32 v191, v158, v159
    s_waitcnt lgkmcnt(8)
    v_mfma_f32_16x16x32_bf16 v[136:139], v[80:83], v[228:231], 0
    ds_read_b64_tr_b16 v[224:225], v250 offset:10496
    v_mfma_f32_16x16x32_bf16 v[140:143], v[84:87], v[228:231], 0
    ds_read_b64_tr_b16 v[226:227], v250 offset:11776
    v_mfma_f32_16x16x32_bf16 v[48:51], v[184:187], v[112:115], v[48:51]
    v_mfma_f32_16x16x32_bf16 v[52:55], v[184:187], v[116:119], v[52:55]
    v_mfma_f32_16x16x32_bf16 v[56:59], v[188:191], v[112:115], v[56:59]
    v_mfma_f32_16x16x32_bf16 v[60:63], v[188:191], v[116:119], v[60:63]
    s_barrier
    s_waitcnt lgkmcnt(8)
    v_mfma_f32_16x16x32_bf16 v[128:131], v[88:91], v[232:235], v[128:131]
    ds_read_b64_tr_b16 v[228:229], v251 offset:10496
    v_mfma_f32_16x16x32_bf16 v[132:135], v[92:95], v[232:235], v[132:135]
    ds_read_b64_tr_b16 v[230:231], v251 offset:11776
    s_waitcnt lgkmcnt(8)
    v_mfma_f32_16x16x32_bf16 v[136:139], v[88:91], v[236:239], v[136:139]
    v_cvt_pk_bf16_f32 v184, v48, v49
    v_cvt_pk_bf16_f32 v185, v50, v51
    v_cvt_pk_bf16_f32 v186, v52, v53
    v_mfma_f32_16x16x32_bf16 v[140:143], v[92:95], v[236:239], v[140:143]
    v_cvt_pk_bf16_f32 v187, v54, v55
    buffer_store_dwordx4 v[184:187], v252, s[64:67], s12 offen offset:2048 sc1
    v_cvt_pk_bf16_f32 v188, v56, v57
    s_waitcnt lgkmcnt(6)
    v_mfma_f32_16x16x32_bf16 v[128:131], v[96:99], v[240:243], v[128:131]
    v_cvt_pk_bf16_f32 v189, v58, v59
    v_cvt_pk_bf16_f32 v190, v60, v61
    v_cvt_pk_bf16_f32 v191, v62, v63
    v_mfma_f32_16x16x32_bf16 v[132:135], v[100:103], v[240:243], v[132:135]
    buffer_store_dwordx4 v[188:191], v252, s[64:67], s12 offen offset:3072 sc1
    s_add_u32 s12, s12, 4096
    s_cmp_eq_u32 s13, 1
    s_cbranch_scc0 L_own3
    s_waitcnt lgkmcnt(8)
    ds_write_b128 v255, v[48:51] offset:12288
    ds_write_b128 v255, v[52:55] offset:13312
    ds_write_b128 v255, v[56:59] offset:14336
    ds_write_b128 v255, v[60:63] offset:15360
    v_mov_b32 v254, 4
    ds_write_b32 v253, v254
L_own3:
    s_waitcnt lgkmcnt(4)
    v_mfma_f32_16x16x32_bf16 v[136:139], v[96:99], v[244:247], v[136:139]
    v_mfma_f32_16x16x32_bf16 v[140:143], v[100:103], v[244:247], v[140:143]
    s_waitcnt lgkmcnt(2)
    v_mfma_f32_16x16x32_bf16 v[128:131], v[104:107], v[224:227], v[128:131]
    v_mfma_f32_16x16x32_bf16 v[132:135], v[108:111], v[224:227], v[132:135]
    s_waitcnt lgkmcnt(0)
    v_mfma_f32_16x16x32_bf16 v[136:139], v[104:107], v[228:231], v[136:139]
    v_mfma_f32_16x16x32_bf16 v[140:143], v[108:111], v[228:231], v[140:143]
    v_mfma_f32_16x16x32_bf16 v[64:67], v[192:195], v[200:203], v[64:67]
    v_mfma_f32_16x16x32_bf16 v[68:71], v[192:195], v[204:207], v[68:71]
    v_mfma_f32_16x16x32_bf16 v[72:75], v[196:199], v[200:203], v[72:75]
    s_nop 0
    v_cvt_pk_bf16_f32 v192, v128, v129
    v_cvt_pk_bf16_f32 v193, v130, v131
    v_cvt_pk_bf16_f32 v194, v132, v133
    v_mfma_f32_16x16x32_bf16 v[76:79], v[196:199], v[204:207], v[76:79]
    v_cvt_pk_bf16_f32 v195, v134, v135
    s_nop 1
    v_mfma_f32_16x16x32_bf16 v[64:67], v[192:195], v[112:115], v[64:67]
    v_cvt_pk_bf16_f32 v196, v136, v137
    v_cvt_pk_bf16_f32 v197, v138, v139
    v_cvt_pk_bf16_f32 v198, v140, v141
    v_mfma_f32_16x16x32_bf16 v[68:71], v[192:195], v[116:119], v[68:71]
    v_cvt_pk_bf16_f32 v199, v142, v143
    s_nop 1
    v_mfma_f32_16x16x32_bf16 v[72:75], v[196:199], v[112:115], v[72:75]
    v_mfma_f32_16x16x32_bf16 v[76:79], v[196:199], v[116:119], v[76:79]
    v_cvt_pk_bf16_f32 v192, v64, v65
    v_cvt_pk_bf16_f32 v193, v66, v67
    s_nop 0
    v_cvt_pk_bf16_f32 v194, v68, v69
    v_cvt_pk_bf16_f32 v195, v70, v71
    buffer_store_dwordx4 v[192:195], v252, s[64:67], s12 offen offset:0 sc1
    s_nop 0
    v_cvt_pk_bf16_f32 v196, v72, v73
    v_cvt_pk_bf16_f32 v197, v74, v75
    v_cvt_pk_bf16_f32 v198, v76, v77
    v_cvt_pk_bf16_f32 v199, v78, v79
    buffer_store_dwordx4 v[196:199], v252, s[64:67], s12 offen offset:1024 sc1
    s_cmp_eq_u32 s13, 1
    s_cbranch_scc0 L_own4
    s_waitcnt lgkmcnt(8)
    v_mov_b32 v254, 5
    ds_write_b32 v253, v254
L_own4:
    s_cmp_eq_u32 s13, 1
    s_cbranch_scc0 L_cdone
    v_lshrrev_b32 v200, 4, v252
    v_add_u32 v203, 8192, v252
    v_and_b32 v201, 15, v200
    v_mul_u32_u24 v201, 2560, v201
    v_bfe_u32 v202, v200, 4, 1
    v_lshl_add_u32 v201, v202, 5, v201
    v_lshrrev_b32 v202, 5, v200
    v_lshl_add_u32 v201, v202, 4, v201
    s_mov_b32 s21, 0xffff0000
    s_lshl_b32 s20, s6, 2
    s_add_u32 s20, s20, s5
    s_mul_i32 s20, s20, 81920
    s_mul_i32 s14, s4, 1280
    s_add_u32 s20, s20, s14
    s_mul_i32 s14, s7, 320
    s_add_u32 s20, s20, s14
    s_mul_i32 s22, s2, 40960
    s_add_u32 s22, s22, 8388608
    s_add_u32 s23, s5, 1
    s_and_b32 s23, s23, 3
    s_mul_i32 s23, s23, 10240
    s_add_u32 s23, s23, s22
    s_add_u32 s24, s5, 2
    s_and_b32 s24, s24, 3
    s_mul_i32 s24, s24, 10240
    s_add_u32 s24, s24, s22
    s_add_u32 s25, s5, 3
    s_and_b32 s25, s25, 3
    s_mul_i32 s25, s25, 10240
    s_add_u32 s25, s25, s22
    s_mov_b32 s14, 8388608
L_cok:
    ds_read_b32 v202, v253 offset:4
    s_waitcnt lgkmcnt(0)
    v_readfirstlane_b32 s16, v202
    s_sub_u32 s14, s14, 1
    s_cbranch_scc1 L_cok_d
    s_cmp_ge_u32 s16, 1
    s_cbranch_scc0 L_cok
L_cok_d:
    s_add_u32 s18, s20, 256
    s_add_u32 s19, s18, 40960
    s_mov_b32 s14, 524288
    buffer_load_dwordx4 v[80:83], v203, s[64:67], s23 offen offset:0 sc1
    buffer_load_dwordx4 v[84:87], v203, s[64:67], s23 offen offset:1024 sc1
    buffer_load_dwordx4 v[88:91], v203, s[64:67], s24 offen offset:0 sc1
    buffer_load_dwordx4 v[92:95], v203, s[64:67], s24 offen offset:1024 sc1
    buffer_load_dwordx4 v[96:99], v203, s[64:67], s25 offen offset:0 sc1
    buffer_load_dwordx4 v[100:103], v203, s[64:67], s25 offen offset:1024 sc1
    s_branch L_f4b
L_f4a:
    buffer_load_dwordx4 v[80:83], v203, s[64:67], s23 offen offset:0 sc1
    buffer_load_dwordx4 v[84:87], v203, s[64:67], s23 offen offset:1024 sc1
    buffer_load_dwordx4 v[88:91], v203, s[64:67], s24 offen offset:0 sc1
    buffer_load_dwordx4 v[92:95], v203, s[64:67], s24 offen offset:1024 sc1
    buffer_load_dwordx4 v[96:99], v203, s[64:67], s25 offen offset:0 sc1
    buffer_load_dwordx4 v[100:103], v203, s[64:67], s25 offen offset:1024 sc1
L_f4b:
    s_waitcnt vmcnt(0)
    v_max3_u32 v202, v80, v81, v82
    v_max3_u32 v202, v202, v83, v84
    v_max3_u32 v202, v202, v85, v86
    v_max3_u32 v202, v202, v87, v88
    v_max3_u32 v202, v202, v89, v90
    v_max3_u32 v202, v202, v91, v92
    v_max3_u32 v202, v202, v93, v94
    v_max3_u32 v202, v202, v95, v96
    v_max3_u32 v202, v202, v97, v98
    v_max3_u32 v202, v202, v99, v100
    v_max3_u32 v202, v202, v101, v102
    v_max_u32 v202, v202, v103
    v_cmp_eq_u32 vcc, -1, v202
    s_sub_u32 s14, s14, 1
    s_cbranch_scc1 L_f4A
    s_cbranch_vccnz L_f4a
L_f4A:
    v_lshlrev_b32 v204, 16, v80
    v_and_b32 v205, s21, v80
    v_add_f32 v64, v64, v204
    v_add_f32 v65, v65, v205
    v_lshlrev_b32 v204, 16, v81
    v_and_b32 v205, s21, v81
    v_add_f32 v66, v66, v204
    v_add_f32 v67, v67, v205
    v_lshlrev_b32 v204, 16, v82
    v_and_b32 v205, s21, v82
    v_add_f32 v68, v68, v204
    v_add_f32 v69, v69, v205
    v_lshlrev_b32 v204, 16, v83
    v_and_b32 v205, s21, v83
    v_add_f32 v70, v70, v204
    v_add_f32 v71, v71, v205
    v_lshlrev_b32 v204, 16, v84
    v_and_b32 v205, s21, v84
    v_add_f32 v72, v72, v204
    v_add_f32 v73, v73, v205
    v_lshlrev_b32 v204, 16, v85
    v_and_b32 v205, s21, v85
    v_add_f32 v74, v74, v204
    v_add_f32 v75, v75, v205
    v_lshlrev_b32 v204, 16, v86
    v_and_b32 v205, s21, v86
    v_add_f32 v76, v76, v204
    v_add_f32 v77, v77, v205
    v_lshlrev_b32 v204, 16, v87
    v_and_b32 v205, s21, v87
    v_add_f32 v78, v78, v204
    v_add_f32 v79, v79, v205
    v_lshlrev_b32 v204, 16, v88
    v_and_b32 v205, s21, v88
    v_add_f32 v64, v64, v204
    v_add_f32 v65, v65, v205
    v_lshlrev_b32 v204, 16, v89
    v_and_b32 v205, s21, v89
    v_add_f32 v66, v66, v204
    v_add_f32 v67, v67, v205
    v_lshlrev_b32 v204, 16, v90
    v_and_b32 v205, s21, v90
    v_add_f32 v68, v68, v204
    v_add_f32 v69, v69, v205
    v_lshlrev_b32 v204, 16, v91
    v_and_b32 v205, s21, v91
    v_add_f32 v70, v70, v204
    v_add_f32 v71, v71, v205
    v_lshlrev_b32 v204, 16, v92
    v_and_b32 v205, s21, v92
    v_add_f32 v72, v72, v204
    v_add_f32 v73, v73, v205
    v_lshlrev_b32 v204, 16, v93
    v_and_b32 v205, s21, v93
    v_add_f32 v74, v74, v204
    v_add_f32 v75, v75, v205
    v_lshlrev_b32 v204, 16, v94
    v_and_b32 v205, s21, v94
    v_add_f32 v76, v76, v204
    v_add_f32 v77, v77, v205
    v_lshlrev_b32 v204, 16, v95
    v_and_b32 v205, s21, v95
    v_add_f32 v78, v78, v204
    v_add_f32 v79, v79, v205
    v_lshlrev_b32 v204, 16, v96
    v_and_b32 v205, s21, v96
    v_add_f32 v64, v64, v204
    v_add_f32 v65, v65, v205
    v_lshlrev_b32 v204, 16, v97
    v_and_b32 v205, s21, v97
    v_add_f32 v66, v66, v204
    v_add_f32 v67, v67, v205
    v_lshlrev_b32 v204, 16, v98
    v_and_b32 v205, s21, v98
    v_add_f32 v68, v68, v204
    v_add_f32 v69, v69, v205
    v_lshlrev_b32 v204, 16, v99
    v_and_b32 v205, s21, v99
    v_add_f32 v70, v70, v204
    v_add_f32 v71, v71, v205
    v_lshlrev_b32 v204, 16, v100
    v_and_b32 v205, s21, v100
    v_add_f32 v72, v72, v204
    v_add_f32 v73, v73, v205
    v_lshlrev_b32 v204, 16, v101
    v_and_b32 v205, s21, v101
    v_add_f32 v74, v74, v204
    v_add_f32 v75, v75, v205
    v_lshlrev_b32 v204, 16, v102
    v_and_b32 v205, s21, v102
    v_add_f32 v76, v76, v204
    v_add_f32 v77, v77, v205
    v_lshlrev_b32 v204, 16, v103
    v_and_b32 v205, s21, v103
    v_add_f32 v78, v78, v204
    v_add_f32 v79, v79, v205
    v_cvt_pk_bf16_f32 v208, v64, v65
    v_cvt_pk_bf16_f32 v209, v66, v67
    v_cvt_pk_bf16_f32 v210, v72, v73
    v_cvt_pk_bf16_f32 v211, v74, v75
    v_cvt_pk_bf16_f32 v212, v68, v69
    v_cvt_pk_bf16_f32 v213, v70, v71
    v_cvt_pk_bf16_f32 v214, v76, v77
    v_cvt_pk_bf16_f32 v215, v78, v79
    v_permlane16_swap_b32 v208, v210
    v_permlane16_swap_b32 v209, v211
    v_permlane16_swap_b32 v212, v214
    v_permlane16_swap_b32 v213, v215
    buffer_store_dwordx4 v[208:211], v201, s[68:71], s18 offen
    buffer_store_dwordx4 v[212:215], v201, s[68:71], s19 offen
L_cdone:
    s_endpgm
L_mark_s:
    s_mov_b32 s13, 524288
L_mark_l:
    buffer_load_dword v23, v51, s[72:75], 0 offen sc1
    s_waitcnt vmcnt(0)
    v_cmp_ne_u32 vcc, 0, v23
    s_sub_u32 s13, s13, 1
    s_cbranch_scc1 L_mark_d
    s_cmp_eq_u64 vcc, exec
    s_cbranch_scc0 L_mark_l
    s_branch L_mark_d
L_cp_s:
    s_mov_b32 s13, 524288
L_cp_l:
    buffer_load_dword v23, v21, s[64:67], 0 offen sc1
    s_waitcnt vmcnt(0)
    v_cmp_ne_u32 vcc, 0, v23
    s_sub_u32 s13, s13, 1
    s_cbranch_scc1 L_cp_d
    s_cmp_eq_u64 vcc, exec
    s_cbranch_scc0 L_cp_l
    s_branch L_cp_d
L_ce_s:
    s_mov_b32 s13, 524288
L_ce_l:
    buffer_load_dword v23, v22, s[64:67], 0 offen sc1
    s_waitcnt vmcnt(0)
    v_cmp_ne_u32 vcc, 0, v23
    s_sub_u32 s13, s13, 1
    s_cbranch_scc1 L_ce_d
    s_cmp_eq_u64 vcc, exec
    s_cbranch_scc0 L_ce_l
    s_branch L_ce_d
L_cs0:
    s_mov_b32 s16, 524288
L_cl0:
    buffer_load_dwordx4 v[200:203], v252, s[64:67], s14 offen sc1
    buffer_load_dwordx4 v[204:207], v252, s[64:67], s14 offen offset:1024 sc1
    s_waitcnt vmcnt(0)
    v_max3_u32 v253, v200, v201, v202
    v_max3_u32 v253, v253, v203, v204
    v_max3_u32 v253, v253, v205, v206
    v_max_u32 v253, v253, v207
    v_cmp_eq_u32 vcc, -1, v253
    s_sub_u32 s16, s16, 1
    s_cbranch_scc1 L_cd0
    s_cbranch_vccnz L_cl0
    s_branch L_cd0
L_cs1:
    s_mov_b32 s16, 524288
L_cl1:
    buffer_load_dwordx4 v[200:203], v252, s[64:67], s14 offen sc1
    buffer_load_dwordx4 v[204:207], v252, s[64:67], s14 offen offset:1024 sc1
    s_waitcnt vmcnt(0)
    v_max3_u32 v253, v200, v201, v202
    v_max3_u32 v253, v253, v203, v204
    v_max3_u32 v253, v253, v205, v206
    v_max_u32 v253, v253, v207
    v_cmp_eq_u32 vcc, -1, v253
    s_sub_u32 s16, s16, 1
    s_cbranch_scc1 L_cd1
    s_cbranch_vccnz L_cl1
    s_branch L_cd1
L_end:
    s_endpgm
.section .rodata,"a"
.p2align 6
.amdhsa_kernel concat_heads__mha_block_cached__gqa_block_cached__near_ridge_kernel
  .amdhsa_next_free_vgpr 256
  .amdhsa_next_free_sgpr 102
  .amdhsa_accum_offset 256
  .amdhsa_group_segment_fixed_size 0
  .amdhsa_kernarg_size 104
  .amdhsa_user_sgpr_count 2
  .amdhsa_user_sgpr_kernarg_segment_ptr 1
  .amdhsa_system_sgpr_workgroup_id_x 1
  .amdhsa_float_denorm_mode_32 3
.end_amdhsa_kernel
```
